```python
import torch

def _softmax(x, axis=-1):
    return torch.softmax(x, dim=axis)
def _gelu(x):
    return torch.nn.functional.gelu(x, approximate="tanh")
def _silu(x):
    return torch.nn.functional.silu(x)
def _sigmoid(x):
    return torch.sigmoid(x)
def _layernorm(x, axis=-1, eps=1e-5):
    m = x.mean(dim=axis, keepdim=True)
    v = x.var(dim=axis, keepdim=True, unbiased=False)
    return (x - m) / torch.sqrt(v + eps)
def _scatter_add(tgt, idx, src, axis=0):
    return tgt.clone().index_add_(axis, idx, src)
def _segment_sum(src, seg, n):
    out = torch.zeros((n,) + src.shape[1:], dtype=src.dtype)
    return out.index_add_(0, seg, src)
def _pad(x, pw):
    flat = tuple(v for pair in reversed(pw) for v in pair)
    return torch.nn.functional.pad(x, flat)

kernel_name = 'sequential_preLN__linear_kernel_hedgehog__glu_gated_bilinear__prompt'

def setup_inputs():

    _w = (lambda a: (lambda t: t.to(torch.bfloat16) if t.is_floating_point() else t)(torch.as_tensor(a)))
    def _A_setup():
        B, S, D, H = 1, 2048, 512, 32
        Dh = D // H
        return {
            "x": _w((lambda *s: torch.randn(*s, dtype=torch.bfloat16) * 0.05)(B, S, D)),
            "wqkv": _w((lambda *s: torch.randn(*s, dtype=torch.bfloat16) * 0.2)(D, 3 * D)),
            "w_phi": _w((lambda *s: torch.randn(*s, dtype=torch.bfloat16) * 0.2)(H, Dh, Dh) * (Dh ** -0.5)),
            "wo": _w((lambda *s: torch.randn(*s, dtype=torch.bfloat16) * 0.05)(D, D)),
        }
    _A_in = _A_setup()

    def _B_setup():
        B, S, D, F = 1, 2048, 512, 1792
        return {
            "x": _w((lambda *s: torch.randn(*s, dtype=torch.bfloat16) * 0.05)(B, S, D)),
            "w_gate": _w((lambda *s: torch.randn(*s, dtype=torch.bfloat16) * 0.4)(D, F) * (D ** -0.5)),
            "w_up": _w((lambda *s: torch.randn(*s, dtype=torch.bfloat16) * 0.4)(D, F) * (D ** -0.5)),
            "w_down": _w((lambda *s: torch.randn(*s, dtype=torch.bfloat16) * 0.4)(F, D) * (F ** -0.5)),
        }
    _B_in = _B_setup()

    return {
        "A_x": _A_in["x"],
        "A_wqkv": _A_in["wqkv"],
        "A_w_phi": _A_in["w_phi"],
        "A_wo": _A_in["wo"],
        "B_x": _B_in["x"],
        "B_w_gate": _B_in["w_gate"],
        "B_w_up": _B_in["w_up"],
        "B_w_down": _B_in["w_down"],
    }

def reference(A_x, A_wqkv, A_w_phi, A_wo, B_x, B_w_gate, B_w_up, B_w_down):
    def _A_ref(x, wqkv, w_phi, wo):
        B, S, D = x.shape
        H = 32; Dh = D // H
        qkv = (lambda x, *d: x.permute(*d))((x @ wqkv).reshape(B, S, 3, H, Dh), 2, 0, 3, 1, 4)
        q, k, v = qkv[0], qkv[1], qkv[2]
        pq = torch.einsum("bhsd,hdf->bhsf", q, w_phi)
        pk = torch.einsum("bhsd,hdf->bhsf", k, w_phi)
        phi_q = torch.concatenate([_softmax(pq, axis=-1), _softmax(-pq, axis=-1)], axis=-1)
        phi_k = torch.concatenate([_softmax(pk, axis=-1), _softmax(-pk, axis=-1)], axis=-1)
        kv = torch.einsum("bhsf,bhsd->bhfd", phi_k, v)
        z  = torch.einsum("bhsf->bhf", phi_k)
        num = torch.einsum("bhqf,bhfd->bhqd", phi_q, kv)
        den = torch.einsum("bhqf,bhf->bhq", phi_q, z)[..., None] + 1e-6
        o = num / den
        return (lambda x, *d: x.permute(*d))(o, 0, 2, 1, 3).reshape(B, S, D) @ wo

    def _B_ref(x, w_gate, w_up, w_down):
        g = torch.einsum("bsd,df->bsf", x, w_gate)
        u = torch.einsum("bsd,df->bsf", x, w_up)
        h = g * u
        return torch.einsum("bsf,fd->bsd", h, w_down)

    x = A_x
    h = x + _A_ref(_layernorm(x, axis=-1), A_wqkv, A_w_phi, A_wo)
    h2 = h + _B_ref(_layernorm(h, axis=-1), B_w_gate, B_w_up, B_w_down)
    return h2
```

```asm
; @launch grid=(256,1,1) block=(512,1,1) lds=163840
.amdgcn_target "amdgcn-amd-amdhsa--gfx950"
.text
.globl sequential_preLN__linear_kernel_hedgehog__glu_gated_bilinear__prompt_kernel
.p2align 8
.type sequential_preLN__linear_kernel_hedgehog__glu_gated_bilinear__prompt_kernel,@function
sequential_preLN__linear_kernel_hedgehog__glu_gated_bilinear__prompt_kernel:
    s_cmp_ge_u32 s2, 256
    s_cbranch_scc1 L_END
    s_load_dwordx16 s[48:63], s[0:1], 0
    s_load_dwordx2 s[44:45], s[0:1], 64
    s_load_dwordx2 s[46:47], s[0:1], 80
    v_lshrrev_b32 v1, 6, v0
    v_and_b32 v0, 63, v0
    v_readfirstlane_b32 s3, v1
    s_and_b32 s4, s2, 7
    s_lshr_b32 s5, s2, 3
    s_and_b32 s6, s5, 7
    s_lshr_b32 s7, s5, 3
    s_cmp_lt_u32 s3, 4
    s_cbranch_scc1 C_ENTRY
    s_cmp_eq_u32 s3, 6
    s_cbranch_scc1 AX_ENTRY
    s_cmp_eq_u32 s3, 7
    s_cbranch_scc1 SY_ENTRY
    v_lshrrev_b32 v1, 3, v0
    v_and_b32 v2, 7, v0
    v_lshrrev_b32 v3, 4, v0
    v_and_b32 v4, 1, v3
    v_xor_b32 v5, v2, v3
    v_lshlrev_b32 v5, 4, v5
    v_lshl_add_u32 v5, v1, 10, v5
    v_xor_b32 v6, 64, v5
    v_add_u32 v48, 0, v5
    v_add_u32 v49, 7168, v6
    v_add_u32 v50, 14336, v5
    v_add_u32 v51, 21504, v6
    v_mul_u32_u24 v5, 3072, v1
    v_lshlrev_b32 v6, 1, v4
    v_xor_b32 v6, v2, v6
    v_lshl_add_u32 v6, v6, 4, v5
    v_xor_b32 v7, 64, v6
    v_add_u32 v52, 0, v6
    v_add_u32 v56, 0, v7
    v_add_u32 v53, 23552, v6
    v_add_u32 v57, 23552, v7
    v_add_u32 v54, 47104, v6
    v_add_u32 v58, 47104, v7
    v_add_u32 v55, 70656, v6
    v_add_u32 v59, 70656, v7
    v_lshlrev_b32 v6, 2, v4
    v_xor_b32 v6, v2, v6
    v_lshl_add_u32 v6, v6, 4, v5
    v_add_u32 v60, 0, v6
    v_add_u32 v61, 23552, v6
    v_add_u32 v62, 47104, v6
    v_add_u32 v63, 70656, v6
    s_sub_u32 s24, s3, 4
    s_lshl_b32 s25, s24, 12
    s_lshl_b32 s26, s4, 18
    s_lshl_b32 s98, s7, 16
    s_add_u32 s26, s26, s98
    s_lshl_b32 s98, s24, 15
    s_add_u32 s26, s26, s98
    s_mul_i32 s27, s24, 98304
    s_lshl_b32 s98, s6, 7
    s_add_u32 s27, s27, s98
    s_lshl_b32 s40, s7, 1
    s_add_u32 s40, s40, s6
    s_mov_b32 s10, 2097152
    s_mov_b32 s11, 0x20000
    s_mov_b32 s14, 1572864
    s_mov_b32 s15, 0x20000
    s_add_u32 s41, s40, 0
    s_and_b32 s41, s41, 7
    s_lshl_b32 s42, s41, 7
    s_add_u32 s42, s42, s26
    s_mul_i32 s43, s41, 196608
    s_add_u32 s43, s43, s27
    s_add_u32 s98, s43, 1024
    s_waitcnt lgkmcnt(0)
    s_mov_b32 s12, s50
    s_and_b32 s13, s51, 0xffff
    s_mov_b32 s8, s48
    s_and_b32 s9, s49, 0xffff
    s_add_u32 m0, s25, 8192
    s_nop 0
    buffer_load_dwordx4 v52, s[12:15], s98 offen lds
    buffer_load_dwordx4 v53, s[12:15], s98 offen offset:1024 lds
    buffer_load_dwordx4 v54, s[12:15], s98 offen offset:2048 lds
    buffer_load_dwordx4 v55, s[12:15], s98 offen offset:3072 lds
    s_add_u32 s98, s43, 2048
    s_add_u32 m0, s25, 16384
    s_nop 0
    buffer_load_dwordx4 v56, s[12:15], s98 offen lds
    buffer_load_dwordx4 v57, s[12:15], s98 offen offset:1024 lds
    buffer_load_dwordx4 v58, s[12:15], s98 offen offset:2048 lds
    buffer_load_dwordx4 v59, s[12:15], s98 offen offset:3072 lds
    s_add_u32 m0, s25, 0
    s_nop 0
    buffer_load_dwordx4 v48, s[8:11], s42 offen lds
    buffer_load_dwordx4 v49, s[8:11], s42 offen offset:1024 lds
    buffer_load_dwordx4 v50, s[8:11], s42 offen offset:2048 lds
    buffer_load_dwordx4 v51, s[8:11], s42 offen offset:3072 lds
    s_add_u32 m0, s25, 24576
    s_nop 0
    buffer_load_dwordx4 v60, s[12:15], s43 offen lds
    buffer_load_dwordx4 v61, s[12:15], s43 offen offset:1024 lds
    buffer_load_dwordx4 v62, s[12:15], s43 offen offset:2048 lds
    buffer_load_dwordx4 v63, s[12:15], s43 offen offset:3072 lds
    s_mov_b32 s16, s54
    s_and_b32 s17, s55, 0xffff
    s_mov_b32 s18, 524288
    s_mov_b32 s19, 0x20000
    s_mov_b32 s28, s62
    s_and_b32 s29, s63, 0xffff
    s_mov_b32 s30, 1835008
    s_mov_b32 s31, 0x20000
    s_mov_b32 s32, s46
    s_and_b32 s33, s47, 0xffff
    s_mov_b32 s34, 268435456
    s_mov_b32 s35, 0x20000
    s_cmp_eq_u32 s3, 4
    s_cselect_b32 s20, s58, s60
    s_cselect_b32 s21, s59, s61
    s_and_b32 s21, s21, 0xffff
    s_mov_b32 s22, 1835008
    s_mov_b32 s23, 0x20000
    v_mov_b32 v14, 163584
    v_mov_b32 v15, 1
    v_lshrrev_b32 v1, 3, v0
    v_and_b32 v2, 7, v0
    v_bfe_u32 v4, v0, 4, 1
    v_lshlrev_b32 v6, 2, v4
    v_xor_b32 v6, v2, v6
    v_lshlrev_b32 v6, 4, v6
    v_mul_u32_u24 v5, 3072, v1
    v_add_u32 v5, v5, v6
    v_lshl_add_u32 v7, v1, 10, v6
    v_add_u32 v104, 0, v7
    v_add_u32 v105, 7168, v7
    v_add_u32 v106, 14336, v7
    v_add_u32 v107, 21504, v7
    v_lshlrev_b32 v6, 1, v4
    s_lshl_b32 s98, s24, 2
    v_add_u32 v6, s98, v6
    v_xor_b32 v6, v2, v6
    v_mul_u32_u24 v5, 3584, v1
    v_lshl_add_u32 v5, v6, 4, v5
    v_add_u32 v76, 0, v5
    v_add_u32 v77, 27648, v5
    v_add_u32 v78, 55296, v5
    v_add_u32 v79, 82944, v5
    v_lshrrev_b32 v1, 4, v0
    v_and_b32 v2, 15, v0
    v_lshlrev_b32 v3, 2, v1
    v_xor_b32 v2, v2, v3
    v_lshlrev_b32 v2, 4, v2
    v_lshl_add_u32 v2, v1, 10, v2
    v_add_u32 v64, 0, v2
    v_add_u32 v65, 3072, v2
    v_add_u32 v66, 6144, v2
    v_add_u32 v67, 9216, v2
    s_mov_b32 s98, 10923
    v_add_u32 v1, 0, v0
    v_mul_lo_u32 v2, v1, s98
    v_lshrrev_b32 v2, 16, v2
    v_mul_u32_u24 v3, 6, v2
    v_sub_u32 v3, v1, v3
    v_mul_u32_u24 v2, 3584, v2
    v_lshl_add_u32 v2, v3, 4, v2
    v_mov_b32 v68, v2
    v_add_u32 v1, 64, v0
    v_mul_lo_u32 v2, v1, s98
    v_lshrrev_b32 v2, 16, v2
    v_mul_u32_u24 v3, 6, v2
    v_sub_u32 v3, v1, v3
    v_mul_u32_u24 v2, 3584, v2
    v_lshl_add_u32 v2, v3, 4, v2
    v_subrev_u32 v69, 1024, v2
    v_add_u32 v1, 128, v0
    v_mul_lo_u32 v2, v1, s98
    v_lshrrev_b32 v2, 16, v2
    v_mul_u32_u24 v3, 6, v2
    v_sub_u32 v3, v1, v3
    v_mul_u32_u24 v2, 3584, v2
    v_lshl_add_u32 v2, v3, 4, v2
    v_subrev_u32 v70, 2048, v2
    v_add_u32 v1, 192, v0
    v_mul_lo_u32 v2, v1, s98
    v_lshrrev_b32 v2, 16, v2
    v_mul_u32_u24 v3, 6, v2
    v_sub_u32 v3, v1, v3
    v_mul_u32_u24 v2, 3584, v2
    v_lshl_add_u32 v2, v3, 4, v2
    v_subrev_u32 v71, 3072, v2
    v_add_u32 v1, 256, v0
    v_mul_lo_u32 v2, v1, s98
    v_lshrrev_b32 v2, 16, v2
    v_mul_u32_u24 v3, 6, v2
    v_sub_u32 v3, v1, v3
    v_mul_u32_u24 v2, 3584, v2
    v_lshl_add_u32 v2, v3, 4, v2
    v_mov_b32 v72, v2
    v_add_u32 v1, 320, v0
    v_mul_lo_u32 v2, v1, s98
    v_lshrrev_b32 v2, 16, v2
    v_mul_u32_u24 v3, 6, v2
    v_sub_u32 v3, v1, v3
    v_mul_u32_u24 v2, 3584, v2
    v_lshl_add_u32 v2, v3, 4, v2
    v_subrev_u32 v73, 1024, v2
    s_add_u32 s41, s40, 1
    s_and_b32 s41, s41, 7
    s_lshl_b32 s42, s41, 7
    s_add_u32 s42, s42, s26
    s_mul_i32 s43, s41, 196608
    s_add_u32 s43, s43, s27
    s_add_u32 s98, s43, 1024
    s_add_u32 m0, s25, 40960
    s_nop 0
    buffer_load_dwordx4 v52, s[12:15], s98 offen lds
    buffer_load_dwordx4 v53, s[12:15], s98 offen offset:1024 lds
    buffer_load_dwordx4 v54, s[12:15], s98 offen offset:2048 lds
    buffer_load_dwordx4 v55, s[12:15], s98 offen offset:3072 lds
    s_add_u32 s98, s43, 2048
    s_add_u32 m0, s25, 49152
    s_nop 0
    buffer_load_dwordx4 v56, s[12:15], s98 offen lds
    buffer_load_dwordx4 v57, s[12:15], s98 offen offset:1024 lds
    buffer_load_dwordx4 v58, s[12:15], s98 offen offset:2048 lds
    buffer_load_dwordx4 v59, s[12:15], s98 offen offset:3072 lds
    s_add_u32 m0, s25, 32768
    s_nop 0
    buffer_load_dwordx4 v48, s[8:11], s42 offen lds
    buffer_load_dwordx4 v49, s[8:11], s42 offen offset:1024 lds
    buffer_load_dwordx4 v50, s[8:11], s42 offen offset:2048 lds
    buffer_load_dwordx4 v51, s[8:11], s42 offen offset:3072 lds
    s_add_u32 m0, s25, 57344
    s_nop 0
    buffer_load_dwordx4 v60, s[12:15], s43 offen lds
    buffer_load_dwordx4 v61, s[12:15], s43 offen offset:1024 lds
    buffer_load_dwordx4 v62, s[12:15], s43 offen offset:2048 lds
    buffer_load_dwordx4 v63, s[12:15], s43 offen offset:3072 lds
    s_and_b32 s98, s6, 3
    s_lshl_b32 s98, s98, 8
    s_lshl_b32 s52, s24, 14
    s_add_u32 s52, s52, s98
    s_lshl_b32 s60, s7, 1
    s_lshr_b32 s98, s6, 2
    s_add_u32 s60, s60, s98
    s_lshl_b32 s60, s60, 1
    s_waitcnt vmcnt(16)
    s_barrier
    s_add_u32 s41, s40, 2
    s_and_b32 s41, s41, 7
    s_lshl_b32 s42, s41, 7
    s_add_u32 s42, s42, s26
    s_mul_i32 s43, s41, 196608
    s_add_u32 s43, s43, s27
    s_add_u32 s98, s43, 1024
    s_add_u32 m0, s25, 73728
    s_nop 0
    buffer_load_dwordx4 v52, s[12:15], s98 offen lds
    buffer_load_dwordx4 v53, s[12:15], s98 offen offset:1024 lds
    buffer_load_dwordx4 v54, s[12:15], s98 offen offset:2048 lds
    buffer_load_dwordx4 v55, s[12:15], s98 offen offset:3072 lds
    s_add_u32 s98, s43, 2048
    s_add_u32 m0, s25, 81920
    s_nop 0
    buffer_load_dwordx4 v56, s[12:15], s98 offen lds
    buffer_load_dwordx4 v57, s[12:15], s98 offen offset:1024 lds
    buffer_load_dwordx4 v58, s[12:15], s98 offen offset:2048 lds
    buffer_load_dwordx4 v59, s[12:15], s98 offen offset:3072 lds
    s_add_u32 m0, s25, 65536
    s_nop 0
    buffer_load_dwordx4 v48, s[8:11], s42 offen lds
    buffer_load_dwordx4 v49, s[8:11], s42 offen offset:1024 lds
    buffer_load_dwordx4 v50, s[8:11], s42 offen offset:2048 lds
    buffer_load_dwordx4 v51, s[8:11], s42 offen offset:3072 lds
    s_add_u32 m0, s25, 90112
    s_nop 0
    buffer_load_dwordx4 v60, s[12:15], s43 offen lds
    buffer_load_dwordx4 v61, s[12:15], s43 offen offset:1024 lds
    buffer_load_dwordx4 v62, s[12:15], s43 offen offset:2048 lds
    buffer_load_dwordx4 v63, s[12:15], s43 offen offset:3072 lds
    s_waitcnt vmcnt(16)
    s_barrier
    s_add_u32 s41, s40, 3
    s_and_b32 s41, s41, 7
    s_lshl_b32 s42, s41, 7
    s_add_u32 s42, s42, s26
    s_mul_i32 s43, s41, 196608
    s_add_u32 s43, s43, s27
    s_add_u32 s98, s43, 1024
    s_add_u32 m0, s25, 106496
    s_nop 0
    buffer_load_dwordx4 v52, s[12:15], s98 offen lds
    buffer_load_dwordx4 v53, s[12:15], s98 offen offset:1024 lds
    buffer_load_dwordx4 v54, s[12:15], s98 offen offset:2048 lds
    buffer_load_dwordx4 v55, s[12:15], s98 offen offset:3072 lds
    s_add_u32 s98, s43, 2048
    s_add_u32 m0, s25, 114688
    s_nop 0
    buffer_load_dwordx4 v56, s[12:15], s98 offen lds
    buffer_load_dwordx4 v57, s[12:15], s98 offen offset:1024 lds
    buffer_load_dwordx4 v58, s[12:15], s98 offen offset:2048 lds
    buffer_load_dwordx4 v59, s[12:15], s98 offen offset:3072 lds
    s_add_u32 m0, s25, 98304
    s_nop 0
    buffer_load_dwordx4 v48, s[8:11], s42 offen lds
    buffer_load_dwordx4 v49, s[8:11], s42 offen offset:1024 lds
    buffer_load_dwordx4 v50, s[8:11], s42 offen offset:2048 lds
    buffer_load_dwordx4 v51, s[8:11], s42 offen offset:3072 lds
    s_add_u32 m0, s25, 122880
    s_nop 0
    buffer_load_dwordx4 v60, s[12:15], s43 offen lds
    buffer_load_dwordx4 v61, s[12:15], s43 offen offset:1024 lds
    buffer_load_dwordx4 v62, s[12:15], s43 offen offset:2048 lds
    buffer_load_dwordx4 v63, s[12:15], s43 offen offset:3072 lds
    s_add_u32 s41, s40, 4
    s_and_b32 s41, s41, 7
    s_lshl_b32 s42, s41, 7
    s_add_u32 s42, s42, s26
    s_mul_i32 s43, s41, 196608
    s_add_u32 s43, s43, s27
    s_add_u32 s98, s43, 1024
    s_add_u32 m0, s25, 8192
    s_nop 0
    buffer_load_dwordx4 v52, s[12:15], s98 offen lds
    buffer_load_dwordx4 v53, s[12:15], s98 offen offset:1024 lds
    buffer_load_dwordx4 v54, s[12:15], s98 offen offset:2048 lds
    buffer_load_dwordx4 v55, s[12:15], s98 offen offset:3072 lds
    s_add_u32 s98, s43, 2048
    s_add_u32 m0, s25, 16384
    s_nop 0
    buffer_load_dwordx4 v56, s[12:15], s98 offen lds
    buffer_load_dwordx4 v57, s[12:15], s98 offen offset:1024 lds
    buffer_load_dwordx4 v58, s[12:15], s98 offen offset:2048 lds
    buffer_load_dwordx4 v59, s[12:15], s98 offen offset:3072 lds
    s_add_u32 m0, s25, 0
    s_nop 0
    buffer_load_dwordx4 v48, s[8:11], s42 offen lds
    buffer_load_dwordx4 v49, s[8:11], s42 offen offset:1024 lds
    buffer_load_dwordx4 v50, s[8:11], s42 offen offset:2048 lds
    buffer_load_dwordx4 v51, s[8:11], s42 offen offset:3072 lds
    s_add_u32 m0, s25, 24576
    s_nop 0
    buffer_load_dwordx4 v60, s[12:15], s43 offen lds
    buffer_load_dwordx4 v61, s[12:15], s43 offen offset:1024 lds
    buffer_load_dwordx4 v62, s[12:15], s43 offen offset:2048 lds
    buffer_load_dwordx4 v63, s[12:15], s43 offen offset:3072 lds
    s_waitcnt vmcnt(32)
    s_barrier
    s_add_u32 s41, s40, 5
    s_and_b32 s41, s41, 7
    s_lshl_b32 s42, s41, 7
    s_add_u32 s42, s42, s26
    s_mul_i32 s43, s41, 196608
    s_add_u32 s43, s43, s27
    s_add_u32 s98, s43, 1024
    s_add_u32 m0, s25, 40960
    s_nop 0
    buffer_load_dwordx4 v52, s[12:15], s98 offen lds
    buffer_load_dwordx4 v53, s[12:15], s98 offen offset:1024 lds
    buffer_load_dwordx4 v54, s[12:15], s98 offen offset:2048 lds
    buffer_load_dwordx4 v55, s[12:15], s98 offen offset:3072 lds
    s_add_u32 s98, s43, 2048
    s_add_u32 m0, s25, 49152
    s_nop 0
    buffer_load_dwordx4 v56, s[12:15], s98 offen lds
    buffer_load_dwordx4 v57, s[12:15], s98 offen offset:1024 lds
    buffer_load_dwordx4 v58, s[12:15], s98 offen offset:2048 lds
    buffer_load_dwordx4 v59, s[12:15], s98 offen offset:3072 lds
    s_add_u32 m0, s25, 32768
    s_nop 0
    buffer_load_dwordx4 v48, s[8:11], s42 offen lds
    buffer_load_dwordx4 v49, s[8:11], s42 offen offset:1024 lds
    buffer_load_dwordx4 v50, s[8:11], s42 offen offset:2048 lds
    buffer_load_dwordx4 v51, s[8:11], s42 offen offset:3072 lds
    s_add_u32 m0, s25, 57344
    s_nop 0
    buffer_load_dwordx4 v60, s[12:15], s43 offen lds
    buffer_load_dwordx4 v61, s[12:15], s43 offen offset:1024 lds
    buffer_load_dwordx4 v62, s[12:15], s43 offen offset:2048 lds
    buffer_load_dwordx4 v63, s[12:15], s43 offen offset:3072 lds
    s_waitcnt vmcnt(32)
    s_barrier
    s_add_u32 s41, s40, 6
    s_and_b32 s41, s41, 7
    s_lshl_b32 s42, s41, 7
    s_add_u32 s42, s42, s26
    s_mul_i32 s43, s41, 196608
    s_add_u32 s43, s43, s27
    s_add_u32 s98, s43, 1024
    s_add_u32 m0, s25, 73728
    s_nop 0
    buffer_load_dwordx4 v52, s[12:15], s98 offen lds
    buffer_load_dwordx4 v53, s[12:15], s98 offen offset:1024 lds
    buffer_load_dwordx4 v54, s[12:15], s98 offen offset:2048 lds
    buffer_load_dwordx4 v55, s[12:15], s98 offen offset:3072 lds
    s_add_u32 s98, s43, 2048
    s_add_u32 m0, s25, 81920
    s_nop 0
    buffer_load_dwordx4 v56, s[12:15], s98 offen lds
    buffer_load_dwordx4 v57, s[12:15], s98 offen offset:1024 lds
    buffer_load_dwordx4 v58, s[12:15], s98 offen offset:2048 lds
    buffer_load_dwordx4 v59, s[12:15], s98 offen offset:3072 lds
    s_add_u32 m0, s25, 65536
    s_nop 0
    buffer_load_dwordx4 v48, s[8:11], s42 offen lds
    buffer_load_dwordx4 v49, s[8:11], s42 offen offset:1024 lds
    buffer_load_dwordx4 v50, s[8:11], s42 offen offset:2048 lds
    buffer_load_dwordx4 v51, s[8:11], s42 offen offset:3072 lds
    s_add_u32 m0, s25, 90112
    s_nop 0
    buffer_load_dwordx4 v60, s[12:15], s43 offen lds
    buffer_load_dwordx4 v61, s[12:15], s43 offen offset:1024 lds
    buffer_load_dwordx4 v62, s[12:15], s43 offen offset:2048 lds
    buffer_load_dwordx4 v63, s[12:15], s43 offen offset:3072 lds
    s_waitcnt vmcnt(16)
    s_barrier
    s_add_u32 s41, s40, 7
    s_and_b32 s41, s41, 7
    s_lshl_b32 s42, s41, 7
    s_add_u32 s42, s42, s26
    s_mul_i32 s43, s41, 196608
    s_add_u32 s43, s43, s27
    s_add_u32 s98, s43, 1024
    s_add_u32 m0, s25, 106496
    s_nop 0
    buffer_load_dwordx4 v52, s[12:15], s98 offen lds
    buffer_load_dwordx4 v53, s[12:15], s98 offen offset:1024 lds
    buffer_load_dwordx4 v54, s[12:15], s98 offen offset:2048 lds
    buffer_load_dwordx4 v55, s[12:15], s98 offen offset:3072 lds
    s_add_u32 s98, s43, 2048
    s_add_u32 m0, s25, 114688
    s_nop 0
    buffer_load_dwordx4 v56, s[12:15], s98 offen lds
    buffer_load_dwordx4 v57, s[12:15], s98 offen offset:1024 lds
    buffer_load_dwordx4 v58, s[12:15], s98 offen offset:2048 lds
    buffer_load_dwordx4 v59, s[12:15], s98 offen offset:3072 lds
    s_add_u32 m0, s25, 98304
    s_nop 0
    buffer_load_dwordx4 v48, s[8:11], s42 offen lds
    buffer_load_dwordx4 v49, s[8:11], s42 offen offset:1024 lds
    buffer_load_dwordx4 v50, s[8:11], s42 offen offset:2048 lds
    buffer_load_dwordx4 v51, s[8:11], s42 offen offset:3072 lds
    s_add_u32 m0, s25, 122880
    s_nop 0
    buffer_load_dwordx4 v60, s[12:15], s43 offen lds
    buffer_load_dwordx4 v61, s[12:15], s43 offen offset:1024 lds
    buffer_load_dwordx4 v62, s[12:15], s43 offen offset:2048 lds
    buffer_load_dwordx4 v63, s[12:15], s43 offen offset:3072 lds
    s_waitcnt vmcnt(16)
    s_barrier
    s_waitcnt vmcnt(0)
    s_barrier
    s_add_u32 s98, s60, 0
    s_and_b32 s98, s98, 15
    s_lshl_b32 s98, s98, 15
    s_add_u32 s98, s98, s52
    s_add_u32 m0, s25, 131072
    s_nop 0
    buffer_load_dwordx4 v64, s[16:19], s98 offen lds
    buffer_load_dwordx4 v65, s[16:19], s98 offen offset:1024 lds
    buffer_load_dwordx4 v66, s[16:19], s98 offen offset:2048 lds
    buffer_load_dwordx4 v67, s[16:19], s98 offen offset:3072 lds
    s_add_u32 s98, s60, 1
    s_and_b32 s98, s98, 15
    s_lshl_b32 s98, s98, 15
    s_add_u32 s98, s98, s52
    s_add_u32 m0, s25, 139264
    s_nop 0
    buffer_load_dwordx4 v64, s[16:19], s98 offen lds
    buffer_load_dwordx4 v65, s[16:19], s98 offen offset:1024 lds
    buffer_load_dwordx4 v66, s[16:19], s98 offen offset:2048 lds
    buffer_load_dwordx4 v67, s[16:19], s98 offen offset:3072 lds
    s_add_u32 s98, s60, 2
    s_and_b32 s98, s98, 15
    s_lshl_b32 s98, s98, 15
    s_add_u32 s98, s98, s52
    s_add_u32 m0, s25, 147456
    s_nop 0
    buffer_load_dwordx4 v64, s[16:19], s98 offen lds
    buffer_load_dwordx4 v65, s[16:19], s98 offen offset:1024 lds
    buffer_load_dwordx4 v66, s[16:19], s98 offen offset:2048 lds
    buffer_load_dwordx4 v67, s[16:19], s98 offen offset:3072 lds
    s_mov_b64 exec, 1
    ds_add_u32 v14, v15 offset:40
    s_mov_b64 exec, -1
    s_mov_b32 s95, 0
LD_cw_1:
    s_sleep 1
    ds_read_b32 v1, v14 offset:0
    s_add_u32 s95, s95, 1
    s_cmp_gt_u32 s95, 16777216
    s_cbranch_scc1 LD_cb_2
    s_waitcnt lgkmcnt(0)
    v_readfirstlane_b32 s98, v1
    s_nop 1
    s_cmp_lt_u32 s98, 4
    s_nop 0
    s_cbranch_scc1 LD_cw_1
LD_cb_2:
    s_waitcnt lgkmcnt(0)
    s_add_u32 s98, s60, 3
    s_and_b32 s98, s98, 15
    s_lshl_b32 s98, s98, 15
    s_add_u32 s98, s98, s52
    s_waitcnt vmcnt(40)
    s_add_u32 m0, s25, 0
    s_nop 0
    buffer_load_dwordx4 v64, s[16:19], s98 offen lds
    buffer_load_dwordx4 v65, s[16:19], s98 offen offset:1024 lds
    buffer_load_dwordx4 v66, s[16:19], s98 offen offset:2048 lds
    buffer_load_dwordx4 v67, s[16:19], s98 offen offset:3072 lds
    s_add_u32 s98, s60, 4
    s_and_b32 s98, s98, 15
    s_lshl_b32 s98, s98, 15
    s_add_u32 s98, s98, s52
    s_waitcnt vmcnt(40)
    s_add_u32 m0, s25, 8192
    s_nop 0
    buffer_load_dwordx4 v64, s[16:19], s98 offen lds
    buffer_load_dwordx4 v65, s[16:19], s98 offen offset:1024 lds
    buffer_load_dwordx4 v66, s[16:19], s98 offen offset:2048 lds
    buffer_load_dwordx4 v67, s[16:19], s98 offen offset:3072 lds
    s_add_u32 s98, s60, 5
    s_and_b32 s98, s98, 15
    s_lshl_b32 s98, s98, 15
    s_add_u32 s98, s98, s52
    s_waitcnt vmcnt(40)
    s_add_u32 m0, s25, 16384
    s_nop 0
    buffer_load_dwordx4 v64, s[16:19], s98 offen lds
    buffer_load_dwordx4 v65, s[16:19], s98 offen offset:1024 lds
    buffer_load_dwordx4 v66, s[16:19], s98 offen offset:2048 lds
    buffer_load_dwordx4 v67, s[16:19], s98 offen offset:3072 lds
    s_add_u32 s98, s60, 6
    s_and_b32 s98, s98, 15
    s_lshl_b32 s98, s98, 15
    s_add_u32 s98, s98, s52
    s_waitcnt vmcnt(40)
    s_add_u32 m0, s25, 24576
    s_nop 0
    buffer_load_dwordx4 v64, s[16:19], s98 offen lds
    buffer_load_dwordx4 v65, s[16:19], s98 offen offset:1024 lds
    buffer_load_dwordx4 v66, s[16:19], s98 offen offset:2048 lds
    buffer_load_dwordx4 v67, s[16:19], s98 offen offset:3072 lds
    s_add_u32 s98, s60, 7
    s_and_b32 s98, s98, 15
    s_lshl_b32 s98, s98, 15
    s_add_u32 s98, s98, s52
    s_waitcnt vmcnt(40)
    s_add_u32 m0, s25, 32768
    s_nop 0
    buffer_load_dwordx4 v64, s[16:19], s98 offen lds
    buffer_load_dwordx4 v65, s[16:19], s98 offen offset:1024 lds
    buffer_load_dwordx4 v66, s[16:19], s98 offen offset:2048 lds
    buffer_load_dwordx4 v67, s[16:19], s98 offen offset:3072 lds
    s_add_u32 s98, s60, 8
    s_and_b32 s98, s98, 15
    s_lshl_b32 s98, s98, 15
    s_add_u32 s98, s98, s52
    s_waitcnt vmcnt(40)
    s_add_u32 m0, s25, 40960
    s_nop 0
    buffer_load_dwordx4 v64, s[16:19], s98 offen lds
    buffer_load_dwordx4 v65, s[16:19], s98 offen offset:1024 lds
    buffer_load_dwordx4 v66, s[16:19], s98 offen offset:2048 lds
    buffer_load_dwordx4 v67, s[16:19], s98 offen offset:3072 lds
    s_add_u32 s98, s60, 9
    s_and_b32 s98, s98, 15
    s_lshl_b32 s98, s98, 15
    s_add_u32 s98, s98, s52
    s_waitcnt vmcnt(40)
    s_add_u32 m0, s25, 49152
    s_nop 0
    buffer_load_dwordx4 v64, s[16:19], s98 offen lds
    buffer_load_dwordx4 v65, s[16:19], s98 offen offset:1024 lds
    buffer_load_dwordx4 v66, s[16:19], s98 offen offset:2048 lds
    buffer_load_dwordx4 v67, s[16:19], s98 offen offset:3072 lds
    s_add_u32 s98, s60, 10
    s_and_b32 s98, s98, 15
    s_lshl_b32 s98, s98, 15
    s_add_u32 s98, s98, s52
    s_waitcnt vmcnt(40)
    s_add_u32 m0, s25, 57344
    s_nop 0
    buffer_load_dwordx4 v64, s[16:19], s98 offen lds
    buffer_load_dwordx4 v65, s[16:19], s98 offen offset:1024 lds
    buffer_load_dwordx4 v66, s[16:19], s98 offen offset:2048 lds
    buffer_load_dwordx4 v67, s[16:19], s98 offen offset:3072 lds
    s_add_u32 s98, s60, 11
    s_and_b32 s98, s98, 15
    s_lshl_b32 s98, s98, 15
    s_add_u32 s98, s98, s52
    s_waitcnt vmcnt(40)
    s_add_u32 m0, s25, 65536
    s_nop 0
    buffer_load_dwordx4 v64, s[16:19], s98 offen lds
    buffer_load_dwordx4 v65, s[16:19], s98 offen offset:1024 lds
    buffer_load_dwordx4 v66, s[16:19], s98 offen offset:2048 lds
    buffer_load_dwordx4 v67, s[16:19], s98 offen offset:3072 lds
    s_add_u32 s98, s60, 12
    s_and_b32 s98, s98, 15
    s_lshl_b32 s98, s98, 15
    s_add_u32 s98, s98, s52
    s_waitcnt vmcnt(40)
    s_add_u32 m0, s25, 73728
    s_nop 0
    buffer_load_dwordx4 v64, s[16:19], s98 offen lds
    buffer_load_dwordx4 v65, s[16:19], s98 offen offset:1024 lds
    buffer_load_dwordx4 v66, s[16:19], s98 offen offset:2048 lds
    buffer_load_dwordx4 v67, s[16:19], s98 offen offset:3072 lds
    s_add_u32 s98, s60, 13
    s_and_b32 s98, s98, 15
    s_lshl_b32 s98, s98, 15
    s_add_u32 s98, s98, s52
    s_waitcnt vmcnt(40)
    s_add_u32 m0, s25, 81920
    s_nop 0
    buffer_load_dwordx4 v64, s[16:19], s98 offen lds
    buffer_load_dwordx4 v65, s[16:19], s98 offen offset:1024 lds
    buffer_load_dwordx4 v66, s[16:19], s98 offen offset:2048 lds
    buffer_load_dwordx4 v67, s[16:19], s98 offen offset:3072 lds
    s_add_u32 s98, s60, 14
    s_and_b32 s98, s98, 15
    s_lshl_b32 s98, s98, 15
    s_add_u32 s98, s98, s52
    s_waitcnt vmcnt(40)
    s_add_u32 m0, s25, 90112
    s_nop 0
    buffer_load_dwordx4 v64, s[16:19], s98 offen lds
    buffer_load_dwordx4 v65, s[16:19], s98 offen offset:1024 lds
    buffer_load_dwordx4 v66, s[16:19], s98 offen offset:2048 lds
    buffer_load_dwordx4 v67, s[16:19], s98 offen offset:3072 lds
    s_add_u32 s98, s60, 15
    s_and_b32 s98, s98, 15
    s_lshl_b32 s98, s98, 15
    s_add_u32 s98, s98, s52
    s_waitcnt vmcnt(40)
    s_add_u32 m0, s25, 98304
    s_nop 0
    buffer_load_dwordx4 v64, s[16:19], s98 offen lds
    buffer_load_dwordx4 v65, s[16:19], s98 offen offset:1024 lds
    buffer_load_dwordx4 v66, s[16:19], s98 offen offset:2048 lds
    buffer_load_dwordx4 v67, s[16:19], s98 offen offset:3072 lds
    s_waitcnt vmcnt(0)
    s_mov_b64 exec, 1
    ds_add_u32 v14, v15 offset:8
    s_mov_b64 exec, -1
    s_and_b32 s53, s5, 15
    s_lshr_b32 s54, s5, 4
    s_lshl_b32 s54, s54, 2
    s_mul_i32 s55, s53, 96
    s_add_u32 s55, s55, 2048
    s_lshl_b32 s56, s53, 7
    s_mul_i32 s57, s24, 6272
    s_lshl_b32 s58, s24, 13
    s_lshl_b32 s59, s24, 16
    s_lshl_b32 s98, s6, 7
    s_add_u32 s59, s59, s98
    s_add_u32 s98, s7, s6
    s_add_u32 s98, s98, 0
    s_mul_i32 s99, s98, 86
    s_lshr_b32 s99, s99, 8
    s_mul_i32 s99, s99, 3
    s_sub_u32 s98, s98, s99
    s_lshl_b32 s98, s98, 17
    s_add_u32 s44, s98, s59
    s_add_u32 s98, s7, s6
    s_add_u32 s98, s98, 1
    s_mul_i32 s99, s98, 86
    s_lshr_b32 s99, s99, 8
    s_mul_i32 s99, s99, 3
    s_sub_u32 s98, s98, s99
    s_lshl_b32 s98, s98, 17
    s_add_u32 s45, s98, s59
    s_add_u32 s98, s7, s6
    s_add_u32 s98, s98, 2
    s_mul_i32 s99, s98, 86
    s_lshr_b32 s99, s99, 8
    s_mul_i32 s99, s99, 3
    s_sub_u32 s98, s98, s99
    s_lshl_b32 s98, s98, 17
    s_add_u32 s46, s98, s59
    s_add_u32 s98, s7, s6
    s_add_u32 s98, s98, 0
    s_and_b32 s98, s98, 3
    s_lshl_b32 s98, s98, 17
    s_add_u32 s47, s98, s59
    s_add_u32 s98, s7, s6
    s_add_u32 s98, s98, 1
    s_and_b32 s98, s98, 3
    s_lshl_b32 s98, s98, 17
    s_add_u32 s48, s98, s59
    s_add_u32 s98, s7, s6
    s_add_u32 s98, s98, 2
    s_and_b32 s98, s98, 3
    s_lshl_b32 s98, s98, 17
    s_add_u32 s49, s98, s59
    s_add_u32 s98, s7, s6
    s_add_u32 s98, s98, 3
    s_and_b32 s98, s98, 3
    s_lshl_b32 s98, s98, 17
    s_add_u32 s50, s98, s59
    s_mov_b32 s95, 0
LD_cw_3:
    s_sleep 1
    ds_read_b32 v1, v14 offset:12
    s_add_u32 s95, s95, 1
    s_cmp_gt_u32 s95, 16777216
    s_cbranch_scc1 LD_cb_4
    s_waitcnt lgkmcnt(0)
    v_readfirstlane_b32 s98, v1
    s_nop 1
    s_cmp_lt_u32 s98, 4
    s_nop 0
    s_cbranch_scc1 LD_cw_3
LD_cb_4:
    s_waitcnt lgkmcnt(0)
    s_mov_b32 s95, 0
LD_cw_5:
    s_sleep 1
    ds_read_b32 v1, v14 offset:36
    s_add_u32 s95, s95, 1
    s_cmp_gt_u32 s95, 16777216
    s_cbranch_scc1 LD_cb_6
    s_waitcnt lgkmcnt(0)
    v_readfirstlane_b32 s98, v1
    s_nop 1
    s_cmp_lt_u32 s98, 4
    s_nop 0
    s_cbranch_scc1 LD_cw_5
LD_cb_6:
    s_waitcnt lgkmcnt(0)
    s_add_u32 s41, s54, 0
    s_and_b32 s41, s41, 7
    s_mul_i32 s41, s41, 229376
    s_add_u32 s41, s41, s55
    s_waitcnt vmcnt(2)
    s_add_u32 m0, s57, 0
    s_nop 0
    buffer_load_dwordx4 v68, s[20:23], s41 offen lds
    buffer_load_dwordx4 v69, s[20:23], s41 offen offset:1024 lds
    buffer_load_dwordx4 v70, s[20:23], s41 offen offset:2048 lds
    buffer_load_dwordx4 v71, s[20:23], s41 offen offset:3072 lds
    s_waitcnt vmcnt(2)
    s_add_u32 m0, s57, 4096
    s_nop 0
    buffer_load_dwordx4 v72, s[20:23], s41 offen lds
    buffer_load_dwordx4 v73, s[20:23], s41 offen offset:1024 lds
    s_add_u32 s41, s54, 1
    s_and_b32 s41, s41, 7
    s_mul_i32 s41, s41, 229376
    s_add_u32 s41, s41, s55
    s_waitcnt vmcnt(2)
    s_add_u32 m0, s57, 12416
    s_nop 0
    buffer_load_dwordx4 v68, s[20:23], s41 offen lds
    buffer_load_dwordx4 v69, s[20:23], s41 offen offset:1024 lds
    buffer_load_dwordx4 v70, s[20:23], s41 offen offset:2048 lds
    buffer_load_dwordx4 v71, s[20:23], s41 offen offset:3072 lds
    s_waitcnt vmcnt(2)
    s_add_u32 m0, s57, 16512
    s_nop 0
    buffer_load_dwordx4 v72, s[20:23], s41 offen lds
    buffer_load_dwordx4 v73, s[20:23], s41 offen offset:1024 lds
    s_add_u32 s41, s54, 2
    s_and_b32 s41, s41, 7
    s_mul_i32 s41, s41, 229376
    s_add_u32 s41, s41, s55
    s_waitcnt vmcnt(2)
    s_add_u32 m0, s57, 24832
    s_nop 0
    buffer_load_dwordx4 v68, s[20:23], s41 offen lds
    buffer_load_dwordx4 v69, s[20:23], s41 offen offset:1024 lds
    buffer_load_dwordx4 v70, s[20:23], s41 offen offset:2048 lds
    buffer_load_dwordx4 v71, s[20:23], s41 offen offset:3072 lds
    s_waitcnt vmcnt(2)
    s_add_u32 m0, s57, 28928
    s_nop 0
    buffer_load_dwordx4 v72, s[20:23], s41 offen lds
    buffer_load_dwordx4 v73, s[20:23], s41 offen offset:1024 lds
    s_add_u32 s41, s54, 3
    s_and_b32 s41, s41, 7
    s_mul_i32 s41, s41, 229376
    s_add_u32 s41, s41, s55
    s_waitcnt vmcnt(2)
    s_add_u32 m0, s57, 37248
    s_nop 0
    buffer_load_dwordx4 v68, s[20:23], s41 offen lds
    buffer_load_dwordx4 v69, s[20:23], s41 offen offset:1024 lds
    buffer_load_dwordx4 v70, s[20:23], s41 offen offset:2048 lds
    buffer_load_dwordx4 v71, s[20:23], s41 offen offset:3072 lds
    s_waitcnt vmcnt(2)
    s_add_u32 m0, s57, 41344
    s_nop 0
    buffer_load_dwordx4 v72, s[20:23], s41 offen lds
    buffer_load_dwordx4 v73, s[20:23], s41 offen offset:1024 lds
    s_add_u32 s41, s54, 4
    s_and_b32 s41, s41, 7
    s_mul_i32 s41, s41, 229376
    s_add_u32 s41, s41, s55
    s_waitcnt vmcnt(2)
    s_add_u32 m0, s57, 49664
    s_nop 0
    buffer_load_dwordx4 v68, s[20:23], s41 offen lds
    buffer_load_dwordx4 v69, s[20:23], s41 offen offset:1024 lds
    buffer_load_dwordx4 v70, s[20:23], s41 offen offset:2048 lds
    buffer_load_dwordx4 v71, s[20:23], s41 offen offset:3072 lds
    s_waitcnt vmcnt(2)
    s_add_u32 m0, s57, 53760
    s_nop 0
    buffer_load_dwordx4 v72, s[20:23], s41 offen lds
    buffer_load_dwordx4 v73, s[20:23], s41 offen offset:1024 lds
    s_add_u32 s41, s54, 5
    s_and_b32 s41, s41, 7
    s_mul_i32 s41, s41, 229376
    s_add_u32 s41, s41, s55
    s_waitcnt vmcnt(2)
    s_add_u32 m0, s57, 62080
    s_nop 0
    buffer_load_dwordx4 v68, s[20:23], s41 offen lds
    buffer_load_dwordx4 v69, s[20:23], s41 offen offset:1024 lds
    buffer_load_dwordx4 v70, s[20:23], s41 offen offset:2048 lds
    buffer_load_dwordx4 v71, s[20:23], s41 offen offset:3072 lds
    s_waitcnt vmcnt(2)
    s_add_u32 m0, s57, 66176
    s_nop 0
    buffer_load_dwordx4 v72, s[20:23], s41 offen lds
    buffer_load_dwordx4 v73, s[20:23], s41 offen offset:1024 lds
    s_add_u32 s41, s54, 6
    s_and_b32 s41, s41, 7
    s_mul_i32 s41, s41, 229376
    s_add_u32 s41, s41, s55
    s_waitcnt vmcnt(2)
    s_add_u32 m0, s57, 74496
    s_nop 0
    buffer_load_dwordx4 v68, s[20:23], s41 offen lds
    buffer_load_dwordx4 v69, s[20:23], s41 offen offset:1024 lds
    buffer_load_dwordx4 v70, s[20:23], s41 offen offset:2048 lds
    buffer_load_dwordx4 v71, s[20:23], s41 offen offset:3072 lds
    s_waitcnt vmcnt(2)
    s_add_u32 m0, s57, 78592
    s_nop 0
    buffer_load_dwordx4 v72, s[20:23], s41 offen lds
    buffer_load_dwordx4 v73, s[20:23], s41 offen offset:1024 lds
    s_add_u32 s41, s54, 7
    s_and_b32 s41, s41, 7
    s_mul_i32 s41, s41, 229376
    s_add_u32 s41, s41, s55
    s_waitcnt vmcnt(2)
    s_add_u32 m0, s57, 86912
    s_nop 0
    buffer_load_dwordx4 v68, s[20:23], s41 offen lds
    buffer_load_dwordx4 v69, s[20:23], s41 offen offset:1024 lds
    buffer_load_dwordx4 v70, s[20:23], s41 offen offset:2048 lds
    buffer_load_dwordx4 v71, s[20:23], s41 offen offset:3072 lds
    s_waitcnt vmcnt(2)
    s_add_u32 m0, s57, 91008
    s_nop 0
    buffer_load_dwordx4 v72, s[20:23], s41 offen lds
    buffer_load_dwordx4 v73, s[20:23], s41 offen offset:1024 lds
    s_add_u32 s41, s54, 0
    s_and_b32 s41, s41, 7
    s_mul_i32 s41, s41, 229376
    s_add_u32 s41, s41, s56
    s_waitcnt vmcnt(2)
    s_add_u32 m0, s58, 132096
    s_nop 0
    buffer_load_dwordx4 v76, s[20:23], s41 offen lds
    buffer_load_dwordx4 v77, s[20:23], s41 offen offset:1024 lds
    buffer_load_dwordx4 v78, s[20:23], s41 offen offset:2048 lds
    buffer_load_dwordx4 v79, s[20:23], s41 offen offset:3072 lds
    s_add_u32 s41, s41, 114688
    s_waitcnt vmcnt(2)
    s_add_u32 m0, s58, 136192
    s_nop 0
    buffer_load_dwordx4 v76, s[20:23], s41 offen lds
    buffer_load_dwordx4 v77, s[20:23], s41 offen offset:1024 lds
    buffer_load_dwordx4 v78, s[20:23], s41 offen offset:2048 lds
    buffer_load_dwordx4 v79, s[20:23], s41 offen offset:3072 lds
    s_waitcnt vmcnt(0)
    s_barrier
    s_barrier
    s_barrier
    s_add_u32 s41, s54, 1
    s_and_b32 s41, s41, 7
    s_mul_i32 s41, s41, 229376
    s_add_u32 s41, s41, s56
    s_add_u32 m0, s58, 99328
    s_nop 0
    buffer_load_dwordx4 v76, s[20:23], s41 offen lds
    buffer_load_dwordx4 v77, s[20:23], s41 offen offset:1024 lds
    buffer_load_dwordx4 v78, s[20:23], s41 offen offset:2048 lds
    buffer_load_dwordx4 v79, s[20:23], s41 offen offset:3072 lds
    s_barrier
    s_add_u32 s41, s54, 1
    s_and_b32 s41, s41, 7
    s_mul_i32 s41, s41, 229376
    s_add_u32 s41, s41, s56
    s_add_u32 s41, s41, 114688
    s_add_u32 m0, s58, 103424
    s_nop 0
    buffer_load_dwordx4 v76, s[20:23], s41 offen lds
    buffer_load_dwordx4 v77, s[20:23], s41 offen offset:1024 lds
    buffer_load_dwordx4 v78, s[20:23], s41 offen offset:2048 lds
    buffer_load_dwordx4 v79, s[20:23], s41 offen offset:3072 lds
    s_barrier
    s_add_u32 s41, s54, 2
    s_and_b32 s41, s41, 7
    s_mul_i32 s41, s41, 229376
    s_add_u32 s41, s41, s56
    s_add_u32 m0, s58, 115712
    s_nop 0
    buffer_load_dwordx4 v76, s[20:23], s41 offen lds
    buffer_load_dwordx4 v77, s[20:23], s41 offen offset:1024 lds
    buffer_load_dwordx4 v78, s[20:23], s41 offen offset:2048 lds
    buffer_load_dwordx4 v79, s[20:23], s41 offen offset:3072 lds
    s_barrier
    s_add_u32 s41, s54, 2
    s_and_b32 s41, s41, 7
    s_mul_i32 s41, s41, 229376
    s_add_u32 s41, s41, s56
    s_add_u32 s41, s41, 114688
    s_add_u32 m0, s58, 119808
    s_nop 0
    buffer_load_dwordx4 v76, s[20:23], s41 offen lds
    buffer_load_dwordx4 v77, s[20:23], s41 offen offset:1024 lds
    buffer_load_dwordx4 v78, s[20:23], s41 offen offset:2048 lds
    buffer_load_dwordx4 v79, s[20:23], s41 offen offset:3072 lds
    s_barrier
    s_add_u32 s41, s54, 3
    s_and_b32 s41, s41, 7
    s_mul_i32 s41, s41, 229376
    s_add_u32 s41, s41, s56
    s_add_u32 m0, s58, 0
    s_nop 0
    buffer_load_dwordx4 v76, s[20:23], s41 offen lds
    buffer_load_dwordx4 v77, s[20:23], s41 offen offset:1024 lds
    buffer_load_dwordx4 v78, s[20:23], s41 offen offset:2048 lds
    buffer_load_dwordx4 v79, s[20:23], s41 offen offset:3072 lds
    s_barrier
    s_add_u32 s41, s54, 3
    s_and_b32 s41, s41, 7
    s_mul_i32 s41, s41, 229376
    s_add_u32 s41, s41, s56
    s_add_u32 s41, s41, 114688
    s_add_u32 m0, s58, 4096
    s_nop 0
    buffer_load_dwordx4 v76, s[20:23], s41 offen lds
    buffer_load_dwordx4 v77, s[20:23], s41 offen offset:1024 lds
    buffer_load_dwordx4 v78, s[20:23], s41 offen offset:2048 lds
    buffer_load_dwordx4 v79, s[20:23], s41 offen offset:3072 lds
    s_add_u32 s41, s54, 4
    s_and_b32 s41, s41, 7
    s_mul_i32 s41, s41, 229376
    s_add_u32 s41, s41, s56
    s_add_u32 m0, s58, 16384
    s_nop 0
    buffer_load_dwordx4 v76, s[20:23], s41 offen lds
    buffer_load_dwordx4 v77, s[20:23], s41 offen offset:1024 lds
    buffer_load_dwordx4 v78, s[20:23], s41 offen offset:2048 lds
    buffer_load_dwordx4 v79, s[20:23], s41 offen offset:3072 lds
    s_waitcnt vmcnt(20)
    s_barrier
    s_add_u32 s41, s54, 4
    s_and_b32 s41, s41, 7
    s_mul_i32 s41, s41, 229376
    s_add_u32 s41, s41, s56
    s_add_u32 s41, s41, 114688
    s_add_u32 m0, s58, 20480
    s_nop 0
    buffer_load_dwordx4 v76, s[20:23], s41 offen lds
    buffer_load_dwordx4 v77, s[20:23], s41 offen offset:1024 lds
    buffer_load_dwordx4 v78, s[20:23], s41 offen offset:2048 lds
    buffer_load_dwordx4 v79, s[20:23], s41 offen offset:3072 lds
    s_add_u32 s41, s54, 5
    s_and_b32 s41, s41, 7
    s_mul_i32 s41, s41, 229376
    s_add_u32 s41, s41, s56
    s_add_u32 m0, s58, 32768
    s_nop 0
    buffer_load_dwordx4 v76, s[20:23], s41 offen lds
    buffer_load_dwordx4 v77, s[20:23], s41 offen offset:1024 lds
    buffer_load_dwordx4 v78, s[20:23], s41 offen offset:2048 lds
    buffer_load_dwordx4 v79, s[20:23], s41 offen offset:3072 lds
    s_add_u32 s41, s54, 5
    s_and_b32 s41, s41, 7
    s_mul_i32 s41, s41, 229376
    s_add_u32 s41, s41, s56
    s_add_u32 s41, s41, 114688
    s_add_u32 m0, s58, 36864
    s_nop 0
    buffer_load_dwordx4 v76, s[20:23], s41 offen lds
    buffer_load_dwordx4 v77, s[20:23], s41 offen offset:1024 lds
    buffer_load_dwordx4 v78, s[20:23], s41 offen offset:2048 lds
    buffer_load_dwordx4 v79, s[20:23], s41 offen offset:3072 lds
    s_waitcnt vmcnt(24)
    s_barrier
    s_add_u32 s41, s54, 6
    s_and_b32 s41, s41, 7
    s_mul_i32 s41, s41, 229376
    s_add_u32 s41, s41, s56
    s_add_u32 m0, s58, 49152
    s_nop 0
    buffer_load_dwordx4 v76, s[20:23], s41 offen lds
    buffer_load_dwordx4 v77, s[20:23], s41 offen offset:1024 lds
    buffer_load_dwordx4 v78, s[20:23], s41 offen offset:2048 lds
    buffer_load_dwordx4 v79, s[20:23], s41 offen offset:3072 lds
    s_add_u32 s41, s54, 6
    s_and_b32 s41, s41, 7
    s_mul_i32 s41, s41, 229376
    s_add_u32 s41, s41, s56
    s_add_u32 s41, s41, 114688
    s_add_u32 m0, s58, 53248
    s_nop 0
    buffer_load_dwordx4 v76, s[20:23], s41 offen lds
    buffer_load_dwordx4 v77, s[20:23], s41 offen offset:1024 lds
    buffer_load_dwordx4 v78, s[20:23], s41 offen offset:2048 lds
    buffer_load_dwordx4 v79, s[20:23], s41 offen offset:3072 lds
    s_add_u32 s41, s54, 7
    s_and_b32 s41, s41, 7
    s_mul_i32 s41, s41, 229376
    s_add_u32 s41, s41, s56
    s_add_u32 m0, s58, 65536
    s_nop 0
    buffer_load_dwordx4 v76, s[20:23], s41 offen lds
    buffer_load_dwordx4 v77, s[20:23], s41 offen offset:1024 lds
    buffer_load_dwordx4 v78, s[20:23], s41 offen offset:2048 lds
    buffer_load_dwordx4 v79, s[20:23], s41 offen offset:3072 lds
    s_add_u32 s41, s54, 7
    s_and_b32 s41, s41, 7
    s_mul_i32 s41, s41, 229376
    s_add_u32 s41, s41, s56
    s_add_u32 s41, s41, 114688
    s_add_u32 m0, s58, 69632
    s_nop 0
    buffer_load_dwordx4 v76, s[20:23], s41 offen lds
    buffer_load_dwordx4 v77, s[20:23], s41 offen offset:1024 lds
    buffer_load_dwordx4 v78, s[20:23], s41 offen offset:2048 lds
    buffer_load_dwordx4 v79, s[20:23], s41 offen offset:3072 lds
    s_waitcnt vmcnt(32)
    s_barrier
    s_add_u32 s98, s44, 1048576
    s_add_u32 m0, s58, 81920
    s_nop 0
    buffer_load_dwordx4 v104, s[28:31], s98 offen lds
    buffer_load_dwordx4 v105, s[28:31], s98 offen offset:1024 lds
    buffer_load_dwordx4 v106, s[28:31], s98 offen offset:2048 lds
    buffer_load_dwordx4 v107, s[28:31], s98 offen offset:3072 lds
    s_add_u32 s98, s44, 1081344
    s_add_u32 m0, s58, 86016
    s_nop 0
    buffer_load_dwordx4 v104, s[28:31], s98 offen lds
    buffer_load_dwordx4 v105, s[28:31], s98 offen offset:1024 lds
    buffer_load_dwordx4 v106, s[28:31], s98 offen offset:2048 lds
    buffer_load_dwordx4 v107, s[28:31], s98 offen offset:3072 lds
    s_add_u32 s98, s44, 1441792
    s_add_u32 m0, s58, 132096
    s_nop 0
    buffer_load_dwordx4 v104, s[28:31], s98 offen lds
    buffer_load_dwordx4 v105, s[28:31], s98 offen offset:1024 lds
    buffer_load_dwordx4 v106, s[28:31], s98 offen offset:2048 lds
    buffer_load_dwordx4 v107, s[28:31], s98 offen offset:3072 lds
    s_add_u32 s98, s44, 1474560
    s_add_u32 m0, s58, 136192
    s_nop 0
    buffer_load_dwordx4 v104, s[28:31], s98 offen lds
    buffer_load_dwordx4 v105, s[28:31], s98 offen offset:1024 lds
    buffer_load_dwordx4 v106, s[28:31], s98 offen offset:2048 lds
    buffer_load_dwordx4 v107, s[28:31], s98 offen offset:3072 lds
    s_waitcnt vmcnt(40)
    s_barrier
    s_add_u32 s98, s45, 1048576
    s_add_u32 m0, s58, 99328
    s_nop 0
    buffer_load_dwordx4 v104, s[28:31], s98 offen lds
    buffer_load_dwordx4 v105, s[28:31], s98 offen offset:1024 lds
    buffer_load_dwordx4 v106, s[28:31], s98 offen offset:2048 lds
    buffer_load_dwordx4 v107, s[28:31], s98 offen offset:3072 lds
    s_add_u32 s98, s45, 1081344
    s_add_u32 m0, s58, 103424
    s_nop 0
    buffer_load_dwordx4 v104, s[28:31], s98 offen lds
    buffer_load_dwordx4 v105, s[28:31], s98 offen offset:1024 lds
    buffer_load_dwordx4 v106, s[28:31], s98 offen offset:2048 lds
    buffer_load_dwordx4 v107, s[28:31], s98 offen offset:3072 lds
    s_add_u32 s98, s45, 1441792
    s_add_u32 m0, s58, 115712
    s_nop 0
    buffer_load_dwordx4 v104, s[28:31], s98 offen lds
    buffer_load_dwordx4 v105, s[28:31], s98 offen offset:1024 lds
    buffer_load_dwordx4 v106, s[28:31], s98 offen offset:2048 lds
    buffer_load_dwordx4 v107, s[28:31], s98 offen offset:3072 lds
    s_add_u32 s98, s45, 1474560
    s_add_u32 m0, s58, 119808
    s_nop 0
    buffer_load_dwordx4 v104, s[28:31], s98 offen lds
    buffer_load_dwordx4 v105, s[28:31], s98 offen offset:1024 lds
    buffer_load_dwordx4 v106, s[28:31], s98 offen offset:2048 lds
    buffer_load_dwordx4 v107, s[28:31], s98 offen offset:3072 lds
    s_waitcnt vmcnt(48)
    s_barrier
    s_add_u32 s98, s46, 1048576
    s_add_u32 m0, s58, 0
    s_nop 0
    buffer_load_dwordx4 v104, s[28:31], s98 offen lds
    buffer_load_dwordx4 v105, s[28:31], s98 offen offset:1024 lds
    buffer_load_dwordx4 v106, s[28:31], s98 offen offset:2048 lds
    buffer_load_dwordx4 v107, s[28:31], s98 offen offset:3072 lds
    s_add_u32 s98, s46, 1081344
    s_add_u32 m0, s58, 4096
    s_nop 0
    buffer_load_dwordx4 v104, s[28:31], s98 offen lds
    buffer_load_dwordx4 v105, s[28:31], s98 offen offset:1024 lds
    buffer_load_dwordx4 v106, s[28:31], s98 offen offset:2048 lds
    buffer_load_dwordx4 v107, s[28:31], s98 offen offset:3072 lds
    s_waitcnt vmcnt(48)
    s_barrier
    s_add_u32 s98, s46, 1441792
    s_add_u32 m0, s58, 16384
    s_nop 0
    buffer_load_dwordx4 v104, s[28:31], s98 offen lds
    buffer_load_dwordx4 v105, s[28:31], s98 offen offset:1024 lds
    buffer_load_dwordx4 v106, s[28:31], s98 offen offset:2048 lds
    buffer_load_dwordx4 v107, s[28:31], s98 offen offset:3072 lds
    s_add_u32 s98, s46, 1474560
    s_add_u32 m0, s58, 20480
    s_nop 0
    buffer_load_dwordx4 v104, s[28:31], s98 offen lds
    buffer_load_dwordx4 v105, s[28:31], s98 offen offset:1024 lds
    buffer_load_dwordx4 v106, s[28:31], s98 offen offset:2048 lds
    buffer_load_dwordx4 v107, s[28:31], s98 offen offset:3072 lds
    s_waitcnt vmcnt(48)
    s_barrier
    s_add_u32 s98, s47, 0
    s_add_u32 m0, s58, 32768
    s_nop 0
    buffer_load_dwordx4 v104, s[28:31], s98 offen lds
    buffer_load_dwordx4 v105, s[28:31], s98 offen offset:1024 lds
    buffer_load_dwordx4 v106, s[28:31], s98 offen offset:2048 lds
    buffer_load_dwordx4 v107, s[28:31], s98 offen offset:3072 lds
    s_add_u32 s98, s47, 32768
    s_add_u32 m0, s58, 36864
    s_nop 0
    buffer_load_dwordx4 v104, s[28:31], s98 offen lds
    buffer_load_dwordx4 v105, s[28:31], s98 offen offset:1024 lds
    buffer_load_dwordx4 v106, s[28:31], s98 offen offset:2048 lds
    buffer_load_dwordx4 v107, s[28:31], s98 offen offset:3072 lds
    s_barrier
    s_add_u32 s98, s47, 524288
    s_add_u32 m0, s58, 49152
    s_nop 0
    buffer_load_dwordx4 v104, s[28:31], s98 offen lds
    buffer_load_dwordx4 v105, s[28:31], s98 offen offset:1024 lds
    buffer_load_dwordx4 v106, s[28:31], s98 offen offset:2048 lds
    buffer_load_dwordx4 v107, s[28:31], s98 offen offset:3072 lds
    s_add_u32 s98, s47, 557056
    s_add_u32 m0, s58, 53248
    s_nop 0
    buffer_load_dwordx4 v104, s[28:31], s98 offen lds
    buffer_load_dwordx4 v105, s[28:31], s98 offen offset:1024 lds
    buffer_load_dwordx4 v106, s[28:31], s98 offen offset:2048 lds
    buffer_load_dwordx4 v107, s[28:31], s98 offen offset:3072 lds
    s_waitcnt vmcnt(56)
    s_waitcnt vmcnt(48)
    s_waitcnt vmcnt(40)
    s_waitcnt vmcnt(32)
    s_barrier
    s_add_u32 s98, s48, 0
    s_add_u32 m0, s58, 65536
    s_nop 0
    buffer_load_dwordx4 v104, s[28:31], s98 offen lds
    buffer_load_dwordx4 v105, s[28:31], s98 offen offset:1024 lds
    buffer_load_dwordx4 v106, s[28:31], s98 offen offset:2048 lds
    buffer_load_dwordx4 v107, s[28:31], s98 offen offset:3072 lds
    s_add_u32 s98, s48, 32768
    s_add_u32 m0, s58, 69632
    s_nop 0
    buffer_load_dwordx4 v104, s[28:31], s98 offen lds
    buffer_load_dwordx4 v105, s[28:31], s98 offen offset:1024 lds
    buffer_load_dwordx4 v106, s[28:31], s98 offen offset:2048 lds
    buffer_load_dwordx4 v107, s[28:31], s98 offen offset:3072 lds
    s_waitcnt vmcnt(32)
    s_waitcnt vmcnt(24)
    s_barrier
    s_add_u32 s98, s48, 524288
    s_add_u32 m0, s58, 81920
    s_nop 0
    buffer_load_dwordx4 v104, s[28:31], s98 offen lds
    buffer_load_dwordx4 v105, s[28:31], s98 offen offset:1024 lds
    buffer_load_dwordx4 v106, s[28:31], s98 offen offset:2048 lds
    buffer_load_dwordx4 v107, s[28:31], s98 offen offset:3072 lds
    s_add_u32 s98, s48, 557056
    s_add_u32 m0, s58, 86016
    s_nop 0
    buffer_load_dwordx4 v104, s[28:31], s98 offen lds
    buffer_load_dwordx4 v105, s[28:31], s98 offen offset:1024 lds
    buffer_load_dwordx4 v106, s[28:31], s98 offen offset:2048 lds
    buffer_load_dwordx4 v107, s[28:31], s98 offen offset:3072 lds
    s_add_u32 s98, s49, 0
    s_add_u32 m0, s58, 132096
    s_nop 0
    buffer_load_dwordx4 v104, s[28:31], s98 offen lds
    buffer_load_dwordx4 v105, s[28:31], s98 offen offset:1024 lds
    buffer_load_dwordx4 v106, s[28:31], s98 offen offset:2048 lds
    buffer_load_dwordx4 v107, s[28:31], s98 offen offset:3072 lds
    s_add_u32 s98, s49, 32768
    s_add_u32 m0, s58, 136192
    s_nop 0
    buffer_load_dwordx4 v104, s[28:31], s98 offen lds
    buffer_load_dwordx4 v105, s[28:31], s98 offen offset:1024 lds
    buffer_load_dwordx4 v106, s[28:31], s98 offen offset:2048 lds
    buffer_load_dwordx4 v107, s[28:31], s98 offen offset:3072 lds
    s_waitcnt vmcnt(32)
    s_waitcnt vmcnt(24)
    s_barrier
    s_add_u32 s98, s49, 524288
    s_add_u32 m0, s58, 99328
    s_nop 0
    buffer_load_dwordx4 v104, s[28:31], s98 offen lds
    buffer_load_dwordx4 v105, s[28:31], s98 offen offset:1024 lds
    buffer_load_dwordx4 v106, s[28:31], s98 offen offset:2048 lds
    buffer_load_dwordx4 v107, s[28:31], s98 offen offset:3072 lds
    s_add_u32 s98, s49, 557056
    s_add_u32 m0, s58, 103424
    s_nop 0
    buffer_load_dwordx4 v104, s[28:31], s98 offen lds
    buffer_load_dwordx4 v105, s[28:31], s98 offen offset:1024 lds
    buffer_load_dwordx4 v106, s[28:31], s98 offen offset:2048 lds
    buffer_load_dwordx4 v107, s[28:31], s98 offen offset:3072 lds
    s_add_u32 s98, s50, 0
    s_add_u32 m0, s58, 115712
    s_nop 0
    buffer_load_dwordx4 v104, s[28:31], s98 offen lds
    buffer_load_dwordx4 v105, s[28:31], s98 offen offset:1024 lds
    buffer_load_dwordx4 v106, s[28:31], s98 offen offset:2048 lds
    buffer_load_dwordx4 v107, s[28:31], s98 offen offset:3072 lds
    s_add_u32 s98, s50, 32768
    s_add_u32 m0, s58, 119808
    s_nop 0
    buffer_load_dwordx4 v104, s[28:31], s98 offen lds
    buffer_load_dwordx4 v105, s[28:31], s98 offen offset:1024 lds
    buffer_load_dwordx4 v106, s[28:31], s98 offen offset:2048 lds
    buffer_load_dwordx4 v107, s[28:31], s98 offen offset:3072 lds
    s_waitcnt vmcnt(32)
    s_waitcnt vmcnt(24)
    s_barrier
    s_add_u32 s98, s50, 524288
    s_add_u32 m0, s58, 0
    s_nop 0
    buffer_load_dwordx4 v104, s[28:31], s98 offen lds
    buffer_load_dwordx4 v105, s[28:31], s98 offen offset:1024 lds
    buffer_load_dwordx4 v106, s[28:31], s98 offen offset:2048 lds
    buffer_load_dwordx4 v107, s[28:31], s98 offen offset:3072 lds
    s_add_u32 s98, s50, 557056
    s_add_u32 m0, s58, 4096
    s_nop 0
    buffer_load_dwordx4 v104, s[28:31], s98 offen lds
    buffer_load_dwordx4 v105, s[28:31], s98 offen offset:1024 lds
    buffer_load_dwordx4 v106, s[28:31], s98 offen offset:2048 lds
    buffer_load_dwordx4 v107, s[28:31], s98 offen offset:3072 lds
    s_waitcnt vmcnt(24)
    s_waitcnt vmcnt(16)
    s_barrier
    s_waitcnt vmcnt(8)
    s_waitcnt vmcnt(0)
    s_barrier
    s_endpgm
.p2align 6
AX_ENTRY:
    v_mov_b32 v4, 0
    v_mov_b32 v5, 0
    v_mov_b32 v6, 0
    v_mov_b32 v7, 0
    v_lshlrev_b32 v48, 4, v0
    v_lshlrev_b32 v2, 2, v0
    v_add_u32 v2, 163584, v2
    ds_write_b32 v2, v4
    v_lshlrev_b32 v49, 7, v0
    s_waitcnt lgkmcnt(0)
    s_mov_b32 s40, s52
    s_and_b32 s41, s53, 0xffff
    s_mov_b32 s42, 16384
    s_mov_b32 s43, 0x20000
    s_lshl_b32 s98, s6, 11
    s_mov_b32 m0, 157696
    s_nop 0
    buffer_load_dwordx4 v48, s[40:43], s98 offen lds
    buffer_load_dwordx4 v48, s[40:43], s98 offen offset:1024 lds
    s_mov_b32 s32, s46
    s_and_b32 s33, s47, 0xffff
    s_mov_b32 s34, 268435456
    s_mov_b32 s35, 0x20000
    s_mov_b32 s12, s50
    s_and_b32 s13, s51, 0xffff
    s_mov_b32 s14, 1572864
    s_mov_b32 s15, 0x20000
    s_mov_b32 s16, s54
    s_and_b32 s17, s55, 0xffff
    s_mov_b32 s18, 524288
    s_mov_b32 s19, 0x20000
    s_mov_b32 s20, s58
    s_and_b32 s21, s59, 0xffff
    s_mov_b32 s22, 1835008
    s_mov_b32 s23, 0x20000
    s_mov_b32 s24, s60
    s_and_b32 s25, s61, 0xffff
    s_mov_b32 s26, 1835008
    s_mov_b32 s27, 0x20000
    s_mov_b32 s28, s62
    s_and_b32 s29, s63, 0xffff
    s_mov_b32 s30, 1835008
    s_mov_b32 s31, 0x20000
    v_mov_b32 v14, 163584
    v_mov_b32 v15, 1
    s_lshl_b32 s44, s4, 2
    s_add_u32 s44, s44, s7
    s_lshr_b32 s45, s6, 2
    s_lshl_b32 s99, s44, 1
    s_add_u32 s45, s45, s99
    v_lshrrev_b32 v1, 3, v0
    v_and_b32 v2, 7, v0
    v_mul_u32_u24 v3, 3072, v1
    v_lshl_add_u32 v50, v2, 7, v3
    v_and_b32 v1, 31, v0
    v_lshlrev_b32 v1, 7, v1
    v_lshrrev_b32 v2, 5, v0
    v_lshl_add_u32 v51, v2, 15, v1
    v_mul_u32_u24 v2, 114688, v2
    v_add_u32 v52, v1, v2
    v_lshrrev_b32 v1, 4, v0
    v_mul_u32_u24 v1, 3584, v1
    v_and_b32 v2, 15, v0
    v_lshl_add_u32 v53, v2, 7, v1
    s_mov_b32 s98, 5462
    v_add_u32 v1, 0, v0
    v_mul_lo_u32 v2, v1, s98
    v_lshrrev_b32 v2, 16, v2
    v_mul_u32_u24 v3, 12, v2
    v_sub_u32 v3, v1, v3
    v_mul_u32_u24 v2, 3584, v2
    v_lshl_add_u32 v64, v3, 7, v2
    v_add_u32 v1, 64, v0
    v_mul_lo_u32 v2, v1, s98
    v_lshrrev_b32 v2, 16, v2
    v_mul_u32_u24 v3, 12, v2
    v_sub_u32 v3, v1, v3
    v_mul_u32_u24 v2, 3584, v2
    v_lshl_add_u32 v65, v3, 7, v2
    v_add_u32 v1, 128, v0
    v_mul_lo_u32 v2, v1, s98
    v_lshrrev_b32 v2, 16, v2
    v_mul_u32_u24 v3, 12, v2
    v_sub_u32 v3, v1, v3
    v_mul_u32_u24 v2, 3584, v2
    v_lshl_add_u32 v66, v3, 7, v2
    v_and_b32 v1, 3, v0
    v_lshlrev_b32 v54, 12, v1
    v_and_b32 v1, 7, v0
    v_lshlrev_b32 v55, 7, v1
    s_getpc_b64 s[48:49]
AX_PC:
    s_sub_u32 s48, s48, AX_PC-sequential_preLN__linear_kernel_hedgehog__glu_gated_bilinear__prompt_kernel
    s_subb_u32 s49, s49, 0
    s_mul_i32 s98, s5, 13
    v_add_u32 v71, s98, v0
    v_min_u32 v71, CODE_LINES-1, v71
    v_lshlrev_b32 v71, 7, v71
    global_load_dword v56, v71, s[48:49] sc1
    v_mov_b32 v70, 0
    buffer_load_dword v70, v70, s[32:35], 0 offen sc1
    s_lshr_b32 s46, s2, 2
    s_min_u32 s46, s46, 55
    s_cmp_lt_u32 s46, 28
    s_cselect_b32 s8, s20, s24
    s_cselect_b32 s9, s21, s25
    s_cselect_b32 s98, 0, 28
    s_mov_b32 s10, 1835008
    s_mov_b32 s11, 0x20000
    s_sub_u32 s98, s46, s98
    s_lshl_b32 s47, s98, 7
    s_and_b32 s98, s2, 3
    s_mul_i32 s98, s98, 458752
    s_add_u32 s47, s47, s98
    v_lshrrev_b32 v1, 3, v0
    v_mul_u32_u24 v1, 3584, v1
    v_and_b32 v2, 7, v0
    v_lshl_add_u32 v67, v2, 4, v1
    v_lshlrev_b32 v2, 3, v2
    v_bfe_u32 v1, v0, 4, 1
    v_add_u32 v2, v2, v1
    v_bfe_u32 v1, v0, 3, 1
    v_lshl_add_u32 v2, v1, 1, v2
    v_lshrrev_b32 v1, 5, v0
    v_lshl_add_u32 v2, v1, 2, v2
    v_lshlrev_b32 v68, 4, v2
    s_barrier
    s_waitcnt vmcnt(2)
    s_barrier
    s_waitcnt vmcnt(0)
    v_readfirstlane_b32 s96, v70
    s_nop 1
    s_add_u32 s96, s96, 0x01010101
    s_barrier
    s_barrier
    s_barrier
    s_barrier
    s_lshl_b32 s98, s44, 16
    s_lshl_b32 s99, s6, 12
    s_add_u32 s98, s98, s99
    s_add_u32 s98, s98, 4194304
    buffer_load_dword v57, v51, s[32:35], s98 offen sc1
    s_lshl_b32 s98, s44, 7
    s_add_u32 s98, s98, 8192
    buffer_load_dword v58, v54, s[32:35], s98 offen sc1
    s_lshl_b32 s98, s45, 15
    s_and_b32 s99, s6, 3
    s_lshl_b32 s100, s99, 13
    s_add_u32 s98, s98, s100
    s_add_u32 s98, s98, 6291456
    buffer_load_dword v59, v49, s[32:35], s98 offen sc1
    s_lshl_b32 s98, s45, 12
    s_lshl_b32 s100, s99, 10
    s_add_u32 s98, s98, s100
    s_add_u32 s98, s98, 262144
    buffer_load_dword v60, v55, s[32:35], s98 offen sc1
    s_barrier
    s_add_u32 s98, s47, 0
    buffer_load_dwordx4 v[128:131], v67, s[8:11], s98 offen
    s_add_u32 s98, s47, 28672
    buffer_load_dwordx4 v[132:135], v67, s[8:11], s98 offen
    s_add_u32 s98, s47, 57344
    buffer_load_dwordx4 v[136:139], v67, s[8:11], s98 offen
    s_add_u32 s98, s47, 86016
    buffer_load_dwordx4 v[140:143], v67, s[8:11], s98 offen
    s_add_u32 s98, s47, 114688
    buffer_load_dwordx4 v[144:147], v67, s[8:11], s98 offen
    s_add_u32 s98, s47, 143360
    buffer_load_dwordx4 v[148:151], v67, s[8:11], s98 offen
    s_add_u32 s98, s47, 172032
    buffer_load_dwordx4 v[152:155], v67, s[8:11], s98 offen
    s_add_u32 s98, s47, 200704
    buffer_load_dwordx4 v[156:159], v67, s[8:11], s98 offen
    s_add_u32 s98, s47, 229376
    buffer_load_dwordx4 v[160:163], v67, s[8:11], s98 offen
    s_add_u32 s98, s47, 258048
    buffer_load_dwordx4 v[164:167], v67, s[8:11], s98 offen
    s_add_u32 s98, s47, 286720
    buffer_load_dwordx4 v[168:171], v67, s[8:11], s98 offen
    s_add_u32 s98, s47, 315392
    buffer_load_dwordx4 v[172:175], v67, s[8:11], s98 offen
    s_add_u32 s98, s47, 344064
    buffer_load_dwordx4 v[176:179], v67, s[8:11], s98 offen
    s_add_u32 s98, s47, 372736
    buffer_load_dwordx4 v[180:183], v67, s[8:11], s98 offen
    s_add_u32 s98, s47, 401408
    buffer_load_dwordx4 v[184:187], v67, s[8:11], s98 offen
    s_add_u32 s98, s47, 430080
    buffer_load_dwordx4 v[188:191], v67, s[8:11], s98 offen
    s_mul_i32 s98, s5, 57344
    s_add_u32 s98, s98, 2048
    buffer_load_dword v61, v64, s[20:23], s98 offen sc1
    buffer_load_dword v62, v64, s[24:27], s98 offen sc1
    s_mov_b32 s95, 0
AX_cw_1:
    s_sleep 1
    ds_read_b32 v1, v14 offset:40
    s_add_u32 s95, s95, 1
    s_cmp_gt_u32 s95, 16777216
    s_cbranch_scc1 AX_cb_2
    s_waitcnt lgkmcnt(0)
    v_readfirstlane_b32 s98, v1
    s_nop 1
    s_cmp_lt_u32 s98, 2
    s_nop 0
    s_cbranch_scc1 AX_cw_1
AX_cb_2:
    s_waitcnt lgkmcnt(0)
    s_mov_b32 s95, 0
AX_cw_3:
    s_sleep 2
    ds_read_b32 v1, v14 offset:0
    s_add_u32 s95, s95, 1
    s_cmp_gt_u32 s95, 16777216
    s_cbranch_scc1 AX_cb_4
    s_waitcnt lgkmcnt(0)
    v_readfirstlane_b32 s98, v1
    s_nop 1
    s_cmp_lt_u32 s98, 4
    s_nop 0
    s_cbranch_scc1 AX_cw_3
AX_cb_4:
    s_waitcnt lgkmcnt(0)
    v_mov_b32 v40, 0
    v_mov_b32 v41, 0
    v_mov_b32 v42, 0
    v_mov_b32 v43, 0
    v_mov_b32 v44, 0
    v_mov_b32 v45, 0
    v_mov_b32 v46, 0
    v_mov_b32 v47, 0
    s_waitcnt vmcnt(17)
    v_lshlrev_b32 v88, 16, v128
    v_and_b32 v89, 0xffff0000, v128
    v_add_f32 v40, v40, v88
    v_add_f32 v41, v41, v89
    v_lshlrev_b32 v90, 16, v129
    v_and_b32 v91, 0xffff0000, v129
    v_add_f32 v42, v42, v90
    v_add_f32 v43, v43, v91
    v_lshlrev_b32 v88, 16, v130
    v_and_b32 v89, 0xffff0000, v130
    v_add_f32 v44, v44, v88
    v_add_f32 v45, v45, v89
    v_lshlrev_b32 v90, 16, v131
    v_and_b32 v91, 0xffff0000, v131
    v_add_f32 v46, v46, v90
    v_add_f32 v47, v47, v91
    s_waitcnt vmcnt(16)
    v_lshlrev_b32 v88, 16, v132
    v_and_b32 v89, 0xffff0000, v132
    v_add_f32 v40, v40, v88
    v_add_f32 v41, v41, v89
    v_lshlrev_b32 v90, 16, v133
    v_and_b32 v91, 0xffff0000, v133
    v_add_f32 v42, v42, v90
    v_add_f32 v43, v43, v91
    v_lshlrev_b32 v88, 16, v134
    v_and_b32 v89, 0xffff0000, v134
    v_add_f32 v44, v44, v88
    v_add_f32 v45, v45, v89
    v_lshlrev_b32 v90, 16, v135
    v_and_b32 v91, 0xffff0000, v135
    v_add_f32 v46, v46, v90
    v_add_f32 v47, v47, v91
    s_waitcnt vmcnt(15)
    v_lshlrev_b32 v88, 16, v136
    v_and_b32 v89, 0xffff0000, v136
    v_add_f32 v40, v40, v88
    v_add_f32 v41, v41, v89
    v_lshlrev_b32 v90, 16, v137
    v_and_b32 v91, 0xffff0000, v137
    v_add_f32 v42, v42, v90
    v_add_f32 v43, v43, v91
    v_lshlrev_b32 v88, 16, v138
    v_and_b32 v89, 0xffff0000, v138
    v_add_f32 v44, v44, v88
    v_add_f32 v45, v45, v89
    v_lshlrev_b32 v90, 16, v139
    v_and_b32 v91, 0xffff0000, v139
    v_add_f32 v46, v46, v90
    v_add_f32 v47, v47, v91
    s_waitcnt vmcnt(14)
    v_lshlrev_b32 v88, 16, v140
    v_and_b32 v89, 0xffff0000, v140
    v_add_f32 v40, v40, v88
    v_add_f32 v41, v41, v89
    v_lshlrev_b32 v90, 16, v141
    v_and_b32 v91, 0xffff0000, v141
    v_add_f32 v42, v42, v90
    v_add_f32 v43, v43, v91
    v_lshlrev_b32 v88, 16, v142
    v_and_b32 v89, 0xffff0000, v142
    v_add_f32 v44, v44, v88
    v_add_f32 v45, v45, v89
    v_lshlrev_b32 v90, 16, v143
    v_and_b32 v91, 0xffff0000, v143
    v_add_f32 v46, v46, v90
    v_add_f32 v47, v47, v91
    s_waitcnt vmcnt(13)
    v_lshlrev_b32 v88, 16, v144
    v_and_b32 v89, 0xffff0000, v144
    v_add_f32 v40, v40, v88
    v_add_f32 v41, v41, v89
    v_lshlrev_b32 v90, 16, v145
    v_and_b32 v91, 0xffff0000, v145
    v_add_f32 v42, v42, v90
    v_add_f32 v43, v43, v91
    v_lshlrev_b32 v88, 16, v146
    v_and_b32 v89, 0xffff0000, v146
    v_add_f32 v44, v44, v88
    v_add_f32 v45, v45, v89
    v_lshlrev_b32 v90, 16, v147
    v_and_b32 v91, 0xffff0000, v147
    v_add_f32 v46, v46, v90
    v_add_f32 v47, v47, v91
    s_waitcnt vmcnt(12)
    v_lshlrev_b32 v88, 16, v148
    v_and_b32 v89, 0xffff0000, v148
    v_add_f32 v40, v40, v88
    v_add_f32 v41, v41, v89
    v_lshlrev_b32 v90, 16, v149
    v_and_b32 v91, 0xffff0000, v149
    v_add_f32 v42, v42, v90
    v_add_f32 v43, v43, v91
    v_lshlrev_b32 v88, 16, v150
    v_and_b32 v89, 0xffff0000, v150
    v_add_f32 v44, v44, v88
    v_add_f32 v45, v45, v89
    v_lshlrev_b32 v90, 16, v151
    v_and_b32 v91, 0xffff0000, v151
    v_add_f32 v46, v46, v90
    v_add_f32 v47, v47, v91
    s_waitcnt vmcnt(11)
    v_lshlrev_b32 v88, 16, v152
    v_and_b32 v89, 0xffff0000, v152
    v_add_f32 v40, v40, v88
    v_add_f32 v41, v41, v89
    v_lshlrev_b32 v90, 16, v153
    v_and_b32 v91, 0xffff0000, v153
    v_add_f32 v42, v42, v90
    v_add_f32 v43, v43, v91
    v_lshlrev_b32 v88, 16, v154
    v_and_b32 v89, 0xffff0000, v154
    v_add_f32 v44, v44, v88
    v_add_f32 v45, v45, v89
    v_lshlrev_b32 v90, 16, v155
    v_and_b32 v91, 0xffff0000, v155
    v_add_f32 v46, v46, v90
    v_add_f32 v47, v47, v91
    s_waitcnt vmcnt(10)
    v_lshlrev_b32 v88, 16, v156
    v_and_b32 v89, 0xffff0000, v156
    v_add_f32 v40, v40, v88
    v_add_f32 v41, v41, v89
    v_lshlrev_b32 v90, 16, v157
    v_and_b32 v91, 0xffff0000, v157
    v_add_f32 v42, v42, v90
    v_add_f32 v43, v43, v91
    v_lshlrev_b32 v88, 16, v158
    v_and_b32 v89, 0xffff0000, v158
    v_add_f32 v44, v44, v88
    v_add_f32 v45, v45, v89
    v_lshlrev_b32 v90, 16, v159
    v_and_b32 v91, 0xffff0000, v159
    v_add_f32 v46, v46, v90
    v_add_f32 v47, v47, v91
    s_waitcnt vmcnt(9)
    v_lshlrev_b32 v88, 16, v160
    v_and_b32 v89, 0xffff0000, v160
    v_add_f32 v40, v40, v88
    v_add_f32 v41, v41, v89
    v_lshlrev_b32 v90, 16, v161
    v_and_b32 v91, 0xffff0000, v161
    v_add_f32 v42, v42, v90
    v_add_f32 v43, v43, v91
    v_lshlrev_b32 v88, 16, v162
    v_and_b32 v89, 0xffff0000, v162
    v_add_f32 v44, v44, v88
    v_add_f32 v45, v45, v89
    v_lshlrev_b32 v90, 16, v163
    v_and_b32 v91, 0xffff0000, v163
    v_add_f32 v46, v46, v90
    v_add_f32 v47, v47, v91
    s_waitcnt vmcnt(8)
    v_lshlrev_b32 v88, 16, v164
    v_and_b32 v89, 0xffff0000, v164
    v_add_f32 v40, v40, v88
    v_add_f32 v41, v41, v89
    v_lshlrev_b32 v90, 16, v165
    v_and_b32 v91, 0xffff0000, v165
    v_add_f32 v42, v42, v90
    v_add_f32 v43, v43, v91
    v_lshlrev_b32 v88, 16, v166
    v_and_b32 v89, 0xffff0000, v166
    v_add_f32 v44, v44, v88
    v_add_f32 v45, v45, v89
    v_lshlrev_b32 v90, 16, v167
    v_and_b32 v91, 0xffff0000, v167
    v_add_f32 v46, v46, v90
    v_add_f32 v47, v47, v91
    s_waitcnt vmcnt(7)
    v_lshlrev_b32 v88, 16, v168
    v_and_b32 v89, 0xffff0000, v168
    v_add_f32 v40, v40, v88
    v_add_f32 v41, v41, v89
    v_lshlrev_b32 v90, 16, v169
    v_and_b32 v91, 0xffff0000, v169
    v_add_f32 v42, v42, v90
    v_add_f32 v43, v43, v91
    v_lshlrev_b32 v88, 16, v170
    v_and_b32 v89, 0xffff0000, v170
    v_add_f32 v44, v44, v88
    v_add_f32 v45, v45, v89
    v_lshlrev_b32 v90, 16, v171
    v_and_b32 v91, 0xffff0000, v171
    v_add_f32 v46, v46, v90
    v_add_f32 v47, v47, v91
    s_waitcnt vmcnt(6)
    v_lshlrev_b32 v88, 16, v172
    v_and_b32 v89, 0xffff0000, v172
    v_add_f32 v40, v40, v88
    v_add_f32 v41, v41, v89
    v_lshlrev_b32 v90, 16, v173
    v_and_b32 v91, 0xffff0000, v173
    v_add_f32 v42, v42, v90
    v_add_f32 v43, v43, v91
    v_lshlrev_b32 v88, 16, v174
    v_and_b32 v89, 0xffff0000, v174
    v_add_f32 v44, v44, v88
    v_add_f32 v45, v45, v89
    v_lshlrev_b32 v90, 16, v175
    v_and_b32 v91, 0xffff0000, v175
    v_add_f32 v46, v46, v90
    v_add_f32 v47, v47, v91
    s_waitcnt vmcnt(5)
    v_lshlrev_b32 v88, 16, v176
    v_and_b32 v89, 0xffff0000, v176
    v_add_f32 v40, v40, v88
    v_add_f32 v41, v41, v89
    v_lshlrev_b32 v90, 16, v177
    v_and_b32 v91, 0xffff0000, v177
    v_add_f32 v42, v42, v90
    v_add_f32 v43, v43, v91
    v_lshlrev_b32 v88, 16, v178
    v_and_b32 v89, 0xffff0000, v178
    v_add_f32 v44, v44, v88
    v_add_f32 v45, v45, v89
    v_lshlrev_b32 v90, 16, v179
    v_and_b32 v91, 0xffff0000, v179
    v_add_f32 v46, v46, v90
    v_add_f32 v47, v47, v91
    s_waitcnt vmcnt(4)
    v_lshlrev_b32 v88, 16, v180
    v_and_b32 v89, 0xffff0000, v180
    v_add_f32 v40, v40, v88
    v_add_f32 v41, v41, v89
    v_lshlrev_b32 v90, 16, v181
    v_and_b32 v91, 0xffff0000, v181
    v_add_f32 v42, v42, v90
    v_add_f32 v43, v43, v91
    v_lshlrev_b32 v88, 16, v182
    v_and_b32 v89, 0xffff0000, v182
    v_add_f32 v44, v44, v88
    v_add_f32 v45, v45, v89
    v_lshlrev_b32 v90, 16, v183
    v_and_b32 v91, 0xffff0000, v183
    v_add_f32 v46, v46, v90
    v_add_f32 v47, v47, v91
    s_waitcnt vmcnt(3)
    v_lshlrev_b32 v88, 16, v184
    v_and_b32 v89, 0xffff0000, v184
    v_add_f32 v40, v40, v88
    v_add_f32 v41, v41, v89
    v_lshlrev_b32 v90, 16, v185
    v_and_b32 v91, 0xffff0000, v185
    v_add_f32 v42, v42, v90
    v_add_f32 v43, v43, v91
    v_lshlrev_b32 v88, 16, v186
    v_and_b32 v89, 0xffff0000, v186
    v_add_f32 v44, v44, v88
    v_add_f32 v45, v45, v89
    v_lshlrev_b32 v90, 16, v187
    v_and_b32 v91, 0xffff0000, v187
    v_add_f32 v46, v46, v90
    v_add_f32 v47, v47, v91
    s_waitcnt vmcnt(2)
    v_lshlrev_b32 v88, 16, v188
    v_and_b32 v89, 0xffff0000, v188
    v_add_f32 v40, v40, v88
    v_add_f32 v41, v41, v89
    v_lshlrev_b32 v90, 16, v189
    v_and_b32 v91, 0xffff0000, v189
    v_add_f32 v42, v42, v90
    v_add_f32 v43, v43, v91
    v_lshlrev_b32 v88, 16, v190
    v_and_b32 v89, 0xffff0000, v190
    v_add_f32 v44, v44, v88
    v_add_f32 v45, v45, v89
    v_lshlrev_b32 v90, 16, v191
    v_and_b32 v91, 0xffff0000, v191
    v_add_f32 v46, v46, v90
    v_add_f32 v47, v47, v91
    v_permlane32_swap_b32 v40, v44
    v_permlane32_swap_b32 v41, v45
    v_permlane32_swap_b32 v42, v46
    v_permlane32_swap_b32 v43, v47
    v_add_f32 v40, v40, v44
    v_add_f32 v41, v41, v45
    v_add_f32 v42, v42, v46
    v_add_f32 v43, v43, v47
    v_permlane16_swap_b32 v40, v41
    s_nop 0
    v_permlane16_swap_b32 v42, v43
    v_add_f32 v40, v40, v41
    v_add_f32 v42, v42, v43
    s_nop 0
    v_add_f32_dpp v40, v40, v40 row_ror:8 row_mask:0xf bank_mask:0xf
    v_add_f32_dpp v42, v42, v42 row_ror:8 row_mask:0xf bank_mask:0xf
    v_and_b32 v1, 8, v0
    v_cmp_eq_u32 vcc, 0, v1
    s_nop 1
    v_cndmask_b32 v40, v42, v40, vcc
    s_and_b32 s98, s2, 3
    v_mov_b32 v1, s96
    v_mov_b32 v2, 0xff
    v_bfi_b32 v40, v2, v1, v40
    s_lshl_b32 s98, s98, 2
    s_lshl_b32 s99, s46, 10
    s_add_u32 s98, s98, s99
    s_add_u32 s98, s98, 196608
    s_cmp_ge_u32 s2, 224
    s_cbranch_scc1 AX_nocs_5
    buffer_store_dword v40, v68, s[32:35], s98 offen sc1
AX_nocs_5:
    s_mov_b32 s95, 0
AX_cw_6:
    s_sleep 2
    ds_read_b32 v1, v14 offset:52
    s_add_u32 s95, s95, 1
    s_cmp_gt_u32 s95, 16777216
    s_cbranch_scc1 AX_cb_7
    s_waitcnt lgkmcnt(0)
    v_readfirstlane_b32 s98, v1
    s_nop 1
    s_cmp_lt_u32 s98, 1
    s_nop 0
    s_cbranch_scc1 AX_cw_6
AX_cb_7:
    s_waitcnt lgkmcnt(0)
    s_mul_i32 s98, s5, 57344
    s_add_u32 s98, s98, 2048
    buffer_load_dword v63, v65, s[20:23], s98 offen sc1
    buffer_load_dword v56, v65, s[24:27], s98 offen sc1
    s_mul_i32 s98, s5, 57344
    s_add_u32 s98, s98, 2048
    buffer_load_dword v57, v66, s[20:23], s98 offen sc1
    buffer_load_dword v58, v66, s[24:27], s98 offen sc1
    s_mov_b32 s95, 0
AX_cw_8:
    s_sleep 2
    ds_read_b32 v1, v14 offset:16
    s_add_u32 s95, s95, 1
    s_cmp_gt_u32 s95, 16777216
    s_cbranch_scc1 AX_cb_9
    s_waitcnt lgkmcnt(0)
    v_readfirstlane_b32 s98, v1
    s_nop 1
    s_cmp_lt_u32 s98, 1
    s_nop 0
    s_cbranch_scc1 AX_cw_8
AX_cb_9:
    s_waitcnt lgkmcnt(0)
    v_bfe_u32 v1, v0, 4, 1
    v_mul_u32_u24 v1, 28672, v1
    v_and_b32 v2, 15, v0
    v_lshl_add_u32 v69, v2, 4, v1
    s_and_b32 s99, s5, 15
    s_mul_i32 s100, s99, 768
    s_add_u32 s100, s100, 212992
    s_lshl_b32 s101, s99, 10
    s_add_u32 s101, s101, 196608
    v_mov_b32 v72, s96
    s_mov_b32 s95, 0
AX_cg_10:
    buffer_load_dwordx4 v[128:131], v69, s[32:35], s100 offen offset:0 sc1
    buffer_load_dwordx4 v[132:135], v69, s[32:35], s100 offen offset:256 sc1
    buffer_load_dwordx4 v[136:139], v69, s[32:35], s100 offen offset:512 sc1
    buffer_load_dwordx4 v[140:143], v69, s[32:35], s101 offen offset:0 sc1
    buffer_load_dwordx4 v[144:147], v69, s[32:35], s101 offen offset:256 sc1
    buffer_load_dwordx4 v[148:151], v69, s[32:35], s101 offen offset:512 sc1
    buffer_load_dwordx4 v[152:155], v69, s[32:35], s101 offen offset:768 sc1
    s_add_u32 s95, s95, 1
    s_cmp_gt_u32 s95, 262144
    s_cbranch_scc1 AX_cgb_11
    v_mov_b32 v1, 0
    s_waitcnt vmcnt(6)
    v_bitop3_b32 v1, v1, v128, v72 bitop3:0xf6
    v_bitop3_b32 v1, v1, v129, v72 bitop3:0xf6
    v_bitop3_b32 v1, v1, v130, v72 bitop3:0xf6
    v_bitop3_b32 v1, v1, v131, v72 bitop3:0xf6
    s_waitcnt vmcnt(5)
    v_bitop3_b32 v1, v1, v132, v72 bitop3:0xf6
    v_bitop3_b32 v1, v1, v133, v72 bitop3:0xf6
    v_bitop3_b32 v1, v1, v134, v72 bitop3:0xf6
    v_bitop3_b32 v1, v1, v135, v72 bitop3:0xf6
    s_waitcnt vmcnt(4)
    v_bitop3_b32 v1, v1, v136, v72 bitop3:0xf6
    v_bitop3_b32 v1, v1, v137, v72 bitop3:0xf6
    v_bitop3_b32 v1, v1, v138, v72 bitop3:0xf6
    v_bitop3_b32 v1, v1, v139, v72 bitop3:0xf6
    s_waitcnt vmcnt(3)
    v_bitop3_b32 v1, v1, v140, v72 bitop3:0xf6
    v_bitop3_b32 v1, v1, v141, v72 bitop3:0xf6
    v_bitop3_b32 v1, v1, v142, v72 bitop3:0xf6
    v_bitop3_b32 v1, v1, v143, v72 bitop3:0xf6
    s_waitcnt vmcnt(2)
    v_bitop3_b32 v1, v1, v144, v72 bitop3:0xf6
    v_bitop3_b32 v1, v1, v145, v72 bitop3:0xf6
    v_bitop3_b32 v1, v1, v146, v72 bitop3:0xf6
    v_bitop3_b32 v1, v1, v147, v72 bitop3:0xf6
    s_waitcnt vmcnt(1)
    v_bitop3_b32 v1, v1, v148, v72 bitop3:0xf6
    v_bitop3_b32 v1, v1, v149, v72 bitop3:0xf6
    v_bitop3_b32 v1, v1, v150, v72 bitop3:0xf6
    v_bitop3_b32 v1, v1, v151, v72 bitop3:0xf6
    s_waitcnt vmcnt(0)
    v_bitop3_b32 v1, v1, v152, v72 bitop3:0xf6
    v_bitop3_b32 v1, v1, v153, v72 bitop3:0xf6
    v_bitop3_b32 v1, v1, v154, v72 bitop3:0xf6
    v_bitop3_b32 v1, v1, v155, v72 bitop3:0xf6
    v_and_b32 v1, 0xff, v1
    v_cmp_ne_u32 vcc, 0, v1
    s_nop 3
    s_cbranch_vccnz AX_cg_10
AX_cgb_11:
    s_waitcnt vmcnt(0)
    v_lshlrev_b32 v3, 3, v0
    v_add_u32 v3, 159744, v3
    v_add_f32 v128, v128, v129
    v_add_f32 v130, v130, v131
    v_add_f32 v128, v128, v130
    v_mul_f32 v128, 0.5, v128
    v_and_b32 v1, 0xffff0000, v128
    v_sub_f32 v131, v128, v1
    v_cvt_pk_bf16_f32 v130, v1, v131
    v_lshrrev_b32 v131, 16, v1
    ds_write_b64 v3, v[130:131] offset:0
    v_add_f32 v132, v132, v133
    v_add_f32 v134, v134, v135
    v_add_f32 v132, v132, v134
    v_mul_f32 v132, 0.5, v132
    v_and_b32 v1, 0xffff0000, v132
    v_sub_f32 v135, v132, v1
    v_cvt_pk_bf16_f32 v134, v1, v135
    v_lshrrev_b32 v135, 16, v1
    ds_write_b64 v3, v[134:135] offset:512
    v_add_f32 v136, v136, v137
    v_add_f32 v138, v138, v139
    v_add_f32 v136, v136, v138
    v_mul_f32 v136, 0.5, v136
    v_and_b32 v1, 0xffff0000, v136
    v_sub_f32 v139, v136, v1
    v_cvt_pk_bf16_f32 v138, v1, v139
    v_lshrrev_b32 v139, 16, v1
    ds_write_b64 v3, v[138:139] offset:1024
    v_add_f32 v140, v140, v141
    v_add_f32 v142, v142, v143
    v_add_f32 v140, v140, v142
    v_mul_f32 v140, 0.5, v140
    v_and_b32 v1, 0xffff0000, v140
    v_sub_f32 v143, v140, v1
    v_cvt_pk_bf16_f32 v142, v1, v143
    v_lshrrev_b32 v143, 16, v1
    ds_write_b64 v3, v[142:143] offset:1536
    v_add_f32 v144, v144, v145
    v_add_f32 v146, v146, v147
    v_add_f32 v144, v144, v146
    v_mul_f32 v144, 0.5, v144
    v_and_b32 v1, 0xffff0000, v144
    v_sub_f32 v147, v144, v1
    v_cvt_pk_bf16_f32 v146, v1, v147
    v_lshrrev_b32 v147, 16, v1
    ds_write_b64 v3, v[146:147] offset:2048
    v_add_f32 v148, v148, v149
    v_add_f32 v150, v150, v151
    v_add_f32 v148, v148, v150
    v_mul_f32 v148, 0.5, v148
    v_and_b32 v1, 0xffff0000, v148
    v_sub_f32 v151, v148, v1
    v_cvt_pk_bf16_f32 v150, v1, v151
    v_lshrrev_b32 v151, 16, v1
    ds_write_b64 v3, v[150:151] offset:2560
    v_add_f32 v152, v152, v153
    v_add_f32 v154, v154, v155
    v_add_f32 v152, v152, v154
    v_mul_f32 v152, 0.5, v152
    v_and_b32 v1, 0xffff0000, v152
    v_sub_f32 v155, v152, v1
    v_cvt_pk_bf16_f32 v154, v1, v155
    v_lshrrev_b32 v155, 16, v1
    ds_write_b64 v3, v[154:155] offset:3072
    s_waitcnt lgkmcnt(0)
    s_waitcnt vmcnt(0)
    s_barrier
    s_endpgm
.p2align 6
SY_ENTRY:
    s_waitcnt lgkmcnt(0)
    s_mov_b32 s32, s46
    s_and_b32 s33, s47, 0xffff
    s_mov_b32 s34, 268435456
    s_mov_b32 s35, 0x20000
    v_mov_b32 v48, 0
    buffer_load_dword v48, v48, s[32:35], 0 offen sc1
    s_mov_b32 s12, s50
    s_and_b32 s13, s51, 0xffff
    s_mov_b32 s14, 1572864
    s_mov_b32 s15, 0x20000
    s_lshr_b32 s46, s2, 3
    s_min_u32 s46, s46, 23
    s_lshl_b32 s99, s46, 7
    s_and_b32 s98, s2, 7
    s_mul_i32 s98, s98, 196608
    s_add_u32 s99, s99, s98
    v_lshrrev_b32 v1, 3, v0
    v_mul_u32_u24 v1, 3072, v1
    v_and_b32 v2, 7, v0
    v_lshl_add_u32 v67, v2, 4, v1
    s_add_u32 s98, s99, 0
    buffer_load_dwordx4 v[128:131], v67, s[12:15], s98 offen
    s_add_u32 s98, s99, 24576
    buffer_load_dwordx4 v[132:135], v67, s[12:15], s98 offen
    s_add_u32 s98, s99, 49152
    buffer_load_dwordx4 v[136:139], v67, s[12:15], s98 offen
    s_add_u32 s98, s99, 73728
    buffer_load_dwordx4 v[140:143], v67, s[12:15], s98 offen
    s_add_u32 s98, s99, 98304
    buffer_load_dwordx4 v[144:147], v67, s[12:15], s98 offen
    s_add_u32 s98, s99, 122880
    buffer_load_dwordx4 v[148:151], v67, s[12:15], s98 offen
    s_add_u32 s98, s99, 147456
    buffer_load_dwordx4 v[152:155], v67, s[12:15], s98 offen
    s_add_u32 s98, s99, 172032
    buffer_load_dwordx4 v[156:159], v67, s[12:15], s98 offen
    v_lshlrev_b32 v2, 3, v2
    v_bfe_u32 v1, v0, 4, 1
    v_add_u32 v2, v2, v1
    v_bfe_u32 v1, v0, 3, 1
    v_lshl_add_u32 v2, v1, 1, v2
    v_lshrrev_b32 v1, 5, v0
    v_lshl_add_u32 v2, v1, 2, v2
    v_lshlrev_b32 v68, 5, v2
    v_bfe_u32 v1, v0, 4, 1
    v_lshlrev_b32 v1, 14, v1
    v_and_b32 v2, 15, v0
    v_lshl_add_u32 v1, v2, 5, v1
    v_add_u32 v69, 16384, v1
    v_and_b32 v2, 31, v0
    v_lshlrev_b32 v70, 5, v2
    v_lshlrev_b32 v71, 3, v0
    v_add_u32 v71, 159744, v71
    v_mov_b32 v40, 0
    v_mov_b32 v41, 0
    v_mov_b32 v42, 0
    v_mov_b32 v43, 0
    v_mov_b32 v44, 0
    v_mov_b32 v45, 0
    v_mov_b32 v46, 0
    v_mov_b32 v47, 0
    s_mov_b32 s8, s48
    s_and_b32 s9, s49, 0xffff
    s_mov_b32 s10, 2097152
    s_mov_b32 s11, 0x20000
    s_mov_b32 s28, s62
    s_and_b32 s29, s63, 0xffff
    s_mov_b32 s30, 1835008
    s_mov_b32 s31, 0x20000
    v_mov_b32 v14, 163584
    v_mov_b32 v15, 1
    s_getreg_b32 s47, hwreg(HW_REG_XCC_ID)
    s_and_b32 s47, s47, 15
    s_lshl_b32 s44, s4, 2
    s_add_u32 s44, s44, s7
    s_lshr_b32 s45, s44, 1
    s_lshl_b32 s45, s45, 7
    s_add_u32 s45, s45, 4096
    v_mov_b32 v56, 0xff
    v_lshlrev_b32 v49, 2, v0
    v_lshlrev_b32 v50, 4, v0
    v_lshrrev_b32 v1, 4, v0
    v_mul_u32_u24 v1, 8704, v1
    v_and_b32 v2, 15, v0
    v_lshl_add_u32 v57, v2, 4, v1
    v_lshlrev_b32 v59, 4, v2
    v_lshrrev_b32 v1, 3, v0
    v_mul_u32_u24 v1, 8704, v1
    v_and_b32 v2, 7, v0
    v_lshl_add_u32 v58, v2, 4, v1
    s_barrier
    s_waitcnt vmcnt(8)
    v_readfirstlane_b32 s96, v48
    s_nop 1
    s_add_u32 s96, s96, 0x01010101
    s_and_b32 s98, s96, 0xfffffff0
    s_or_b32 s47, s47, s98
    s_and_b32 s98, s5, 15
    s_lshl_b32 s98, s98, 2
    v_mov_b32 v1, s98
    v_mov_b32 v2, s47
    s_mov_b64 exec, 1
    buffer_store_dword v2, v1, s[32:35], s45 offen sc1
    s_mov_b64 exec, -1
    s_lshr_b32 s98, s96, 0
    v_mov_b32 v52, s98
    s_lshr_b32 s98, s96, 8
    v_mov_b32 v53, s98
    s_lshr_b32 s98, s96, 16
    v_mov_b32 v54, s98
    s_lshr_b32 s98, s96, 24
    v_mov_b32 v55, s98
    s_waitcnt vmcnt(8)
    v_lshlrev_b32 v88, 16, v128
    v_and_b32 v89, 0xffff0000, v128
    v_add_f32 v40, v40, v88
    v_add_f32 v41, v41, v89
    v_lshlrev_b32 v90, 16, v129
    v_and_b32 v91, 0xffff0000, v129
    v_add_f32 v42, v42, v90
    v_add_f32 v43, v43, v91
    v_lshlrev_b32 v88, 16, v130
    v_and_b32 v89, 0xffff0000, v130
    v_add_f32 v44, v44, v88
    v_add_f32 v45, v45, v89
    v_lshlrev_b32 v90, 16, v131
    v_and_b32 v91, 0xffff0000, v131
    v_add_f32 v46, v46, v90
    v_add_f32 v47, v47, v91
    s_waitcnt vmcnt(7)
    v_lshlrev_b32 v88, 16, v132
    v_and_b32 v89, 0xffff0000, v132
    v_add_f32 v40, v40, v88
    v_add_f32 v41, v41, v89
    v_lshlrev_b32 v90, 16, v133
    v_and_b32 v91, 0xffff0000, v133
    v_add_f32 v42, v42, v90
    v_add_f32 v43, v43, v91
    v_lshlrev_b32 v88, 16, v134
    v_and_b32 v89, 0xffff0000, v134
    v_add_f32 v44, v44, v88
    v_add_f32 v45, v45, v89
    v_lshlrev_b32 v90, 16, v135
    v_and_b32 v91, 0xffff0000, v135
    v_add_f32 v46, v46, v90
    v_add_f32 v47, v47, v91
    s_waitcnt vmcnt(6)
    v_lshlrev_b32 v88, 16, v136
    v_and_b32 v89, 0xffff0000, v136
    v_add_f32 v40, v40, v88
    v_add_f32 v41, v41, v89
    v_lshlrev_b32 v90, 16, v137
    v_and_b32 v91, 0xffff0000, v137
    v_add_f32 v42, v42, v90
    v_add_f32 v43, v43, v91
    v_lshlrev_b32 v88, 16, v138
    v_and_b32 v89, 0xffff0000, v138
    v_add_f32 v44, v44, v88
    v_add_f32 v45, v45, v89
    v_lshlrev_b32 v90, 16, v139
    v_and_b32 v91, 0xffff0000, v139
    v_add_f32 v46, v46, v90
    v_add_f32 v47, v47, v91
    s_waitcnt vmcnt(5)
    v_lshlrev_b32 v88, 16, v140
    v_and_b32 v89, 0xffff0000, v140
    v_add_f32 v40, v40, v88
    v_add_f32 v41, v41, v89
    v_lshlrev_b32 v90, 16, v141
    v_and_b32 v91, 0xffff0000, v141
    v_add_f32 v42, v42, v90
    v_add_f32 v43, v43, v91
    v_lshlrev_b32 v88, 16, v142
    v_and_b32 v89, 0xffff0000, v142
    v_add_f32 v44, v44, v88
    v_add_f32 v45, v45, v89
    v_lshlrev_b32 v90, 16, v143
    v_and_b32 v91, 0xffff0000, v143
    v_add_f32 v46, v46, v90
    v_add_f32 v47, v47, v91
    s_barrier
    s_waitcnt vmcnt(4)
    v_lshlrev_b32 v88, 16, v144
    v_and_b32 v89, 0xffff0000, v144
    v_add_f32 v40, v40, v88
    v_add_f32 v41, v41, v89
    v_lshlrev_b32 v90, 16, v145
    v_and_b32 v91, 0xffff0000, v145
    v_add_f32 v42, v42, v90
    v_add_f32 v43, v43, v91
    v_lshlrev_b32 v88, 16, v146
    v_and_b32 v89, 0xffff0000, v146
    v_add_f32 v44, v44, v88
    v_add_f32 v45, v45, v89
    v_lshlrev_b32 v90, 16, v147
    v_and_b32 v91, 0xffff0000, v147
    v_add_f32 v46, v46, v90
    v_add_f32 v47, v47, v91
    s_waitcnt vmcnt(3)
    v_lshlrev_b32 v88, 16, v148
    v_and_b32 v89, 0xffff0000, v148
    v_add_f32 v40, v40, v88
    v_add_f32 v41, v41, v89
    v_lshlrev_b32 v90, 16, v149
    v_and_b32 v91, 0xffff0000, v149
    v_add_f32 v42, v42, v90
    v_add_f32 v43, v43, v91
    v_lshlrev_b32 v88, 16, v150
    v_and_b32 v89, 0xffff0000, v150
    v_add_f32 v44, v44, v88
    v_add_f32 v45, v45, v89
    v_lshlrev_b32 v90, 16, v151
    v_and_b32 v91, 0xffff0000, v151
    v_add_f32 v46, v46, v90
    v_add_f32 v47, v47, v91
    s_waitcnt vmcnt(2)
    v_lshlrev_b32 v88, 16, v152
    v_and_b32 v89, 0xffff0000, v152
    v_add_f32 v40, v40, v88
    v_add_f32 v41, v41, v89
    v_lshlrev_b32 v90, 16, v153
    v_and_b32 v91, 0xffff0000, v153
    v_add_f32 v42, v42, v90
    v_add_f32 v43, v43, v91
    v_lshlrev_b32 v88, 16, v154
    v_and_b32 v89, 0xffff0000, v154
    v_add_f32 v44, v44, v88
    v_add_f32 v45, v45, v89
    v_lshlrev_b32 v90, 16, v155
    v_and_b32 v91, 0xffff0000, v155
    v_add_f32 v46, v46, v90
    v_add_f32 v47, v47, v91
    s_waitcnt vmcnt(1)
    v_lshlrev_b32 v88, 16, v156
    v_and_b32 v89, 0xffff0000, v156
    v_add_f32 v40, v40, v88
    v_add_f32 v41, v41, v89
    v_lshlrev_b32 v90, 16, v157
    v_and_b32 v91, 0xffff0000, v157
    v_add_f32 v42, v42, v90
    v_add_f32 v43, v43, v91
    v_lshlrev_b32 v88, 16, v158
    v_and_b32 v89, 0xffff0000, v158
    v_add_f32 v44, v44, v88
    v_add_f32 v45, v45, v89
    v_lshlrev_b32 v90, 16, v159
    v_and_b32 v91, 0xffff0000, v159
    v_add_f32 v46, v46, v90
    v_add_f32 v47, v47, v91
    v_permlane32_swap_b32 v40, v44
    v_permlane32_swap_b32 v41, v45
    v_permlane32_swap_b32 v42, v46
    v_permlane32_swap_b32 v43, v47
    v_add_f32 v40, v40, v44
    v_add_f32 v41, v41, v45
    v_add_f32 v42, v42, v46
    v_add_f32 v43, v43, v47
    v_permlane16_swap_b32 v40, v41
    s_nop 0
    v_permlane16_swap_b32 v42, v43
    v_add_f32 v40, v40, v41
    v_add_f32 v42, v42, v43
    s_nop 0
    v_add_f32_dpp v40, v40, v40 row_ror:8 row_mask:0xf bank_mask:0xf
    v_add_f32_dpp v42, v42, v42 row_ror:8 row_mask:0xf bank_mask:0xf
    v_and_b32 v1, 8, v0
    v_cmp_eq_u32 vcc, 0, v1
    s_nop 1
    v_cndmask_b32 v40, v42, v40, vcc
    v_bfi_b32 v40, v56, v52, v40
    s_and_b32 s98, s2, 7
    s_lshl_b32 s98, s98, 2
    s_lshl_b32 s99, s46, 11
    s_add_u32 s98, s98, s99
    s_add_u32 s98, s98, 524288
    s_cmp_ge_u32 s2, 192
    s_cbranch_scc1 SY_nocs_1
    buffer_store_dword v40, v68, s[32:35], s98 offen sc1
SY_nocs_1:
    s_lshl_b32 s46, s6, 11
    s_add_u32 s46, s46, 524288
    s_barrier
    s_barrier
    s_barrier
    buffer_load_dwordx4 v[128:131], v69, s[32:35], s46 offen offset:0 sc1
    buffer_load_dwordx4 v[132:135], v69, s[32:35], s46 offen offset:16 sc1
    buffer_load_dwordx4 v[136:139], v69, s[32:35], s46 offen offset:512 sc1
    buffer_load_dwordx4 v[140:143], v69, s[32:35], s46 offen offset:528 sc1
    buffer_load_dwordx4 v[144:147], v69, s[32:35], s46 offen offset:1024 sc1
    buffer_load_dwordx4 v[148:151], v69, s[32:35], s46 offen offset:1040 sc1
    buffer_load_dwordx4 v[152:155], v69, s[32:35], s46 offen offset:1536 sc1
    buffer_load_dwordx4 v[156:159], v69, s[32:35], s46 offen offset:1552 sc1
    buffer_load_dwordx4 v[160:163], v70, s[32:35], s46 offen offset:0 sc1
    buffer_load_dwordx4 v[164:167], v70, s[32:35], s46 offen offset:16 sc1
    buffer_load_dwordx4 v[168:171], v70, s[32:35], s46 offen offset:1024 sc1
    buffer_load_dwordx4 v[172:175], v70, s[32:35], s46 offen offset:1040 sc1
    s_barrier
    s_barrier
    s_mov_b32 s95, 0
    s_branch SY_gqc_3
SY_gq_2:
    buffer_load_dwordx4 v[128:131], v69, s[32:35], s46 offen offset:0 sc1
    buffer_load_dwordx4 v[132:135], v69, s[32:35], s46 offen offset:16 sc1
    buffer_load_dwordx4 v[136:139], v69, s[32:35], s46 offen offset:512 sc1
    buffer_load_dwordx4 v[140:143], v69, s[32:35], s46 offen offset:528 sc1
    buffer_load_dwordx4 v[144:147], v69, s[32:35], s46 offen offset:1024 sc1
    buffer_load_dwordx4 v[148:151], v69, s[32:35], s46 offen offset:1040 sc1
    buffer_load_dwordx4 v[152:155], v69, s[32:35], s46 offen offset:1536 sc1
    buffer_load_dwordx4 v[156:159], v69, s[32:35], s46 offen offset:1552 sc1
    buffer_load_dwordx4 v[160:163], v70, s[32:35], s46 offen offset:0 sc1
    buffer_load_dwordx4 v[164:167], v70, s[32:35], s46 offen offset:16 sc1
    buffer_load_dwordx4 v[168:171], v70, s[32:35], s46 offen offset:1024 sc1
    buffer_load_dwordx4 v[172:175], v70, s[32:35], s46 offen offset:1040 sc1
SY_gqc_3:
    s_waitcnt vmcnt(0)
    s_add_u32 s95, s95, 1
    s_cmp_gt_u32 s95, 262144
    s_cbranch_scc1 SY_gqb_4
    v_mov_b32 v1, 0
    v_bitop3_b32 v1, v1, v128, v52 bitop3:0xf6
    v_bitop3_b32 v1, v1, v129, v52 bitop3:0xf6
    v_bitop3_b32 v1, v1, v130, v52 bitop3:0xf6
    v_bitop3_b32 v1, v1, v131, v52 bitop3:0xf6
    v_bitop3_b32 v1, v1, v132, v52 bitop3:0xf6
    v_bitop3_b32 v1, v1, v133, v52 bitop3:0xf6
    v_bitop3_b32 v1, v1, v134, v52 bitop3:0xf6
    v_bitop3_b32 v1, v1, v135, v52 bitop3:0xf6
    v_bitop3_b32 v1, v1, v136, v52 bitop3:0xf6
    v_bitop3_b32 v1, v1, v137, v52 bitop3:0xf6
    v_bitop3_b32 v1, v1, v138, v52 bitop3:0xf6
    v_bitop3_b32 v1, v1, v139, v52 bitop3:0xf6
    v_bitop3_b32 v1, v1, v140, v52 bitop3:0xf6
    v_bitop3_b32 v1, v1, v141, v52 bitop3:0xf6
    v_bitop3_b32 v1, v1, v142, v52 bitop3:0xf6
    v_bitop3_b32 v1, v1, v143, v52 bitop3:0xf6
    v_bitop3_b32 v1, v1, v144, v52 bitop3:0xf6
    v_bitop3_b32 v1, v1, v145, v52 bitop3:0xf6
    v_bitop3_b32 v1, v1, v146, v52 bitop3:0xf6
    v_bitop3_b32 v1, v1, v147, v52 bitop3:0xf6
    v_bitop3_b32 v1, v1, v148, v52 bitop3:0xf6
    v_bitop3_b32 v1, v1, v149, v52 bitop3:0xf6
    v_bitop3_b32 v1, v1, v150, v52 bitop3:0xf6
    v_bitop3_b32 v1, v1, v151, v52 bitop3:0xf6
    v_bitop3_b32 v1, v1, v152, v52 bitop3:0xf6
    v_bitop3_b32 v1, v1, v153, v52 bitop3:0xf6
    v_bitop3_b32 v1, v1, v154, v52 bitop3:0xf6
    v_bitop3_b32 v1, v1, v155, v52 bitop3:0xf6
    v_bitop3_b32 v1, v1, v156, v52 bitop3:0xf6
    v_bitop3_b32 v1, v1, v157, v52 bitop3:0xf6
    v_bitop3_b32 v1, v1, v158, v52 bitop3:0xf6
    v_bitop3_b32 v1, v1, v159, v52 bitop3:0xf6
    v_bitop3_b32 v1, v1, v160, v52 bitop3:0xf6
    v_bitop3_b32 v1, v1, v161, v52 bitop3:0xf6
    v_bitop3_b32 v1, v1, v162, v52 bitop3:0xf6
    v_bitop3_b32 v1, v1, v163, v52 bitop3:0xf6
    v_bitop3_b32 v1, v1, v164, v52 bitop3:0xf6
    v_bitop3_b32 v1, v1, v165, v52 bitop3:0xf6
    v_bitop3_b32 v1, v1, v166, v52 bitop3:0xf6
    v_bitop3_b32 v1, v1, v167, v52 bitop3:0xf6
    v_bitop3_b32 v1, v1, v168, v52 bitop3:0xf6
    v_bitop3_b32 v1, v1, v169, v52 bitop3:0xf6
    v_bitop3_b32 v1, v1, v170, v52 bitop3:0xf6
    v_bitop3_b32 v1, v1, v171, v52 bitop3:0xf6
    v_bitop3_b32 v1, v1, v172, v52 bitop3:0xf6
    v_bitop3_b32 v1, v1, v173, v52 bitop3:0xf6
    v_bitop3_b32 v1, v1, v174, v52 bitop3:0xf6
    v_bitop3_b32 v1, v1, v175, v52 bitop3:0xf6
    v_and_b32 v1, 0xff, v1
    v_cmp_ne_u32 vcc, 0, v1
    s_nop 3
    s_cbranch_vccnz SY_gq_2
SY_gqb_4:
    v_add_f32 v128, v128, v132
    v_add_f32 v129, v129, v133
    v_add_f32 v130, v130, v134
    v_add_f32 v131, v131, v135
    v_add_f32 v128, v128, v130
    v_add_f32 v129, v129, v131
    v_add_f32 v128, v128, v129
    v_mul_f32 v128, 0.5, v128
    v_and_b32 v1, 0xffff0000, v128
    v_sub_f32 v131, v128, v1
    v_cvt_pk_bf16_f32 v130, v1, v131
    v_lshrrev_b32 v131, 16, v1
    ds_write_b64 v71, v[130:131] offset:0
    v_add_f32 v136, v136, v140
    v_add_f32 v137, v137, v141
    v_add_f32 v138, v138, v142
    v_add_f32 v139, v139, v143
    v_add_f32 v136, v136, v138
    v_add_f32 v137, v137, v139
    v_add_f32 v136, v136, v137
    v_mul_f32 v136, 0.5, v136
    v_and_b32 v1, 0xffff0000, v136
    v_sub_f32 v139, v136, v1
    v_cvt_pk_bf16_f32 v138, v1, v139
    v_lshrrev_b32 v139, 16, v1
    ds_write_b64 v71, v[138:139] offset:512
    v_add_f32 v144, v144, v148
    v_add_f32 v145, v145, v149
    v_add_f32 v146, v146, v150
    v_add_f32 v147, v147, v151
    v_add_f32 v144, v144, v146
    v_add_f32 v145, v145, v147
    v_add_f32 v144, v144, v145
    v_mul_f32 v144, 0.5, v144
    v_and_b32 v1, 0xffff0000, v144
    v_sub_f32 v147, v144, v1
    v_cvt_pk_bf16_f32 v146, v1, v147
    v_lshrrev_b32 v147, 16, v1
    ds_write_b64 v71, v[146:147] offset:1024
    v_add_f32 v152, v152, v156
    v_add_f32 v153, v153, v157
    v_add_f32 v154, v154, v158
    v_add_f32 v155, v155, v159
    v_add_f32 v152, v152, v154
    v_add_f32 v153, v153, v155
    v_add_f32 v152, v152, v153
    v_mul_f32 v152, 0.5, v152
    v_and_b32 v1, 0xffff0000, v152
    v_sub_f32 v155, v152, v1
    v_cvt_pk_bf16_f32 v154, v1, v155
    v_lshrrev_b32 v155, 16, v1
    ds_write_b64 v71, v[154:155] offset:1536
    v_add_f32 v160, v160, v164
    v_add_f32 v161, v161, v165
    v_add_f32 v162, v162, v166
    v_add_f32 v163, v163, v167
    v_add_f32 v160, v160, v162
    v_add_f32 v161, v161, v163
    v_add_f32 v160, v160, v161
    v_mul_f32 v160, 0.5, v160
    v_and_b32 v1, 0xffff0000, v160
    v_sub_f32 v163, v160, v1
    v_cvt_pk_bf16_f32 v162, v1, v163
    v_lshrrev_b32 v163, 16, v1
    ds_write_b64 v71, v[162:163] offset:2048
    v_add_f32 v168, v168, v172
    v_add_f32 v169, v169, v173
    v_add_f32 v170, v170, v174
    v_add_f32 v171, v171, v175
    v_add_f32 v168, v168, v170
    v_add_f32 v169, v169, v171
    v_add_f32 v168, v168, v169
    v_mul_f32 v168, 0.5, v168
    v_and_b32 v1, 0xffff0000, v168
    v_sub_f32 v171, v168, v1
    v_cvt_pk_bf16_f32 v170, v1, v171
    v_lshrrev_b32 v171, 16, v1
    ds_write_b64 v71, v[170:171] offset:2560
    s_waitcnt lgkmcnt(0)
    s_mov_b64 exec, 1
    ds_add_u32 v14, v15 offset:28
    s_mov_b64 exec, -1
    s_mov_b64 exec, 0xffff
    s_mov_b32 s95, 0
SY_xl_5:
    buffer_load_dword v1, v49, s[32:35], s45 offen sc1
    s_add_u32 s95, s95, 1
    s_cmp_gt_u32 s95, 262144
    s_cbranch_scc1 SY_xb_6
    s_waitcnt vmcnt(0)
    v_xor_b32 v1, s47, v1
    v_cmp_lt_u32 vcc, 15, v1
    s_nop 3
    s_cbranch_vccnz SY_xl_5
SY_xb_6:
    s_waitcnt vmcnt(0)
    v_cmp_ne_u32 vcc, 0, v1
    s_nop 1
    s_cmp_eq_u64 vcc, 0
    s_cselect_b32 s98, 2, 1
    s_mov_b64 exec, 1
    v_mov_b32 v1, s98
    ds_write_b32 v14, v1 offset:20
    s_mov_b64 exec, -1
    s_mul_i32 s48, s6, 278528
    s_add_u32 s48, s48, 1048576
    s_mul_i32 s49, s6, 8704
    s_add_u32 s49, s49, 65536
    v_lshrrev_b32 v1, 4, v0
    v_lshlrev_b32 v2, 3, v1
    v_lshrrev_b32 v60, v2, v52
    v_lshl_add_u32 v61, v1, 2, v59
    s_lshl_b32 s50, s44, 8
    s_add_u32 s99, s48, s50
    s_add_u32 s50, s49, s50
    s_lshl_b32 s100, s44, 7
    s_add_u32 s100, s100, 8192
    s_add_u32 s101, s48, s100
    s_add_u32 s100, s49, s100
    s_mov_b32 s95, 0
SY_cw_7:
    s_sleep 1
    ds_read_b32 v1, v14 offset:0
    s_add_u32 s95, s95, 1
    s_cmp_gt_u32 s95, 16777216
    s_cbranch_scc1 SY_cb_8
    s_waitcnt lgkmcnt(0)
    v_readfirstlane_b32 s51, v1
    s_nop 1
    s_cmp_lt_u32 s51, 4
    s_nop 0
    s_cbranch_scc1 SY_cw_7
SY_cb_8:
    s_waitcnt lgkmcnt(0)
    s_cmp_ge_u32 s44, 4
    s_cbranch_scc1 SY_nz_9
    s_mov_b32 s95, 0
SY_hl_11:
    s_sleep 4
    s_add_u32 s98, s99, 0
    buffer_load_dwordx4 v[104:107], v57, s[32:35], s98 offen sc1
    s_add_u32 s98, s99, 34816
    buffer_load_dwordx4 v[108:111], v57, s[32:35], s98 offen sc1
    s_add_u32 s98, s99, 69632
    buffer_load_dwordx4 v[112:115], v57, s[32:35], s98 offen sc1
    s_add_u32 s98, s99, 104448
    buffer_load_dwordx4 v[116:119], v57, s[32:35], s98 offen sc1
    s_add_u32 s98, s99, 139264
    buffer_load_dwordx4 v[120:123], v57, s[32:35], s98 offen sc1
    s_add_u32 s98, s99, 174080
    buffer_load_dwordx4 v[124:127], v57, s[32:35], s98 offen sc1
    s_add_u32 s98, s99, 208896
    buffer_load_dwordx4 v[128:131], v57, s[32:35], s98 offen sc1
    s_add_u32 s98, s99, 243712
    buffer_load_dwordx4 v[132:135], v57, s[32:35], s98 offen sc1
    s_add_u32 s98, s101, 0
    buffer_load_dwordx4 v[136:139], v58, s[32:35], s98 offen sc1
    s_add_u32 s98, s101, 69632
    buffer_load_dwordx4 v[140:143], v58, s[32:35], s98 offen sc1
    s_add_u32 s98, s101, 139264
    buffer_load_dwordx4 v[144:147], v58, s[32:35], s98 offen sc1
    s_add_u32 s98, s101, 208896
    buffer_load_dwordx4 v[148:151], v58, s[32:35], s98 offen sc1
    s_add_u32 s95, s95, 1
    s_cmp_gt_u32 s95, 262144
    s_cbranch_scc1 SY_hb_12
    v_mov_b32 v1, 0
    s_waitcnt vmcnt(11)
    v_bitop3_b32 v1, v1, v104, v52 bitop3:0xf6
    v_bitop3_b32 v1, v1, v105, v53 bitop3:0xf6
    v_bitop3_b32 v1, v1, v106, v54 bitop3:0xf6
    v_bitop3_b32 v1, v1, v107, v55 bitop3:0xf6
    s_waitcnt vmcnt(10)
    v_bitop3_b32 v1, v1, v108, v52 bitop3:0xf6
    v_bitop3_b32 v1, v1, v109, v53 bitop3:0xf6
    v_bitop3_b32 v1, v1, v110, v54 bitop3:0xf6
    v_bitop3_b32 v1, v1, v111, v55 bitop3:0xf6
    s_waitcnt vmcnt(9)
    v_bitop3_b32 v1, v1, v112, v52 bitop3:0xf6
    v_bitop3_b32 v1, v1, v113, v53 bitop3:0xf6
    v_bitop3_b32 v1, v1, v114, v54 bitop3:0xf6
    v_bitop3_b32 v1, v1, v115, v55 bitop3:0xf6
    s_waitcnt vmcnt(8)
    v_bitop3_b32 v1, v1, v116, v52 bitop3:0xf6
    v_bitop3_b32 v1, v1, v117, v53 bitop3:0xf6
    v_bitop3_b32 v1, v1, v118, v54 bitop3:0xf6
    v_bitop3_b32 v1, v1, v119, v55 bitop3:0xf6
    s_waitcnt vmcnt(7)
    v_bitop3_b32 v1, v1, v120, v52 bitop3:0xf6
    v_bitop3_b32 v1, v1, v121, v53 bitop3:0xf6
    v_bitop3_b32 v1, v1, v122, v54 bitop3:0xf6
    v_bitop3_b32 v1, v1, v123, v55 bitop3:0xf6
    s_waitcnt vmcnt(6)
    v_bitop3_b32 v1, v1, v124, v52 bitop3:0xf6
    v_bitop3_b32 v1, v1, v125, v53 bitop3:0xf6
    v_bitop3_b32 v1, v1, v126, v54 bitop3:0xf6
    v_bitop3_b32 v1, v1, v127, v55 bitop3:0xf6
    s_waitcnt vmcnt(5)
    v_bitop3_b32 v1, v1, v128, v52 bitop3:0xf6
    v_bitop3_b32 v1, v1, v129, v53 bitop3:0xf6
    v_bitop3_b32 v1, v1, v130, v54 bitop3:0xf6
    v_bitop3_b32 v1, v1, v131, v55 bitop3:0xf6
    s_waitcnt vmcnt(4)
    v_bitop3_b32 v1, v1, v132, v52 bitop3:0xf6
    v_bitop3_b32 v1, v1, v133, v53 bitop3:0xf6
    v_bitop3_b32 v1, v1, v134, v54 bitop3:0xf6
    v_bitop3_b32 v1, v1, v135, v55 bitop3:0xf6
    s_waitcnt vmcnt(3)
    v_bitop3_b32 v1, v1, v136, v52 bitop3:0xf6
    v_bitop3_b32 v1, v1, v137, v53 bitop3:0xf6
    v_bitop3_b32 v1, v1, v138, v54 bitop3:0xf6
    v_bitop3_b32 v1, v1, v139, v55 bitop3:0xf6
    s_waitcnt vmcnt(2)
    v_bitop3_b32 v1, v1, v140, v52 bitop3:0xf6
    v_bitop3_b32 v1, v1, v141, v53 bitop3:0xf6
    v_bitop3_b32 v1, v1, v142, v54 bitop3:0xf6
    v_bitop3_b32 v1, v1, v143, v55 bitop3:0xf6
    s_waitcnt vmcnt(1)
    v_bitop3_b32 v1, v1, v144, v52 bitop3:0xf6
    v_bitop3_b32 v1, v1, v145, v53 bitop3:0xf6
    v_bitop3_b32 v1, v1, v146, v54 bitop3:0xf6
    v_bitop3_b32 v1, v1, v147, v55 bitop3:0xf6
    s_waitcnt vmcnt(0)
    v_bitop3_b32 v1, v1, v148, v52 bitop3:0xf6
    v_bitop3_b32 v1, v1, v149, v53 bitop3:0xf6
    v_bitop3_b32 v1, v1, v150, v54 bitop3:0xf6
    v_bitop3_b32 v1, v1, v151, v55 bitop3:0xf6
    v_and_b32 v1, 0xff, v1
    v_cmp_ne_u32 vcc, 0, v1
    s_nop 3
    s_cbranch_vccnz SY_hl_11
SY_hb_12:
    s_waitcnt vmcnt(0)
    v_pk_add_f32 v[104:105], v[104:105], v[120:121]
    v_pk_add_f32 v[106:107], v[106:107], v[122:123]
    v_pk_add_f32 v[108:109], v[108:109], v[124:125]
    v_pk_add_f32 v[110:111], v[110:111], v[126:127]
    v_pk_add_f32 v[112:113], v[112:113], v[128:129]
    v_pk_add_f32 v[114:115], v[114:115], v[130:131]
    v_pk_add_f32 v[116:117], v[116:117], v[132:133]
    v_pk_add_f32 v[118:119], v[118:119], v[134:135]
    v_pk_add_f32 v[104:105], v[104:105], v[112:113]
    v_pk_add_f32 v[106:107], v[106:107], v[114:115]
    v_pk_add_f32 v[108:109], v[108:109], v[116:117]
    v_pk_add_f32 v[110:111], v[110:111], v[118:119]
    v_pk_add_f32 v[104:105], v[104:105], v[108:109]
    v_pk_add_f32 v[106:107], v[106:107], v[110:111]
    s_nop 1
    v_permlane32_swap_b32 v104, v106
    v_permlane32_swap_b32 v105, v107
    v_pk_add_f32 v[104:105], v[104:105], v[106:107]
    s_nop 1
    v_permlane16_swap_b32 v104, v105
    v_add_f32 v104, v104, v105
    v_bfi_b32 v104, v56, v60, v104
    buffer_store_dword v104, v61, s[32:35], s50 offen sc1
    v_pk_add_f32 v[136:137], v[136:137], v[144:145]
    v_pk_add_f32 v[138:139], v[138:139], v[146:147]
    v_pk_add_f32 v[140:141], v[140:141], v[148:149]
    v_pk_add_f32 v[142:143], v[142:143], v[150:151]
    v_pk_add_f32 v[136:137], v[136:137], v[140:141]
    v_pk_add_f32 v[138:139], v[138:139], v[142:143]
    s_nop 1
    v_permlane32_swap_b32 v136, v138
    v_permlane32_swap_b32 v137, v139
    v_pk_add_f32 v[136:137], v[136:137], v[138:139]
    s_nop 1
    v_permlane16_swap_b32 v136, v137
    v_add_f32 v136, v136, v137
    s_nop 1
    v_add_f32_dpp v136, v136, v136 row_ror:8 row_mask:0xf bank_mask:0xf
    v_bfi_b32 v136, v56, v60, v136
    s_mov_b32 exec_lo, 0x00ff00ff
    s_mov_b32 exec_hi, 0x00ff00ff
    buffer_store_dword v136, v61, s[32:35], s100 offen sc1
    s_mov_b64 exec, -1
    s_branch SY_dz_10
SY_nz_9:
    s_mov_b32 s95, 0
SY_hl_13:
    s_sleep 4
    s_add_u32 s98, s99, 0
    buffer_load_dwordx4 v[104:107], v57, s[32:35], s98 offen sc1
    s_add_u32 s98, s99, 34816
    buffer_load_dwordx4 v[108:111], v57, s[32:35], s98 offen sc1
    s_add_u32 s98, s99, 69632
    buffer_load_dwordx4 v[112:115], v57, s[32:35], s98 offen sc1
    s_add_u32 s98, s99, 104448
    buffer_load_dwordx4 v[116:119], v57, s[32:35], s98 offen sc1
    s_add_u32 s98, s99, 139264
    buffer_load_dwordx4 v[120:123], v57, s[32:35], s98 offen sc1
    s_add_u32 s98, s99, 174080
    buffer_load_dwordx4 v[124:127], v57, s[32:35], s98 offen sc1
    s_add_u32 s98, s99, 208896
    buffer_load_dwordx4 v[128:131], v57, s[32:35], s98 offen sc1
    s_add_u32 s98, s99, 243712
    buffer_load_dwordx4 v[132:135], v57, s[32:35], s98 offen sc1
    s_add_u32 s95, s95, 1
    s_cmp_gt_u32 s95, 262144
    s_cbranch_scc1 SY_hb_14
    v_mov_b32 v1, 0
    s_waitcnt vmcnt(7)
    v_bitop3_b32 v1, v1, v104, v52 bitop3:0xf6
    v_bitop3_b32 v1, v1, v105, v53 bitop3:0xf6
    v_bitop3_b32 v1, v1, v106, v54 bitop3:0xf6
    v_bitop3_b32 v1, v1, v107, v55 bitop3:0xf6
    s_waitcnt vmcnt(6)
    v_bitop3_b32 v1, v1, v108, v52 bitop3:0xf6
    v_bitop3_b32 v1, v1, v109, v53 bitop3:0xf6
    v_bitop3_b32 v1, v1, v110, v54 bitop3:0xf6
    v_bitop3_b32 v1, v1, v111, v55 bitop3:0xf6
    s_waitcnt vmcnt(5)
    v_bitop3_b32 v1, v1, v112, v52 bitop3:0xf6
    v_bitop3_b32 v1, v1, v113, v53 bitop3:0xf6
    v_bitop3_b32 v1, v1, v114, v54 bitop3:0xf6
    v_bitop3_b32 v1, v1, v115, v55 bitop3:0xf6
    s_waitcnt vmcnt(4)
    v_bitop3_b32 v1, v1, v116, v52 bitop3:0xf6
    v_bitop3_b32 v1, v1, v117, v53 bitop3:0xf6
    v_bitop3_b32 v1, v1, v118, v54 bitop3:0xf6
    v_bitop3_b32 v1, v1, v119, v55 bitop3:0xf6
    s_waitcnt vmcnt(3)
    v_bitop3_b32 v1, v1, v120, v52 bitop3:0xf6
    v_bitop3_b32 v1, v1, v121, v53 bitop3:0xf6
    v_bitop3_b32 v1, v1, v122, v54 bitop3:0xf6
    v_bitop3_b32 v1, v1, v123, v55 bitop3:0xf6
    s_waitcnt vmcnt(2)
    v_bitop3_b32 v1, v1, v124, v52 bitop3:0xf6
    v_bitop3_b32 v1, v1, v125, v53 bitop3:0xf6
    v_bitop3_b32 v1, v1, v126, v54 bitop3:0xf6
    v_bitop3_b32 v1, v1, v127, v55 bitop3:0xf6
    s_waitcnt vmcnt(1)
    v_bitop3_b32 v1, v1, v128, v52 bitop3:0xf6
    v_bitop3_b32 v1, v1, v129, v53 bitop3:0xf6
    v_bitop3_b32 v1, v1, v130, v54 bitop3:0xf6
    v_bitop3_b32 v1, v1, v131, v55 bitop3:0xf6
    s_waitcnt vmcnt(0)
    v_bitop3_b32 v1, v1, v132, v52 bitop3:0xf6
    v_bitop3_b32 v1, v1, v133, v53 bitop3:0xf6
    v_bitop3_b32 v1, v1, v134, v54 bitop3:0xf6
    v_bitop3_b32 v1, v1, v135, v55 bitop3:0xf6
    v_and_b32 v1, 0xff, v1
    v_cmp_ne_u32 vcc, 0, v1
    s_nop 3
    s_cbranch_vccnz SY_hl_13
SY_hb_14:
    s_waitcnt vmcnt(0)
    v_pk_add_f32 v[104:105], v[104:105], v[120:121]
    v_pk_add_f32 v[106:107], v[106:107], v[122:123]
    v_pk_add_f32 v[108:109], v[108:109], v[124:125]
    v_pk_add_f32 v[110:111], v[110:111], v[126:127]
    v_pk_add_f32 v[112:113], v[112:113], v[128:129]
    v_pk_add_f32 v[114:115], v[114:115], v[130:131]
    v_pk_add_f32 v[116:117], v[116:117], v[132:133]
    v_pk_add_f32 v[118:119], v[118:119], v[134:135]
    v_pk_add_f32 v[104:105], v[104:105], v[112:113]
    v_pk_add_f32 v[106:107], v[106:107], v[114:115]
    v_pk_add_f32 v[108:109], v[108:109], v[116:117]
    v_pk_add_f32 v[110:111], v[110:111], v[118:119]
    v_pk_add_f32 v[104:105], v[104:105], v[108:109]
    v_pk_add_f32 v[106:107], v[106:107], v[110:111]
    s_nop 1
    v_permlane32_swap_b32 v104, v106
    v_permlane32_swap_b32 v105, v107
    v_pk_add_f32 v[104:105], v[104:105], v[106:107]
    s_nop 1
    v_permlane16_swap_b32 v104, v105
    v_add_f32 v104, v104, v105
    v_bfi_b32 v104, v56, v60, v104
    buffer_store_dword v104, v61, s[32:35], s50 offen sc1
SY_dz_10:
    s_mov_b64 exec, 1
    ds_add_u32 v14, v15 offset:52
    s_mov_b64 exec, -1
    s_mov_b64 exec, 1
    ds_add_u32 v14, v15 offset:32
    s_mov_b64 exec, -1
    s_waitcnt vmcnt(0)
    s_lshr_b32 s99, s6, 2
    s_lshl_b32 s98, s44, 1
    s_add_u32 s99, s99, s98
    s_lshl_b32 s100, s99, 6
    s_add_u32 s100, s100, 8192
    s_lshl_b32 s50, s99, 15
    s_add_u32 s50, s50, 4194304
    v_lshrrev_b32 v1, 4, v0
    v_and_b32 v2, 15, v0
    v_xor_b32 v2, v2, v1
    v_lshlrev_b32 v2, 4, v2
    v_lshl_add_u32 v2, v1, 10, v2
    v_xor_b32 v62, 0, v2
    v_add_u32 v62, 0, v62
    v_xor_b32 v63, 64, v2
    v_add_u32 v63, 3072, v63
    v_xor_b32 v64, 128, v2
    v_add_u32 v64, 6144, v64
    v_xor_b32 v65, 192, v2
    v_add_u32 v65, 9216, v65
    s_lshl_b32 s101, s99, 15
    s_and_b32 s98, s6, 3
    s_lshl_b32 s98, s98, 8
    s_add_u32 s101, s101, s98
    s_lshl_b32 s51, s7, 1
    s_lshr_b32 s98, s6, 2
    s_add_u32 s51, s51, s98
    s_mov_b32 s95, 0
SY_cw_15:
    ds_read_b32 v1, v14 offset:12
    s_add_u32 s95, s95, 1
    s_cmp_gt_u32 s95, 16777216
    s_cbranch_scc1 SY_cb_16
    s_waitcnt lgkmcnt(0)
    v_readfirstlane_b32 s98, v1
    s_nop 1
    s_cmp_lt_u32 s98, 4
    s_nop 0
    s_cbranch_scc1 SY_cw_15
SY_cb_16:
    s_waitcnt lgkmcnt(0)
    s_mov_b32 m0, 148480
    s_add_u32 s98, s101, 0
    buffer_load_dwordx4 v62, s[8:11], s98 offen lds
    buffer_load_dwordx4 v63, s[8:11], s98 offen offset:1024 lds
    buffer_load_dwordx4 v64, s[8:11], s98 offen offset:2048 lds
    buffer_load_dwordx4 v65, s[8:11], s98 offen offset:3072 lds
    s_mov_b32 m0, 152576
    s_add_u32 s98, s101, 16384
    buffer_load_dwordx4 v62, s[8:11], s98 offen lds
    buffer_load_dwordx4 v63, s[8:11], s98 offen offset:1024 lds
    buffer_load_dwordx4 v64, s[8:11], s98 offen offset:2048 lds
    buffer_load_dwordx4 v65, s[8:11], s98 offen offset:3072 lds
    s_waitcnt vmcnt(0)
    s_mov_b64 exec, 1
    ds_add_u32 v14, v15 offset:24
    s_mov_b64 exec, -1
    s_mov_b64 exec, 0xffff
    s_mov_b32 s95, 0
SY_pf_17:
    buffer_load_dword v1, v49, s[32:35], s100 offen sc1
    s_add_u32 s95, s95, 1
    s_cmp_gt_u32 s95, 262144
    s_cbranch_scc1 SY_pb_18
    s_waitcnt vmcnt(0)
    v_cmp_ne_u32 vcc, s96, v1
    s_nop 3
    s_cbranch_vccnz SY_pf_17
SY_pb_18:
    s_waitcnt vmcnt(0)
    s_mov_b64 exec, -1
    s_mov_b32 m0, 99328
    s_add_u32 s98, s51, 0
    s_and_b32 s98, s98, 7
    s_lshl_b32 s98, s98, 12
    s_add_u32 s98, s98, s50
    buffer_load_dwordx4 v50, s[32:35], s98 offen sc1 lds
    buffer_load_dwordx4 v50, s[32:35], s98 offen offset:1024 sc1 lds
    buffer_load_dwordx4 v50, s[32:35], s98 offen offset:2048 sc1 lds
    buffer_load_dwordx4 v50, s[32:35], s98 offen offset:3072 sc1 lds
    s_mov_b32 m0, 103424
    s_add_u32 s98, s51, 1
    s_and_b32 s98, s98, 7
    s_lshl_b32 s98, s98, 12
    s_add_u32 s98, s98, s50
    buffer_load_dwordx4 v50, s[32:35], s98 offen sc1 lds
    buffer_load_dwordx4 v50, s[32:35], s98 offen offset:1024 sc1 lds
    buffer_load_dwordx4 v50, s[32:35], s98 offen offset:2048 sc1 lds
    buffer_load_dwordx4 v50, s[32:35], s98 offen offset:3072 sc1 lds
    s_mov_b32 m0, 107520
    s_add_u32 s98, s51, 2
    s_and_b32 s98, s98, 7
    s_lshl_b32 s98, s98, 12
    s_add_u32 s98, s98, s50
    buffer_load_dwordx4 v50, s[32:35], s98 offen sc1 lds
    buffer_load_dwordx4 v50, s[32:35], s98 offen offset:1024 sc1 lds
    buffer_load_dwordx4 v50, s[32:35], s98 offen offset:2048 sc1 lds
    buffer_load_dwordx4 v50, s[32:35], s98 offen offset:3072 sc1 lds
    s_mov_b32 m0, 111616
    s_add_u32 s98, s51, 3
    s_and_b32 s98, s98, 7
    s_lshl_b32 s98, s98, 12
    s_add_u32 s98, s98, s50
    buffer_load_dwordx4 v50, s[32:35], s98 offen sc1 lds
    buffer_load_dwordx4 v50, s[32:35], s98 offen offset:1024 sc1 lds
    buffer_load_dwordx4 v50, s[32:35], s98 offen offset:2048 sc1 lds
    buffer_load_dwordx4 v50, s[32:35], s98 offen offset:3072 sc1 lds
    s_mov_b32 m0, 115712
    s_add_u32 s98, s51, 4
    s_and_b32 s98, s98, 7
    s_lshl_b32 s98, s98, 12
    s_add_u32 s98, s98, s50
    buffer_load_dwordx4 v50, s[32:35], s98 offen sc1 lds
    buffer_load_dwordx4 v50, s[32:35], s98 offen offset:1024 sc1 lds
    buffer_load_dwordx4 v50, s[32:35], s98 offen offset:2048 sc1 lds
    buffer_load_dwordx4 v50, s[32:35], s98 offen offset:3072 sc1 lds
    s_mov_b32 m0, 119808
    s_add_u32 s98, s51, 5
    s_and_b32 s98, s98, 7
    s_lshl_b32 s98, s98, 12
    s_add_u32 s98, s98, s50
    buffer_load_dwordx4 v50, s[32:35], s98 offen sc1 lds
    buffer_load_dwordx4 v50, s[32:35], s98 offen offset:1024 sc1 lds
    buffer_load_dwordx4 v50, s[32:35], s98 offen offset:2048 sc1 lds
    buffer_load_dwordx4 v50, s[32:35], s98 offen offset:3072 sc1 lds
    s_mov_b32 m0, 123904
    s_add_u32 s98, s51, 6
    s_and_b32 s98, s98, 7
    s_lshl_b32 s98, s98, 12
    s_add_u32 s98, s98, s50
    buffer_load_dwordx4 v50, s[32:35], s98 offen sc1 lds
    buffer_load_dwordx4 v50, s[32:35], s98 offen offset:1024 sc1 lds
    buffer_load_dwordx4 v50, s[32:35], s98 offen offset:2048 sc1 lds
    buffer_load_dwordx4 v50, s[32:35], s98 offen offset:3072 sc1 lds
    s_mov_b32 m0, 128000
    s_add_u32 s98, s51, 7
    s_and_b32 s98, s98, 7
    s_lshl_b32 s98, s98, 12
    s_add_u32 s98, s98, s50
    buffer_load_dwordx4 v50, s[32:35], s98 offen sc1 lds
    buffer_load_dwordx4 v50, s[32:35], s98 offen offset:1024 sc1 lds
    buffer_load_dwordx4 v50, s[32:35], s98 offen offset:2048 sc1 lds
    buffer_load_dwordx4 v50, s[32:35], s98 offen offset:3072 sc1 lds
    s_waitcnt vmcnt(24)
    s_mov_b64 exec, 1
    ds_add_u32 v14, v15 offset:16
    s_mov_b64 exec, -1
    s_waitcnt vmcnt(16)
    s_mov_b64 exec, 1
    ds_add_u32 v14, v15 offset:16
    s_mov_b64 exec, -1
    s_waitcnt vmcnt(8)
    s_mov_b64 exec, 1
    ds_add_u32 v14, v15 offset:16
    s_mov_b64 exec, -1
    s_waitcnt vmcnt(0)
    s_mov_b64 exec, 1
    ds_add_u32 v14, v15 offset:16
    s_mov_b64 exec, -1
    s_endpgm
.p2align 6
C_ENTRY:
    s_waitcnt lgkmcnt(0)
    s_mov_b32 s32, s46
    s_and_b32 s33, s47, 0xffff
    s_mov_b32 s34, 268435456
    s_mov_b32 s35, 0x20000
    v_mov_b32 v15, 0
    buffer_load_dword v15, v15, s[32:35], 0 offen sc1
    s_mov_b32 s36, s44
    s_and_b32 s37, s45, 0xffff
    s_mov_b32 s38, 2097152
    s_mov_b32 s39, 0x20000
    s_lshl_b32 s44, s4, 2
    s_add_u32 s44, s44, s7
    s_and_b32 s45, s3, 1
    s_lshr_b32 s46, s3, 1
    v_mov_b32 v9, 0x3f803f80
    v_mov_b32 v11, 163584
    v_and_b32 v1, 31, v0
    v_lshrrev_b32 v2, 5, v0
    v_bfe_u32 v3, v1, 1, 3
    v_xor_b32 v3, v3, v2
    v_lshlrev_b32 v3, 4, v3
    v_lshl_add_u32 v3, v1, 7, v3
    s_lshl_b32 s98, s45, 12
    v_add_u32 v3, s98, v3
    s_lshl_b32 s98, s46, 5
    v_xor_b32 v3, s98, v3
    v_xor_b32 v104, 0, v3
    v_xor_b32 v108, 4096, v3
    v_xor_b32 v105, 32, v3
    v_xor_b32 v109, 4128, v3
    v_xor_b32 v106, 64, v3
    v_xor_b32 v110, 4160, v3
    v_xor_b32 v107, 96, v3
    v_xor_b32 v111, 4192, v3
    s_lshl_b32 s99, s3, 1
    v_lshrrev_b32 v1, 5, v0
    v_bfe_u32 v2, v0, 4, 1
    v_bfe_u32 v3, v0, 2, 2
    v_and_b32 v4, 3, v0
    v_lshrrev_b32 v5, 1, v4
    v_add_u32 v5, s99, v5
    v_and_b32 v6, 2, v3
    v_lshl_add_u32 v6, v2, 2, v6
    v_xor_b32 v5, v5, v6
    v_lshlrev_b32 v5, 4, v5
    v_and_b32 v6, 1, v4
    v_lshl_add_u32 v5, v6, 3, v5
    v_mul_u32_u24 v6, 8, v1
    v_add_u32 v6, v6, v3
    v_mul_u32_u24 v6, 128, v6
    v_add_u32 v5, v5, v6
    v_mul_u32_u24 v6, 8192, v2
    v_add_u32 v5, v5, v6
    v_add_u32 v10, 8192, v5
    s_lshl_b32 s98, s46, 11
    v_subrev_u32 v8, s98, v10
    v_add_u32 v10, s98, v10
    v_mov_b32 v100, 0
    v_mov_b32 v101, 0
    v_mov_b32 v102, 0
    v_mov_b32 v103, 0
    s_lshl_b32 s99, s46, 2
    v_lshrrev_b32 v1, 5, v0
    v_bfe_u32 v2, v0, 4, 1
    v_bfe_u32 v3, v0, 2, 2
    v_and_b32 v4, 3, v0
    v_lshrrev_b32 v5, 1, v4
    v_lshl_add_u32 v5, v2, 1, v5
    v_add_u32 v5, s99, v5
    v_and_b32 v6, 2, v3
    v_lshlrev_b32 v6, 1, v6
    v_xor_b32 v5, v5, v6
    v_lshlrev_b32 v5, 4, v5
    v_and_b32 v6, 1, v4
    v_lshl_add_u32 v5, v6, 3, v5
    v_mul_u32_u24 v6, 8, v1
    v_add_u32 v6, v6, v3
    v_mul_u32_u24 v6, 128, v6
    v_add_u32 v5, v5, v6
    v_add_u32 v82, 24576, v5
    s_lshl_b32 s98, s46, 11
    v_subrev_u32 v83, s98, v82
    v_add_u32 v82, s98, v82
    v_and_b32 v1, 31, v0
    v_lshrrev_b32 v2, 5, v0
    v_lshlrev_b32 v2, 2, v2
    v_sub_u32 v1, v1, v2
    v_mov_b32 v2, 0x3f80
    v_mov_b32 v3, 0x3f800000
    v_cmp_eq_u32 vcc, 0, v1
    s_nop 1
    v_cndmask_b32 v120, 0, v2, vcc
    v_cmp_eq_u32 vcc, 1, v1
    s_nop 1
    v_cndmask_b32 v120, v120, v3, vcc
    v_cmp_eq_u32 vcc, 2, v1
    s_nop 1
    v_cndmask_b32 v121, 0, v2, vcc
    v_cmp_eq_u32 vcc, 3, v1
    s_nop 1
    v_cndmask_b32 v121, v121, v3, vcc
    v_cmp_eq_u32 vcc, 8, v1
    s_nop 1
    v_cndmask_b32 v122, 0, v2, vcc
    v_cmp_eq_u32 vcc, 9, v1
    s_nop 1
    v_cndmask_b32 v122, v122, v3, vcc
    v_cmp_eq_u32 vcc, 10, v1
    s_nop 1
    v_cndmask_b32 v123, 0, v2, vcc
    v_cmp_eq_u32 vcc, 11, v1
    s_nop 1
    v_cndmask_b32 v123, v123, v3, vcc
    v_cmp_eq_u32 vcc, 16, v1
    s_nop 1
    v_cndmask_b32 v124, 0, v2, vcc
    v_cmp_eq_u32 vcc, 17, v1
    s_nop 1
    v_cndmask_b32 v124, v124, v3, vcc
    v_cmp_eq_u32 vcc, 18, v1
    s_nop 1
    v_cndmask_b32 v125, 0, v2, vcc
    v_cmp_eq_u32 vcc, 19, v1
    s_nop 1
    v_cndmask_b32 v125, v125, v3, vcc
    v_cmp_eq_u32 vcc, 24, v1
    s_nop 1
    v_cndmask_b32 v126, 0, v2, vcc
    v_cmp_eq_u32 vcc, 25, v1
    s_nop 1
    v_cndmask_b32 v126, v126, v3, vcc
    v_cmp_eq_u32 vcc, 26, v1
    s_nop 1
    v_cndmask_b32 v127, 0, v2, vcc
    v_cmp_eq_u32 vcc, 27, v1
    s_nop 1
    v_cndmask_b32 v127, v127, v3, vcc
    v_bfe_u32 v1, v0, 4, 1
    v_mul_u32_u24 v80, 0x3f80, v1
    v_lshl_add_u32 v80, v80, 16, v80
    v_mov_b32 v7, 1
    s_barrier
    ds_read_b64_tr_b16 v[128:129], v10 offset:0
    ds_read_b64_tr_b16 v[130:131], v10 offset:512
    ds_read_b128 v[208:211], v104 offset:0
    ds_read_b128 v[160:163], v108 offset:0
    ds_read_b64_tr_b16 v[176:177], v82 offset:0
    ds_read_b64_tr_b16 v[178:179], v82 offset:512
    ds_read_b64_tr_b16 v[132:133], v8 offset:2048
    ds_read_b64_tr_b16 v[134:135], v8 offset:2560
    ds_read_b128 v[212:215], v105 offset:0
    ds_read_b128 v[164:167], v109 offset:0
    ds_read_b64_tr_b16 v[180:181], v83 offset:2048
    ds_read_b64_tr_b16 v[182:183], v83 offset:2560
    s_waitcnt lgkmcnt(9)
    v_mfma_f32_32x32x16_bf16 v[16:31], v[128:131], v[208:211], 0
    ds_read_b64_tr_b16 v[136:137], v10 offset:4096
    ds_read_b64_tr_b16 v[138:139], v10 offset:4608
    v_lshlrev_b32 v1, 16, v208
    v_and_b32 v2, 0xffff0000, v208
    v_add_f32 v100, v100, v1
    v_fmac_f32 v102, v1, v1
    s_waitcnt lgkmcnt(10)
    v_mfma_f32_32x32x16_bf16 v[32:47], v[128:131], v[160:163], 0
    ds_read_b128 v[216:219], v106 offset:0
    ds_read_b128 v[168:171], v110 offset:0
    v_add_f32 v101, v101, v2
    v_fmac_f32 v103, v2, v2
    v_lshlrev_b32 v1, 16, v209
    v_and_b32 v2, 0xffff0000, v209
    s_waitcnt lgkmcnt(10)
    v_mfma_f32_32x32x16_bf16 v[192:207], v[176:179], v[208:211], 0
    ds_read_b64_tr_b16 v[184:185], v82 offset:4096
    ds_read_b64_tr_b16 v[186:187], v82 offset:4608
    v_add_f32 v100, v100, v1
    v_fmac_f32 v102, v1, v1
    v_add_f32 v101, v101, v2
    v_fmac_f32 v103, v2, v2
    s_waitcnt lgkmcnt(9)
    v_mfma_f32_32x32x16_bf16 v[16:31], v[132:135], v[212:215], v[16:31]
    ds_read_b64_tr_b16 v[140:141], v8 offset:6144
    ds_read_b64_tr_b16 v[142:143], v8 offset:6656
    v_lshlrev_b32 v1, 16, v210
    v_and_b32 v2, 0xffff0000, v210
    v_add_f32 v100, v100, v1
    v_fmac_f32 v102, v1, v1
    s_waitcnt lgkmcnt(10)
    v_mfma_f32_32x32x16_bf16 v[32:47], v[132:135], v[164:167], v[32:47]
    ds_read_b128 v[220:223], v107 offset:0
    ds_read_b128 v[172:175], v111 offset:0
    v_add_f32 v101, v101, v2
    v_fmac_f32 v103, v2, v2
    v_lshlrev_b32 v1, 16, v211
    v_and_b32 v2, 0xffff0000, v211
    s_waitcnt lgkmcnt(10)
    v_mfma_f32_32x32x16_bf16 v[192:207], v[180:183], v[212:215], v[192:207]
    ds_read_b64_tr_b16 v[188:189], v83 offset:6144
    ds_read_b64_tr_b16 v[190:191], v83 offset:6656
    v_add_f32 v100, v100, v1
    v_fmac_f32 v102, v1, v1
    v_add_f32 v101, v101, v2
    v_fmac_f32 v103, v2, v2
    s_waitcnt lgkmcnt(9)
    v_mfma_f32_32x32x16_bf16 v[16:31], v[136:139], v[216:219], v[16:31]
    v_lshlrev_b32 v1, 16, v216
    v_and_b32 v2, 0xffff0000, v216
    v_add_f32 v100, v100, v1
    v_fmac_f32 v102, v1, v1
    s_waitcnt lgkmcnt(8)
    v_mfma_f32_32x32x16_bf16 v[32:47], v[136:139], v[168:171], v[32:47]
    v_add_f32 v101, v101, v2
    v_fmac_f32 v103, v2, v2
    v_lshlrev_b32 v1, 16, v217
    v_and_b32 v2, 0xffff0000, v217
    s_waitcnt lgkmcnt(6)
    v_mfma_f32_32x32x16_bf16 v[192:207], v[184:187], v[216:219], v[192:207]
    v_add_f32 v100, v100, v1
    v_fmac_f32 v102, v1, v1
    v_add_f32 v101, v101, v2
    v_fmac_f32 v103, v2, v2
    s_waitcnt lgkmcnt(3)
    v_mfma_f32_32x32x16_bf16 v[16:31], v[140:143], v[220:223], v[16:31]
    v_lshlrev_b32 v1, 16, v218
    v_and_b32 v2, 0xffff0000, v218
    v_add_f32 v100, v100, v1
    v_fmac_f32 v102, v1, v1
    s_waitcnt lgkmcnt(2)
    v_mfma_f32_32x32x16_bf16 v[32:47], v[140:143], v[172:175], v[32:47]
    v_add_f32 v101, v101, v2
    v_fmac_f32 v103, v2, v2
    v_lshlrev_b32 v1, 16, v219
    v_and_b32 v2, 0xffff0000, v219
    s_waitcnt lgkmcnt(0)
    v_mfma_f32_32x32x16_bf16 v[192:207], v[188:191], v[220:223], v[192:207]
    v_add_f32 v100, v100, v1
    v_fmac_f32 v102, v1, v1
    v_add_f32 v101, v101, v2
    v_fmac_f32 v103, v2, v2
    s_barrier
    ds_read_b64_tr_b16 v[128:129], v10 offset:32768
    ds_read_b64_tr_b16 v[130:131], v10 offset:33280
    ds_read_b128 v[224:227], v104 offset:32768
    ds_read_b128 v[160:163], v108 offset:32768
    ds_read_b64_tr_b16 v[176:177], v82 offset:32768
    ds_read_b64_tr_b16 v[178:179], v82 offset:33280
    ds_read_b64_tr_b16 v[132:133], v8 offset:34816
    ds_read_b64_tr_b16 v[134:135], v8 offset:35328
    ds_read_b128 v[228:231], v105 offset:32768
    ds_read_b128 v[164:167], v109 offset:32768
    ds_read_b64_tr_b16 v[180:181], v83 offset:34816
    ds_read_b64_tr_b16 v[182:183], v83 offset:35328
    s_waitcnt lgkmcnt(9)
    v_mfma_f32_32x32x16_bf16 v[16:31], v[128:131], v[224:227], v[16:31]
    ds_read_b64_tr_b16 v[136:137], v10 offset:36864
    ds_read_b64_tr_b16 v[138:139], v10 offset:37376
    v_lshlrev_b32 v1, 16, v224
    v_and_b32 v2, 0xffff0000, v224
    v_add_f32 v100, v100, v1
    v_fmac_f32 v102, v1, v1
    s_waitcnt lgkmcnt(10)
    v_mfma_f32_32x32x16_bf16 v[32:47], v[128:131], v[160:163], v[32:47]
    ds_read_b128 v[232:235], v106 offset:32768
    ds_read_b128 v[168:171], v110 offset:32768
    v_add_f32 v101, v101, v2
    v_fmac_f32 v103, v2, v2
    v_lshlrev_b32 v1, 16, v225
    v_and_b32 v2, 0xffff0000, v225
    s_waitcnt lgkmcnt(10)
    v_mfma_f32_32x32x16_bf16 v[192:207], v[176:179], v[224:227], v[192:207]
    ds_read_b64_tr_b16 v[184:185], v82 offset:36864
    ds_read_b64_tr_b16 v[186:187], v82 offset:37376
    v_add_f32 v100, v100, v1
    v_fmac_f32 v102, v1, v1
    v_add_f32 v101, v101, v2
    v_fmac_f32 v103, v2, v2
    s_waitcnt lgkmcnt(9)
    v_mfma_f32_32x32x16_bf16 v[16:31], v[132:135], v[228:231], v[16:31]
    ds_read_b64_tr_b16 v[140:141], v8 offset:38912
    ds_read_b64_tr_b16 v[142:143], v8 offset:39424
    v_lshlrev_b32 v1, 16, v226
    v_and_b32 v2, 0xffff0000, v226
    v_add_f32 v100, v100, v1
    v_fmac_f32 v102, v1, v1
    s_waitcnt lgkmcnt(10)
    v_mfma_f32_32x32x16_bf16 v[32:47], v[132:135], v[164:167], v[32:47]
    ds_read_b128 v[236:239], v107 offset:32768
    ds_read_b128 v[172:175], v111 offset:32768
    v_add_f32 v101, v101, v2
    v_fmac_f32 v103, v2, v2
    v_lshlrev_b32 v1, 16, v227
    v_and_b32 v2, 0xffff0000, v227
    s_waitcnt lgkmcnt(10)
    v_mfma_f32_32x32x16_bf16 v[192:207], v[180:183], v[228:231], v[192:207]
    ds_read_b64_tr_b16 v[188:189], v83 offset:38912
    ds_read_b64_tr_b16 v[190:191], v83 offset:39424
    v_add_f32 v100, v100, v1
    v_fmac_f32 v102, v1, v1
    v_add_f32 v101, v101, v2
    v_fmac_f32 v103, v2, v2
    s_waitcnt lgkmcnt(9)
    v_mfma_f32_32x32x16_bf16 v[16:31], v[136:139], v[232:235], v[16:31]
    v_lshlrev_b32 v1, 16, v232
    v_and_b32 v2, 0xffff0000, v232
    v_add_f32 v100, v100, v1
    v_fmac_f32 v102, v1, v1
    s_waitcnt lgkmcnt(8)
    v_mfma_f32_32x32x16_bf16 v[32:47], v[136:139], v[168:171], v[32:47]
    v_add_f32 v101, v101, v2
    v_fmac_f32 v103, v2, v2
    v_lshlrev_b32 v1, 16, v233
    v_and_b32 v2, 0xffff0000, v233
    s_waitcnt lgkmcnt(6)
    v_mfma_f32_32x32x16_bf16 v[192:207], v[184:187], v[232:235], v[192:207]
    v_add_f32 v100, v100, v1
    v_fmac_f32 v102, v1, v1
    v_add_f32 v101, v101, v2
    v_fmac_f32 v103, v2, v2
    s_waitcnt lgkmcnt(3)
    v_mfma_f32_32x32x16_bf16 v[16:31], v[140:143], v[236:239], v[16:31]
    v_lshlrev_b32 v1, 16, v234
    v_and_b32 v2, 0xffff0000, v234
    v_add_f32 v100, v100, v1
    v_fmac_f32 v102, v1, v1
    s_waitcnt lgkmcnt(2)
    v_mfma_f32_32x32x16_bf16 v[32:47], v[140:143], v[172:175], v[32:47]
    v_add_f32 v101, v101, v2
    v_fmac_f32 v103, v2, v2
    v_lshlrev_b32 v1, 16, v235
    v_and_b32 v2, 0xffff0000, v235
    s_waitcnt lgkmcnt(0)
    v_mfma_f32_32x32x16_bf16 v[192:207], v[188:191], v[236:239], v[192:207]
    v_add_f32 v100, v100, v1
    v_fmac_f32 v102, v1, v1
    v_add_f32 v101, v101, v2
    v_fmac_f32 v103, v2, v2
    v_lshrrev_b32 v1, 5, v0
    v_bfe_u32 v2, v0, 4, 1
    v_bfe_u32 v3, v0, 2, 2
    v_and_b32 v4, 3, v0
    v_lshl_add_u32 v5, v1, 2, v3
    v_lshlrev_b32 v5, 5, v5
    v_lshl_add_u32 v5, v4, 3, v5
    s_lshl_b32 s98, s3, 9
    s_lshl_b32 s99, s3, 9
    s_sub_u32 s99, s99, s98
    v_mul_lo_u32 v6, v2, s99
    v_add3_u32 v5, v5, v6, s98
    v_add_u32 v5, 157696, v5
    ds_read_b64_tr_b16 v[84:85], v5 offset:0
    ds_read_b64_tr_b16 v[86:87], v5 offset:256
    v_cmp_eq_u32 vcc, 0, v2
    s_waitcnt lgkmcnt(1)
    s_nop 0
    v_cndmask_b32 v112, 0, v84, vcc
    v_cndmask_b32 v116, v84, 0, vcc
    v_cndmask_b32 v113, 0, v85, vcc
    v_cndmask_b32 v117, v85, 0, vcc
    s_waitcnt lgkmcnt(0)
    v_cndmask_b32 v114, 0, v86, vcc
    v_cndmask_b32 v118, v86, 0, vcc
    v_cndmask_b32 v115, 0, v87, vcc
    v_cndmask_b32 v119, v87, 0, vcc
    s_waitcnt vmcnt(0)
    v_readfirstlane_b32 s96, v15
    s_nop 1
    s_add_u32 s96, s96, 0x01010101
    s_lshr_b32 s98, s96, 0
    v_mov_b32 v12, s98
    s_lshr_b32 s98, s96, 8
    v_mov_b32 v13, s98
    s_lshr_b32 s98, s96, 16
    v_mov_b32 v14, s98
    s_lshr_b32 s98, s96, 24
    v_mov_b32 v15, s98
    s_lshl_b32 s47, s6, 5
    s_add_u32 s47, s47, s44
    s_mul_i32 s47, s47, 8704
    s_add_u32 s47, s47, 1048576
    s_lshl_b32 s98, s45, 9
    s_lshl_b32 s99, s46, 8
    s_add_u32 s98, s98, 156672
    s_add_u32 s99, s99, s98
    v_lshlrev_b32 v96, 2, v0
    v_add_u32 v96, s99, v96
    v_and_b32 v3, 31, v0
    v_lshlrev_b32 v97, 2, v3
    v_add_u32 v97, s98, v97
    s_lshl_b32 s98, s3, 9
    s_add_u32 s98, s98, 159744
    v_lshlrev_b32 v98, 3, v0
    v_add_u32 v98, s98, v98
    v_lshrrev_b32 v4, 5, v0
    v_lshlrev_b32 v5, 4, v3
    v_lshl_add_u32 v5, v4, 8, v5
    s_lshl_b32 s98, s3, 11
    v_add_u32 v5, s98, v5
    s_lshl_b32 s98, s3, 7
    s_add_u32 s98, s98, 8192
    v_lshlrev_b32 v4, 4, v4
    v_add_u32 v4, s98, v4
    v_cmp_gt_u32 vcc, 16, v3
    v_mov_b32 v6, 512
    s_nop 0
    v_cndmask_b32 v99, v4, v5, vcc
    v_cndmask_b32 v9, 32, v6, vcc
    s_barrier
    v_add_u32 v104, 65536, v104
    v_add_u32 v105, 65536, v105
    v_add_u32 v106, 65536, v106
    v_add_u32 v107, 65536, v107
    v_add_u32 v108, 65536, v108
    v_add_u32 v109, 65536, v109
    v_add_u32 v110, 65536, v110
    v_add_u32 v111, 65536, v111
    v_add_u32 v10, 65536, v10
    v_add_u32 v8, 65536, v8
    v_add_u32 v82, 65536, v82
    v_add_u32 v83, 65536, v83
    ds_read_b64_tr_b16 v[128:129], v10 offset:0
    ds_read_b64_tr_b16 v[130:131], v10 offset:512
    ds_read_b128 v[208:211], v104 offset:0
    ds_read_b128 v[160:163], v108 offset:0
    ds_read_b64_tr_b16 v[176:177], v82 offset:0
    ds_read_b64_tr_b16 v[178:179], v82 offset:512
    ds_read_b64_tr_b16 v[132:133], v8 offset:2048
    ds_read_b64_tr_b16 v[134:135], v8 offset:2560
    ds_read_b128 v[212:215], v105 offset:0
    ds_read_b128 v[164:167], v109 offset:0
    ds_read_b64_tr_b16 v[180:181], v83 offset:2048
    ds_read_b64_tr_b16 v[182:183], v83 offset:2560
    s_waitcnt lgkmcnt(9)
    v_mfma_f32_32x32x16_bf16 v[16:31], v[128:131], v[208:211], v[16:31]
    ds_read_b64_tr_b16 v[136:137], v10 offset:4096
    ds_read_b64_tr_b16 v[138:139], v10 offset:4608
    v_lshlrev_b32 v1, 16, v208
    v_and_b32 v2, 0xffff0000, v208
    v_add_f32 v100, v100, v1
    v_fmac_f32 v102, v1, v1
    s_waitcnt lgkmcnt(10)
    v_mfma_f32_32x32x16_bf16 v[32:47], v[128:131], v[160:163], v[32:47]
    ds_read_b128 v[216:219], v106 offset:0
    ds_read_b128 v[168:171], v110 offset:0
    v_add_f32 v101, v101, v2
    v_fmac_f32 v103, v2, v2
    v_lshlrev_b32 v1, 16, v209
    v_and_b32 v2, 0xffff0000, v209
    s_waitcnt lgkmcnt(10)
    v_mfma_f32_32x32x16_bf16 v[192:207], v[176:179], v[208:211], v[192:207]
    ds_read_b64_tr_b16 v[184:185], v82 offset:4096
    ds_read_b64_tr_b16 v[186:187], v82 offset:4608
    v_add_f32 v100, v100, v1
    v_fmac_f32 v102, v1, v1
    v_add_f32 v101, v101, v2
    v_fmac_f32 v103, v2, v2
    s_waitcnt lgkmcnt(9)
    v_mfma_f32_32x32x16_bf16 v[16:31], v[132:135], v[212:215], v[16:31]
    ds_read_b64_tr_b16 v[140:141], v8 offset:6144
    ds_read_b64_tr_b16 v[142:143], v8 offset:6656
    v_lshlrev_b32 v1, 16, v210
    v_and_b32 v2, 0xffff0000, v210
    v_add_f32 v100, v100, v1
    v_fmac_f32 v102, v1, v1
    s_waitcnt lgkmcnt(10)
    v_mfma_f32_32x32x16_bf16 v[32:47], v[132:135], v[164:167], v[32:47]
    ds_read_b128 v[220:223], v107 offset:0
    ds_read_b128 v[172:175], v111 offset:0
    v_add_f32 v101, v101, v2
    v_fmac_f32 v103, v2, v2
    v_lshlrev_b32 v1, 16, v211
    v_and_b32 v2, 0xffff0000, v211
    s_waitcnt lgkmcnt(10)
    v_mfma_f32_32x32x16_bf16 v[192:207], v[180:183], v[212:215], v[192:207]
    ds_read_b64_tr_b16 v[188:189], v83 offset:6144
    ds_read_b64_tr_b16 v[190:191], v83 offset:6656
    v_add_f32 v100, v100, v1
    v_fmac_f32 v102, v1, v1
    v_add_f32 v101, v101, v2
    v_fmac_f32 v103, v2, v2
    s_waitcnt lgkmcnt(9)
    v_mfma_f32_32x32x16_bf16 v[16:31], v[136:139], v[216:219], v[16:31]
    v_lshlrev_b32 v1, 16, v216
    v_and_b32 v2, 0xffff0000, v216
    v_add_f32 v100, v100, v1
    v_fmac_f32 v102, v1, v1
    s_waitcnt lgkmcnt(8)
    v_mfma_f32_32x32x16_bf16 v[32:47], v[136:139], v[168:171], v[32:47]
    v_add_f32 v101, v101, v2
    v_fmac_f32 v103, v2, v2
    v_lshlrev_b32 v1, 16, v217
    v_and_b32 v2, 0xffff0000, v217
    s_waitcnt lgkmcnt(6)
    v_mfma_f32_32x32x16_bf16 v[192:207], v[184:187], v[216:219], v[192:207]
    v_add_f32 v100, v100, v1
    v_fmac_f32 v102, v1, v1
    v_add_f32 v101, v101, v2
    v_fmac_f32 v103, v2, v2
    s_waitcnt lgkmcnt(3)
    v_mfma_f32_32x32x16_bf16 v[16:31], v[140:143], v[220:223], v[16:31]
    v_lshlrev_b32 v1, 16, v218
    v_and_b32 v2, 0xffff0000, v218
    v_add_f32 v100, v100, v1
    v_fmac_f32 v102, v1, v1
    s_waitcnt lgkmcnt(2)
    v_mfma_f32_32x32x16_bf16 v[32:47], v[140:143], v[172:175], v[32:47]
    v_add_f32 v101, v101, v2
    v_fmac_f32 v103, v2, v2
    v_lshlrev_b32 v1, 16, v219
    v_and_b32 v2, 0xffff0000, v219
    s_waitcnt lgkmcnt(0)
    v_mfma_f32_32x32x16_bf16 v[192:207], v[188:191], v[220:223], v[192:207]
    v_add_f32 v100, v100, v1
    v_fmac_f32 v102, v1, v1
    v_add_f32 v101, v101, v2
    v_fmac_f32 v103, v2, v2
    s_barrier
    ds_read_b64_tr_b16 v[128:129], v10 offset:32768
    ds_read_b64_tr_b16 v[130:131], v10 offset:33280
    ds_read_b128 v[224:227], v104 offset:32768
    ds_read_b128 v[160:163], v108 offset:32768
    ds_read_b64_tr_b16 v[176:177], v82 offset:32768
    ds_read_b64_tr_b16 v[178:179], v82 offset:33280
    ds_read_b64_tr_b16 v[132:133], v8 offset:34816
    ds_read_b64_tr_b16 v[134:135], v8 offset:35328
    ds_read_b128 v[228:231], v105 offset:32768
    ds_read_b128 v[164:167], v109 offset:32768
    ds_read_b64_tr_b16 v[180:181], v83 offset:34816
    ds_read_b64_tr_b16 v[182:183], v83 offset:35328
    s_waitcnt lgkmcnt(9)
    v_mfma_f32_32x32x16_bf16 v[16:31], v[128:131], v[224:227], v[16:31]
    ds_read_b64_tr_b16 v[136:137], v10 offset:36864
    ds_read_b64_tr_b16 v[138:139], v10 offset:37376
    v_lshlrev_b32 v1, 16, v224
    v_and_b32 v2, 0xffff0000, v224
    v_add_f32 v100, v100, v1
    v_fmac_f32 v102, v1, v1
    s_waitcnt lgkmcnt(10)
    v_mfma_f32_32x32x16_bf16 v[32:47], v[128:131], v[160:163], v[32:47]
    ds_read_b128 v[232:235], v106 offset:32768
    ds_read_b128 v[168:171], v110 offset:32768
    v_add_f32 v101, v101, v2
    v_fmac_f32 v103, v2, v2
    v_lshlrev_b32 v1, 16, v225
    v_and_b32 v2, 0xffff0000, v225
    s_waitcnt lgkmcnt(10)
    v_mfma_f32_32x32x16_bf16 v[192:207], v[176:179], v[224:227], v[192:207]
    ds_read_b64_tr_b16 v[184:185], v82 offset:36864
    ds_read_b64_tr_b16 v[186:187], v82 offset:37376
    v_add_f32 v100, v100, v1
    v_fmac_f32 v102, v1, v1
    v_add_f32 v101, v101, v2
    v_fmac_f32 v103, v2, v2
    s_waitcnt lgkmcnt(9)
    v_mfma_f32_32x32x16_bf16 v[16:31], v[132:135], v[228:231], v[16:31]
    ds_read_b64_tr_b16 v[140:141], v8 offset:38912
    ds_read_b64_tr_b16 v[142:143], v8 offset:39424
    v_lshlrev_b32 v1, 16, v226
    v_and_b32 v2, 0xffff0000, v226
    v_add_f32 v100, v100, v1
    v_fmac_f32 v102, v1, v1
    s_waitcnt lgkmcnt(10)
    v_mfma_f32_32x32x16_bf16 v[32:47], v[132:135], v[164:167], v[32:47]
    ds_read_b128 v[236:239], v107 offset:32768
    ds_read_b128 v[172:175], v111 offset:32768
    v_add_f32 v101, v101, v2
    v_fmac_f32 v103, v2, v2
    v_lshlrev_b32 v1, 16, v227
    v_and_b32 v2, 0xffff0000, v227
    s_waitcnt lgkmcnt(10)
    v_mfma_f32_32x32x16_bf16 v[192:207], v[180:183], v[228:231], v[192:207]
    ds_read_b64_tr_b16 v[188:189], v83 offset:38912
    ds_read_b64_tr_b16 v[190:191], v83 offset:39424
    v_add_f32 v100, v100, v1
    v_fmac_f32 v102, v1, v1
    v_add_f32 v101, v101, v2
    v_fmac_f32 v103, v2, v2
    s_waitcnt lgkmcnt(9)
    v_mfma_f32_32x32x16_bf16 v[16:31], v[136:139], v[232:235], v[16:31]
    v_lshlrev_b32 v1, 16, v232
    v_and_b32 v2, 0xffff0000, v232
    v_add_f32 v100, v100, v1
    v_fmac_f32 v102, v1, v1
    s_waitcnt lgkmcnt(8)
    v_mfma_f32_32x32x16_bf16 v[32:47], v[136:139], v[168:171], v[32:47]
    v_add_f32 v101, v101, v2
    v_fmac_f32 v103, v2, v2
    v_lshlrev_b32 v1, 16, v233
    v_and_b32 v2, 0xffff0000, v233
    s_waitcnt lgkmcnt(6)
    v_mfma_f32_32x32x16_bf16 v[192:207], v[184:187], v[232:235], v[192:207]
    v_add_f32 v100, v100, v1
    v_fmac_f32 v102, v1, v1
    v_add_f32 v101, v101, v2
    v_fmac_f32 v103, v2, v2
    s_waitcnt lgkmcnt(3)
    v_mfma_f32_32x32x16_bf16 v[16:31], v[140:143], v[236:239], v[16:31]
    v_lshlrev_b32 v1, 16, v234
    v_and_b32 v2, 0xffff0000, v234
    v_add_f32 v100, v100, v1
    v_fmac_f32 v102, v1, v1
    s_waitcnt lgkmcnt(2)
    v_mfma_f32_32x32x16_bf16 v[32:47], v[140:143], v[172:175], v[32:47]
    v_add_f32 v101, v101, v2
    v_fmac_f32 v103, v2, v2
    v_lshlrev_b32 v1, 16, v235
    v_and_b32 v2, 0xffff0000, v235
    s_waitcnt lgkmcnt(0)
    v_mfma_f32_32x32x16_bf16 v[192:207], v[188:191], v[236:239], v[192:207]
    v_add_f32 v100, v100, v1
    v_fmac_f32 v102, v1, v1
    v_add_f32 v101, v101, v2
    v_fmac_f32 v103, v2, v2
    s_barrier
    v_subrev_u32 v104, 65536, v104
    v_subrev_u32 v105, 65536, v105
    v_subrev_u32 v106, 65536, v106
    v_subrev_u32 v107, 65536, v107
    v_subrev_u32 v108, 65536, v108
    v_subrev_u32 v109, 65536, v109
    v_subrev_u32 v110, 65536, v110
    v_subrev_u32 v111, 65536, v111
    v_subrev_u32 v10, 65536, v10
    v_subrev_u32 v8, 65536, v8
    v_subrev_u32 v82, 65536, v82
    v_subrev_u32 v83, 65536, v83
    ds_read_b64_tr_b16 v[128:129], v10 offset:0
    ds_read_b64_tr_b16 v[130:131], v10 offset:512
    ds_read_b128 v[208:211], v104 offset:0
    ds_read_b128 v[160:163], v108 offset:0
    ds_read_b64_tr_b16 v[176:177], v82 offset:0
    ds_read_b64_tr_b16 v[178:179], v82 offset:512
    ds_read_b64_tr_b16 v[132:133], v8 offset:2048
    ds_read_b64_tr_b16 v[134:135], v8 offset:2560
    ds_read_b128 v[212:215], v105 offset:0
    ds_read_b128 v[164:167], v109 offset:0
    ds_read_b64_tr_b16 v[180:181], v83 offset:2048
    ds_read_b64_tr_b16 v[182:183], v83 offset:2560
    s_waitcnt lgkmcnt(9)
    v_mfma_f32_32x32x16_bf16 v[16:31], v[128:131], v[208:211], v[16:31]
    ds_read_b64_tr_b16 v[136:137], v10 offset:4096
    ds_read_b64_tr_b16 v[138:139], v10 offset:4608
    v_lshlrev_b32 v1, 16, v208
    v_and_b32 v2, 0xffff0000, v208
    v_add_f32 v100, v100, v1
    v_fmac_f32 v102, v1, v1
    s_waitcnt lgkmcnt(10)
    v_mfma_f32_32x32x16_bf16 v[32:47], v[128:131], v[160:163], v[32:47]
    ds_read_b128 v[216:219], v106 offset:0
    ds_read_b128 v[168:171], v110 offset:0
    v_add_f32 v101, v101, v2
    v_fmac_f32 v103, v2, v2
    v_lshlrev_b32 v1, 16, v209
    v_and_b32 v2, 0xffff0000, v209
    s_waitcnt lgkmcnt(10)
    v_mfma_f32_32x32x16_bf16 v[192:207], v[176:179], v[208:211], v[192:207]
    ds_read_b64_tr_b16 v[184:185], v82 offset:4096
    ds_read_b64_tr_b16 v[186:187], v82 offset:4608
    v_add_f32 v100, v100, v1
    v_fmac_f32 v102, v1, v1
    v_add_f32 v101, v101, v2
    v_fmac_f32 v103, v2, v2
    s_waitcnt lgkmcnt(9)
    v_mfma_f32_32x32x16_bf16 v[16:31], v[132:135], v[212:215], v[16:31]
    ds_read_b64_tr_b16 v[140:141], v8 offset:6144
    ds_read_b64_tr_b16 v[142:143], v8 offset:6656
    v_lshlrev_b32 v1, 16, v210
    v_and_b32 v2, 0xffff0000, v210
    v_add_f32 v100, v100, v1
    v_fmac_f32 v102, v1, v1
    s_waitcnt lgkmcnt(10)
    v_mfma_f32_32x32x16_bf16 v[32:47], v[132:135], v[164:167], v[32:47]
    ds_read_b128 v[220:223], v107 offset:0
    ds_read_b128 v[172:175], v111 offset:0
    v_add_f32 v101, v101, v2
    v_fmac_f32 v103, v2, v2
    v_lshlrev_b32 v1, 16, v211
    v_and_b32 v2, 0xffff0000, v211
    s_waitcnt lgkmcnt(10)
    v_mfma_f32_32x32x16_bf16 v[192:207], v[180:183], v[212:215], v[192:207]
    ds_read_b64_tr_b16 v[188:189], v83 offset:6144
    ds_read_b64_tr_b16 v[190:191], v83 offset:6656
    v_add_f32 v100, v100, v1
    v_fmac_f32 v102, v1, v1
    v_add_f32 v101, v101, v2
    v_fmac_f32 v103, v2, v2
    s_waitcnt lgkmcnt(9)
    v_mfma_f32_32x32x16_bf16 v[16:31], v[136:139], v[216:219], v[16:31]
    ds_read_b64_tr_b16 v[128:129], v10 offset:32768
    ds_read_b64_tr_b16 v[130:131], v10 offset:33280
    v_lshlrev_b32 v1, 16, v216
    v_and_b32 v2, 0xffff0000, v216
    v_add_f32 v100, v100, v1
    v_fmac_f32 v102, v1, v1
    s_waitcnt lgkmcnt(10)
    v_mfma_f32_32x32x16_bf16 v[32:47], v[136:139], v[168:171], v[32:47]
    ds_read_b128 v[224:227], v104 offset:32768
    ds_read_b128 v[160:163], v108 offset:32768
    v_add_f32 v101, v101, v2
    v_fmac_f32 v103, v2, v2
    v_lshlrev_b32 v1, 16, v217
    v_and_b32 v2, 0xffff0000, v217
    s_waitcnt lgkmcnt(10)
    v_mfma_f32_32x32x16_bf16 v[192:207], v[184:187], v[216:219], v[192:207]
    ds_read_b64_tr_b16 v[176:177], v82 offset:32768
    ds_read_b64_tr_b16 v[178:179], v82 offset:33280
    v_add_f32 v100, v100, v1
    v_fmac_f32 v102, v1, v1
    v_add_f32 v101, v101, v2
    v_fmac_f32 v103, v2, v2
    s_waitcnt lgkmcnt(9)
    v_mfma_f32_32x32x16_bf16 v[16:31], v[140:143], v[220:223], v[16:31]
    ds_read_b64_tr_b16 v[132:133], v8 offset:34816
    ds_read_b64_tr_b16 v[134:135], v8 offset:35328
    v_lshlrev_b32 v1, 16, v218
    v_and_b32 v2, 0xffff0000, v218
    v_add_f32 v100, v100, v1
    v_fmac_f32 v102, v1, v1
    s_waitcnt lgkmcnt(10)
    v_mfma_f32_32x32x16_bf16 v[32:47], v[140:143], v[172:175], v[32:47]
    ds_read_b128 v[228:231], v105 offset:32768
    ds_read_b128 v[164:167], v109 offset:32768
    v_add_f32 v101, v101, v2
    v_fmac_f32 v103, v2, v2
    v_lshlrev_b32 v1, 16, v219
    v_and_b32 v2, 0xffff0000, v219
    s_waitcnt lgkmcnt(10)
    v_mfma_f32_32x32x16_bf16 v[192:207], v[188:191], v[220:223], v[192:207]
    ds_read_b64_tr_b16 v[180:181], v83 offset:34816
    ds_read_b64_tr_b16 v[182:183], v83 offset:35328
    v_add_f32 v100, v100, v1
    v_fmac_f32 v102, v1, v1
    v_add_f32 v101, v101, v2
    v_fmac_f32 v103, v2, v2
    s_barrier
    s_waitcnt lgkmcnt(9)
    v_mfma_f32_32x32x16_bf16 v[16:31], v[128:131], v[224:227], v[16:31]
    ds_read_b64_tr_b16 v[136:137], v10 offset:36864
    ds_read_b64_tr_b16 v[138:139], v10 offset:37376
    v_lshlrev_b32 v1, 16, v224
    v_and_b32 v2, 0xffff0000, v224
    v_add_f32 v100, v100, v1
    v_fmac_f32 v102, v1, v1
    s_waitcnt lgkmcnt(10)
    v_mfma_f32_32x32x16_bf16 v[32:47], v[128:131], v[160:163], v[32:47]
    ds_read_b128 v[232:235], v106 offset:32768
    ds_read_b128 v[168:171], v110 offset:32768
    v_add_f32 v101, v101, v2
    v_fmac_f32 v103, v2, v2
    v_lshlrev_b32 v1, 16, v225
    v_and_b32 v2, 0xffff0000, v225
    s_waitcnt lgkmcnt(10)
    v_mfma_f32_32x32x16_bf16 v[192:207], v[176:179], v[224:227], v[192:207]
    ds_read_b64_tr_b16 v[184:185], v82 offset:36864
    ds_read_b64_tr_b16 v[186:187], v82 offset:37376
    v_add_f32 v100, v100, v1
    v_fmac_f32 v102, v1, v1
    v_add_f32 v101, v101, v2
    v_fmac_f32 v103, v2, v2
    s_waitcnt lgkmcnt(9)
    v_mfma_f32_32x32x16_bf16 v[16:31], v[132:135], v[228:231], v[16:31]
    ds_read_b64_tr_b16 v[140:141], v8 offset:38912
    ds_read_b64_tr_b16 v[142:143], v8 offset:39424
    v_lshlrev_b32 v1, 16, v226
    v_and_b32 v2, 0xffff0000, v226
    v_add_f32 v100, v100, v1
    v_fmac_f32 v102, v1, v1
    s_waitcnt lgkmcnt(10)
    v_mfma_f32_32x32x16_bf16 v[32:47], v[132:135], v[164:167], v[32:47]
    ds_read_b128 v[236:239], v107 offset:32768
    ds_read_b128 v[172:175], v111 offset:32768
    v_add_f32 v101, v101, v2
    v_fmac_f32 v103, v2, v2
    v_lshlrev_b32 v1, 16, v227
    v_and_b32 v2, 0xffff0000, v227
    s_waitcnt lgkmcnt(10)
    v_mfma_f32_32x32x16_bf16 v[192:207], v[180:183], v[228:231], v[192:207]
    ds_read_b64_tr_b16 v[188:189], v83 offset:38912
    ds_read_b64_tr_b16 v[190:191], v83 offset:39424
    v_add_f32 v100, v100, v1
    v_fmac_f32 v102, v1, v1
    v_add_f32 v101, v101, v2
    v_fmac_f32 v103, v2, v2
    v_add_u32 v104, 65536, v104
    v_add_u32 v105, 65536, v105
    v_add_u32 v106, 65536, v106
    v_add_u32 v107, 65536, v107
    v_add_u32 v108, 65536, v108
    v_add_u32 v109, 65536, v109
    v_add_u32 v110, 65536, v110
    v_add_u32 v111, 65536, v111
    v_add_u32 v10, 65536, v10
    v_add_u32 v8, 65536, v8
    v_add_u32 v82, 65536, v82
    v_add_u32 v83, 65536, v83
    s_waitcnt lgkmcnt(9)
    v_mfma_f32_32x32x16_bf16 v[16:31], v[136:139], v[232:235], v[16:31]
    ds_read_b64_tr_b16 v[128:129], v10 offset:0
    ds_read_b64_tr_b16 v[130:131], v10 offset:512
    v_lshlrev_b32 v1, 16, v232
    v_and_b32 v2, 0xffff0000, v232
    v_add_f32 v100, v100, v1
    v_fmac_f32 v102, v1, v1
    s_waitcnt lgkmcnt(10)
    v_mfma_f32_32x32x16_bf16 v[32:47], v[136:139], v[168:171], v[32:47]
    ds_read_b128 v[208:211], v104 offset:0
    ds_read_b128 v[160:163], v108 offset:0
    v_add_f32 v101, v101, v2
    v_fmac_f32 v103, v2, v2
    v_lshlrev_b32 v1, 16, v233
    v_and_b32 v2, 0xffff0000, v233
    s_waitcnt lgkmcnt(10)
    v_mfma_f32_32x32x16_bf16 v[192:207], v[184:187], v[232:235], v[192:207]
    ds_read_b64_tr_b16 v[176:177], v82 offset:0
    ds_read_b64_tr_b16 v[178:179], v82 offset:512
    v_add_f32 v100, v100, v1
    v_fmac_f32 v102, v1, v1
    v_add_f32 v101, v101, v2
    v_fmac_f32 v103, v2, v2
    s_waitcnt lgkmcnt(9)
    v_mfma_f32_32x32x16_bf16 v[16:31], v[140:143], v[236:239], v[16:31]
    ds_read_b64_tr_b16 v[132:133], v8 offset:2048
    ds_read_b64_tr_b16 v[134:135], v8 offset:2560
    v_lshlrev_b32 v1, 16, v234
    v_and_b32 v2, 0xffff0000, v234
    v_add_f32 v100, v100, v1
    v_fmac_f32 v102, v1, v1
    s_waitcnt lgkmcnt(10)
    v_mfma_f32_32x32x16_bf16 v[32:47], v[140:143], v[172:175], v[32:47]
    ds_read_b128 v[212:215], v105 offset:0
    ds_read_b128 v[164:167], v109 offset:0
    v_add_f32 v101, v101, v2
    v_fmac_f32 v103, v2, v2
    v_lshlrev_b32 v1, 16, v235
    v_and_b32 v2, 0xffff0000, v235
    s_waitcnt lgkmcnt(10)
    v_mfma_f32_32x32x16_bf16 v[192:207], v[188:191], v[236:239], v[192:207]
    ds_read_b64_tr_b16 v[180:181], v83 offset:2048
    ds_read_b64_tr_b16 v[182:183], v83 offset:2560
    v_add_f32 v100, v100, v1
    v_fmac_f32 v102, v1, v1
    v_add_f32 v101, v101, v2
    v_fmac_f32 v103, v2, v2
    s_barrier
    s_waitcnt lgkmcnt(9)
    v_mfma_f32_32x32x16_bf16 v[16:31], v[128:131], v[208:211], v[16:31]
    ds_read_b64_tr_b16 v[136:137], v10 offset:4096
    ds_read_b64_tr_b16 v[138:139], v10 offset:4608
    v_lshlrev_b32 v1, 16, v208
    v_and_b32 v2, 0xffff0000, v208
    v_add_f32 v100, v100, v1
    v_fmac_f32 v102, v1, v1
    s_waitcnt lgkmcnt(10)
    v_mfma_f32_32x32x16_bf16 v[32:47], v[128:131], v[160:163], v[32:47]
    ds_read_b128 v[216:219], v106 offset:0
    ds_read_b128 v[168:171], v110 offset:0
    v_add_f32 v101, v101, v2
    v_fmac_f32 v103, v2, v2
    v_lshlrev_b32 v1, 16, v209
    v_and_b32 v2, 0xffff0000, v209
    s_waitcnt lgkmcnt(10)
    v_mfma_f32_32x32x16_bf16 v[192:207], v[176:179], v[208:211], v[192:207]
    ds_read_b64_tr_b16 v[184:185], v82 offset:4096
    ds_read_b64_tr_b16 v[186:187], v82 offset:4608
    v_add_f32 v100, v100, v1
    v_fmac_f32 v102, v1, v1
    v_add_f32 v101, v101, v2
    v_fmac_f32 v103, v2, v2
    s_waitcnt lgkmcnt(9)
    v_mfma_f32_32x32x16_bf16 v[16:31], v[132:135], v[212:215], v[16:31]
    ds_read_b64_tr_b16 v[140:141], v8 offset:6144
    ds_read_b64_tr_b16 v[142:143], v8 offset:6656
    v_lshlrev_b32 v1, 16, v210
    v_and_b32 v2, 0xffff0000, v210
    v_add_f32 v100, v100, v1
    v_fmac_f32 v102, v1, v1
    s_waitcnt lgkmcnt(10)
    v_mfma_f32_32x32x16_bf16 v[32:47], v[132:135], v[164:167], v[32:47]
    ds_read_b128 v[220:223], v107 offset:0
    ds_read_b128 v[172:175], v111 offset:0
    v_add_f32 v101, v101, v2
    v_fmac_f32 v103, v2, v2
    v_lshlrev_b32 v1, 16, v211
    v_and_b32 v2, 0xffff0000, v211
    s_waitcnt lgkmcnt(10)
    v_mfma_f32_32x32x16_bf16 v[192:207], v[180:183], v[212:215], v[192:207]
    ds_read_b64_tr_b16 v[188:189], v83 offset:6144
    ds_read_b64_tr_b16 v[190:191], v83 offset:6656
    v_add_f32 v100, v100, v1
    v_fmac_f32 v102, v1, v1
    v_add_f32 v101, v101, v2
    v_fmac_f32 v103, v2, v2
    s_waitcnt lgkmcnt(9)
    v_mfma_f32_32x32x16_bf16 v[16:31], v[136:139], v[216:219], v[16:31]
    ds_read_b64_tr_b16 v[128:129], v10 offset:32768
    ds_read_b64_tr_b16 v[130:131], v10 offset:33280
    v_lshlrev_b32 v1, 16, v216
    v_and_b32 v2, 0xffff0000, v216
    v_add_f32 v100, v100, v1
    v_fmac_f32 v102, v1, v1
    s_waitcnt lgkmcnt(10)
    v_mfma_f32_32x32x16_bf16 v[32:47], v[136:139], v[168:171], v[32:47]
    ds_read_b128 v[224:227], v104 offset:32768
    ds_read_b128 v[160:163], v108 offset:32768
    v_add_f32 v101, v101, v2
    v_fmac_f32 v103, v2, v2
    v_lshlrev_b32 v1, 16, v217
    v_and_b32 v2, 0xffff0000, v217
    s_waitcnt lgkmcnt(10)
    v_mfma_f32_32x32x16_bf16 v[192:207], v[184:187], v[216:219], v[192:207]
    ds_read_b64_tr_b16 v[176:177], v82 offset:32768
    ds_read_b64_tr_b16 v[178:179], v82 offset:33280
    v_add_f32 v100, v100, v1
    v_fmac_f32 v102, v1, v1
    v_add_f32 v101, v101, v2
    v_fmac_f32 v103, v2, v2
    s_waitcnt lgkmcnt(9)
    v_mfma_f32_32x32x16_bf16 v[16:31], v[140:143], v[220:223], v[16:31]
    ds_read_b64_tr_b16 v[132:133], v8 offset:34816
    ds_read_b64_tr_b16 v[134:135], v8 offset:35328
    v_lshlrev_b32 v1, 16, v218
    v_and_b32 v2, 0xffff0000, v218
    v_add_f32 v100, v100, v1
    v_fmac_f32 v102, v1, v1
    s_waitcnt lgkmcnt(10)
    v_mfma_f32_32x32x16_bf16 v[32:47], v[140:143], v[172:175], v[32:47]
    ds_read_b128 v[228:231], v105 offset:32768
    ds_read_b128 v[164:167], v109 offset:32768
    v_add_f32 v101, v101, v2
    v_fmac_f32 v103, v2, v2
    v_lshlrev_b32 v1, 16, v219
    v_and_b32 v2, 0xffff0000, v219
    s_waitcnt lgkmcnt(10)
    v_mfma_f32_32x32x16_bf16 v[192:207], v[188:191], v[220:223], v[192:207]
    ds_read_b64_tr_b16 v[180:181], v83 offset:34816
    ds_read_b64_tr_b16 v[182:183], v83 offset:35328
    v_add_f32 v100, v100, v1
    v_fmac_f32 v102, v1, v1
    v_add_f32 v101, v101, v2
    v_fmac_f32 v103, v2, v2
    s_waitcnt lgkmcnt(9)
    v_mfma_f32_32x32x16_bf16 v[16:31], v[128:131], v[224:227], v[16:31]
    ds_read_b64_tr_b16 v[136:137], v10 offset:36864
    ds_read_b64_tr_b16 v[138:139], v10 offset:37376
    v_lshlrev_b32 v1, 16, v224
    v_and_b32 v2, 0xffff0000, v224
    v_add_f32 v100, v100, v1
    v_fmac_f32 v102, v1, v1
    s_waitcnt lgkmcnt(10)
    v_mfma_f32_32x32x16_bf16 v[32:47], v[128:131], v[160:163], v[32:47]
    ds_read_b128 v[232:235], v106 offset:32768
    ds_read_b128 v[168:171], v110 offset:32768
    v_add_f32 v101, v101, v2
    v_fmac_f32 v103, v2, v2
    v_lshlrev_b32 v1, 16, v225
    v_and_b32 v2, 0xffff0000, v225
    s_waitcnt lgkmcnt(10)
    v_mfma_f32_32x32x16_bf16 v[192:207], v[176:179], v[224:227], v[192:207]
    ds_read_b64_tr_b16 v[184:185], v82 offset:36864
    ds_read_b64_tr_b16 v[186:187], v82 offset:37376
    v_add_f32 v100, v100, v1
    v_fmac_f32 v102, v1, v1
    v_add_f32 v101, v101, v2
    v_fmac_f32 v103, v2, v2
    s_waitcnt lgkmcnt(9)
    v_mfma_f32_32x32x16_bf16 v[16:31], v[132:135], v[228:231], v[16:31]
    ds_read_b64_tr_b16 v[140:141], v8 offset:38912
    ds_read_b64_tr_b16 v[142:143], v8 offset:39424
    v_lshlrev_b32 v1, 16, v226
    v_and_b32 v2, 0xffff0000, v226
    v_add_f32 v100, v100, v1
    v_fmac_f32 v102, v1, v1
    s_waitcnt lgkmcnt(10)
    v_mfma_f32_32x32x16_bf16 v[32:47], v[132:135], v[164:167], v[32:47]
    ds_read_b128 v[236:239], v107 offset:32768
    ds_read_b128 v[172:175], v111 offset:32768
    v_add_f32 v101, v101, v2
    v_fmac_f32 v103, v2, v2
    v_lshlrev_b32 v1, 16, v227
    v_and_b32 v2, 0xffff0000, v227
    s_waitcnt lgkmcnt(10)
    v_mfma_f32_32x32x16_bf16 v[192:207], v[180:183], v[228:231], v[192:207]
    ds_read_b64_tr_b16 v[188:189], v83 offset:38912
    ds_read_b64_tr_b16 v[190:191], v83 offset:39424
    v_add_f32 v100, v100, v1
    v_fmac_f32 v102, v1, v1
    v_add_f32 v101, v101, v2
    v_fmac_f32 v103, v2, v2
    s_waitcnt lgkmcnt(9)
    v_mfma_f32_32x32x16_bf16 v[16:31], v[136:139], v[232:235], v[16:31]
    v_lshlrev_b32 v1, 16, v232
    v_and_b32 v2, 0xffff0000, v232
    v_add_f32 v100, v100, v1
    v_fmac_f32 v102, v1, v1
    s_waitcnt lgkmcnt(8)
    v_mfma_f32_32x32x16_bf16 v[32:47], v[136:139], v[168:171], v[32:47]
    v_add_f32 v101, v101, v2
    v_fmac_f32 v103, v2, v2
    v_lshlrev_b32 v1, 16, v233
    v_and_b32 v2, 0xffff0000, v233
    s_waitcnt lgkmcnt(6)
    v_mfma_f32_32x32x16_bf16 v[192:207], v[184:187], v[232:235], v[192:207]
    v_add_f32 v100, v100, v1
    v_fmac_f32 v102, v1, v1
    v_add_f32 v101, v101, v2
    v_fmac_f32 v103, v2, v2
    s_waitcnt lgkmcnt(3)
    v_mfma_f32_32x32x16_bf16 v[16:31], v[140:143], v[236:239], v[16:31]
    v_lshlrev_b32 v1, 16, v234
    v_and_b32 v2, 0xffff0000, v234
    v_add_f32 v100, v100, v1
    v_fmac_f32 v102, v1, v1
    s_waitcnt lgkmcnt(2)
    v_mfma_f32_32x32x16_bf16 v[32:47], v[140:143], v[172:175], v[32:47]
    v_add_f32 v101, v101, v2
    v_fmac_f32 v103, v2, v2
    v_lshlrev_b32 v1, 16, v235
    v_and_b32 v2, 0xffff0000, v235
    s_waitcnt lgkmcnt(0)
    v_mfma_f32_32x32x16_bf16 v[192:207], v[188:191], v[236:239], v[192:207]
    v_add_f32 v100, v100, v1
    v_fmac_f32 v102, v1, v1
    v_add_f32 v101, v101, v2
    v_fmac_f32 v103, v2, v2
    v_add_f32 v100, v100, v101
    v_add_f32 v101, v102, v103
    v_mov_b32 v1, v97
    v_xor_b32 v2, 512, v97
    v_permlane32_swap_b32 v100, v101
    v_mov_b32 v3, v98
    v_add_f32 v100, v100, v101
    ds_write_b32 v96, v100
    v_mov_b32 v108, v99
    v_add_u32 v109, v108, v9
    v_add_u32 v110, v109, v9
    v_add_u32 v111, v110, v9
    v_mov_b32 v98, 0
    v_mov_b32 v99, 0
    v_mov_b32 v102, 0
    v_mov_b32 v103, 0
    v_mov_b32 v9, v80
    s_mov_b64 exec, 1
    ds_add_u32 v11, v7 offset:28
    s_mov_b64 exec, -1
    v_mov_b32 v94, 0
    v_mov_b32 v95, 0
    s_mov_b32 s95, 0
C_cw_1:
    ds_read_b32 v4, v11 offset:28
    s_add_u32 s95, s95, 1
    s_cmp_gt_u32 s95, 16777216
    s_cbranch_scc1 C_cb_2
    s_waitcnt lgkmcnt(0)
    v_readfirstlane_b32 s98, v4
    s_nop 1
    s_cmp_lt_u32 s98, 5
    s_nop 0
    s_cbranch_scc1 C_cw_1
C_cb_2:
    s_waitcnt lgkmcnt(0)
    ds_read_b64 v[92:93], v3
    ds_read2_b32 v[80:81], v1 offset0:0 offset1:32
    ds_read2_b32 v[82:83], v1 offset0:64 offset1:96
    ds_read2_b32 v[84:85], v2 offset0:0 offset1:32
    ds_read2_b32 v[86:87], v2 offset0:64 offset1:96
    s_waitcnt lgkmcnt(2)
    v_pk_add_f32 v[80:81], v[80:81], v[82:83]
    s_waitcnt lgkmcnt(0)
    v_pk_add_f32 v[84:85], v[84:85], v[86:87]
    v_mul_f32 v80, 0xbb000000, v80
    v_and_b32 v82, 0xffff0000, v80
    v_sub_f32 v97, v80, v82
    v_cvt_pk_bf16_f32 v97, v97, 0
    v_cvt_pk_bf16_f32 v96, v82, v82
    v_mul_f32 v84, 0xbb000000, v84
    v_and_b32 v86, 0xffff0000, v84
    v_sub_f32 v101, v84, v86
    v_cvt_pk_bf16_f32 v101, v101, 0
    v_cvt_pk_bf16_f32 v100, v86, v86
    v_mul_f32 v81, 0x3b000000, v81
    v_fma_f32 v81, -v80, v80, v81
    v_add_f32 v81, 0x3727c5ac, v81
    v_mul_f32 v85, 0x3b000000, v85
    v_fma_f32 v85, -v84, v84, v85
    v_add_f32 v85, 0x3727c5ac, v85
    v_mfma_f32_32x32x16_bf16 v[16:31], v[92:95], v[96:99], v[16:31]
    v_mfma_f32_32x32x16_bf16 v[32:47], v[92:95], v[100:103], v[32:47]
    v_rsq_f32 v104, v81
    v_rsq_f32 v106, v85
    v_mul_f32 v105, 0x3fb8aa3b, v104
    v_mul_f32 v107, 0x3fb8aa3b, v106
    s_nop 6
    v_cvt_pk_bf16_f32 v80, v16, v17
    v_cvt_pk_bf16_f32 v81, v18, v19
    v_cvt_pk_bf16_f32 v82, v20, v21
    v_cvt_pk_bf16_f32 v83, v22, v23
    v_cvt_pk_bf16_f32 v84, v32, v33
    v_cvt_pk_bf16_f32 v85, v34, v35
    v_cvt_pk_bf16_f32 v86, v36, v37
    v_cvt_pk_bf16_f32 v87, v38, v39
    v_pk_mul_f32 v[24:25], v[24:25], v[104:105] op_sel:[0,0] op_sel_hi:[1,0]
    v_pk_mul_f32 v[26:27], v[26:27], v[104:105] op_sel:[0,0] op_sel_hi:[1,0]
    v_pk_mul_f32 v[28:29], v[28:29], v[104:105] op_sel:[0,0] op_sel_hi:[1,0]
    v_pk_mul_f32 v[30:31], v[30:31], v[104:105] op_sel:[0,0] op_sel_hi:[1,0]
    v_cvt_pk_bf16_f32 v88, v24, v25
    v_cvt_pk_bf16_f32 v89, v26, v27
    v_cvt_pk_bf16_f32 v90, v28, v29
    v_cvt_pk_bf16_f32 v91, v30, v31
    v_mfma_f32_32x32x16_bf16 v[16:31], v[112:115], v[80:83], 0
    v_mfma_f32_32x32x16_bf16 v[16:31], v[116:119], v[84:87], v[16:31]
    v_pk_mul_f32 v[40:41], v[40:41], v[106:107] op_sel:[0,0] op_sel_hi:[1,0]
    v_pk_mul_f32 v[42:43], v[42:43], v[106:107] op_sel:[0,0] op_sel_hi:[1,0]
    v_pk_mul_f32 v[44:45], v[44:45], v[106:107] op_sel:[0,0] op_sel_hi:[1,0]
    v_pk_mul_f32 v[46:47], v[46:47], v[106:107] op_sel:[0,0] op_sel_hi:[1,0]
    v_cvt_pk_bf16_f32 v92, v40, v41
    v_cvt_pk_bf16_f32 v93, v42, v43
    v_cvt_pk_bf16_f32 v94, v44, v45
    v_cvt_pk_bf16_f32 v95, v46, v47
    v_mfma_f32_32x32x16_bf16 v[48:63], v[88:91], v[120:123], 0
    s_nop 0
    v_mfma_f32_32x32x16_bf16 v[64:79], v[92:95], v[120:123], 0
    s_nop 0
    v_max3_f32 v1, v16, v17, v18
    v_min3_f32 v3, v16, v17, v18
    v_max3_f32 v1, v1, v19, v20
    v_min3_f32 v3, v3, v19, v20
    v_max3_f32 v1, v1, v21, v22
    v_min3_f32 v3, v3, v21, v22
    v_max_f32 v1, v1, v23
    v_min_f32 v3, v3, v23
    v_max3_f32 v2, v24, v25, v26
    v_min3_f32 v4, v24, v25, v26
    v_max3_f32 v2, v2, v27, v28
    v_min3_f32 v4, v4, v27, v28
    v_max3_f32 v2, v2, v29, v30
    v_min3_f32 v4, v4, v29, v30
    v_max_f32 v2, v2, v31
    v_min_f32 v4, v4, v31
    s_nop 0
    v_permlane32_swap_b32 v1, v2
    v_permlane32_swap_b32 v3, v4
    v_max_f32 v1, v1, v2
    v_min_f32 v3, v3, v4
    v_mov_b32 v2, v1
    v_mov_b32 v4, v3
    s_nop 0
    v_permlane32_swap_b32 v1, v2
    v_permlane32_swap_b32 v3, v4
    v_mul_f32 v1, v1, v105
    v_mul_f32 v3, v3, v105
    v_mul_f32 v2, v2, v107
    v_mul_f32 v4, v4, v107
    v_pk_fma_f32 v[32:33], v[16:17], v[104:105], v[0:1] op_sel:[0,1,1] op_sel_hi:[1,1,1] neg_lo:[0,0,1] neg_hi:[0,0,1]
    v_pk_fma_f32 v[16:17], v[16:17], v[104:105], v[2:3] op_sel:[0,1,1] op_sel_hi:[1,1,1] neg_lo:[1,0,0] neg_hi:[1,0,0]
    v_pk_fma_f32 v[34:35], v[18:19], v[104:105], v[0:1] op_sel:[0,1,1] op_sel_hi:[1,1,1] neg_lo:[0,0,1] neg_hi:[0,0,1]
    v_pk_fma_f32 v[18:19], v[18:19], v[104:105], v[2:3] op_sel:[0,1,1] op_sel_hi:[1,1,1] neg_lo:[1,0,0] neg_hi:[1,0,0]
    v_pk_fma_f32 v[36:37], v[20:21], v[104:105], v[0:1] op_sel:[0,1,1] op_sel_hi:[1,1,1] neg_lo:[0,0,1] neg_hi:[0,0,1]
    v_pk_fma_f32 v[20:21], v[20:21], v[104:105], v[2:3] op_sel:[0,1,1] op_sel_hi:[1,1,1] neg_lo:[1,0,0] neg_hi:[1,0,0]
    v_pk_fma_f32 v[38:39], v[22:23], v[104:105], v[0:1] op_sel:[0,1,1] op_sel_hi:[1,1,1] neg_lo:[0,0,1] neg_hi:[0,0,1]
    v_pk_fma_f32 v[22:23], v[22:23], v[104:105], v[2:3] op_sel:[0,1,1] op_sel_hi:[1,1,1] neg_lo:[1,0,0] neg_hi:[1,0,0]
    v_pk_fma_f32 v[40:41], v[24:25], v[106:107], v[2:3] op_sel:[0,1,0] op_sel_hi:[1,1,0] neg_lo:[0,0,1] neg_hi:[0,0,1]
    v_pk_fma_f32 v[24:25], v[24:25], v[106:107], v[4:5] op_sel:[0,1,0] op_sel_hi:[1,1,0] neg_lo:[1,0,0] neg_hi:[1,0,0]
    v_pk_fma_f32 v[42:43], v[26:27], v[106:107], v[2:3] op_sel:[0,1,0] op_sel_hi:[1,1,0] neg_lo:[0,0,1] neg_hi:[0,0,1]
    v_pk_fma_f32 v[26:27], v[26:27], v[106:107], v[4:5] op_sel:[0,1,0] op_sel_hi:[1,1,0] neg_lo:[1,0,0] neg_hi:[1,0,0]
    v_pk_fma_f32 v[44:45], v[28:29], v[106:107], v[2:3] op_sel:[0,1,0] op_sel_hi:[1,1,0] neg_lo:[0,0,1] neg_hi:[0,0,1]
    v_pk_fma_f32 v[28:29], v[28:29], v[106:107], v[4:5] op_sel:[0,1,0] op_sel_hi:[1,1,0] neg_lo:[1,0,0] neg_hi:[1,0,0]
    v_pk_fma_f32 v[46:47], v[30:31], v[106:107], v[2:3] op_sel:[0,1,0] op_sel_hi:[1,1,0] neg_lo:[0,0,1] neg_hi:[0,0,1]
    v_pk_fma_f32 v[30:31], v[30:31], v[106:107], v[4:5] op_sel:[0,1,0] op_sel_hi:[1,1,0] neg_lo:[1,0,0] neg_hi:[1,0,0]
    v_exp_f32 v32, v32
    v_exp_f32 v16, v16
    v_exp_f32 v33, v33
    v_exp_f32 v17, v17
    v_exp_f32 v34, v34
    v_exp_f32 v18, v18
    v_exp_f32 v35, v35
    v_exp_f32 v19, v19
    v_exp_f32 v36, v36
    v_exp_f32 v20, v20
    v_exp_f32 v37, v37
    v_exp_f32 v21, v21
    v_exp_f32 v38, v38
    v_exp_f32 v22, v22
    v_exp_f32 v39, v39
    v_exp_f32 v23, v23
    v_exp_f32 v40, v40
    v_exp_f32 v24, v24
    v_exp_f32 v41, v41
    v_exp_f32 v25, v25
    v_exp_f32 v42, v42
    v_exp_f32 v26, v26
    v_exp_f32 v43, v43
    v_exp_f32 v27, v27
    v_exp_f32 v44, v44
    v_exp_f32 v28, v28
    v_exp_f32 v45, v45
    v_exp_f32 v29, v29
    v_exp_f32 v46, v46
    v_exp_f32 v30, v30
    v_exp_f32 v47, v47
    v_exp_f32 v31, v31
    v_cvt_pk_bf16_f32 v48, v48, v49
    v_cvt_pk_bf16_f32 v49, v50, v51
    v_cvt_pk_bf16_f32 v50, v52, v53
    v_cvt_pk_bf16_f32 v51, v54, v55
    v_cvt_pk_bf16_f32 v52, v56, v57
    v_cvt_pk_bf16_f32 v53, v58, v59
    v_cvt_pk_bf16_f32 v54, v60, v61
    v_cvt_pk_bf16_f32 v55, v62, v63
    v_cvt_pk_bf16_f32 v64, v64, v65
    v_cvt_pk_bf16_f32 v65, v66, v67
    v_cvt_pk_bf16_f32 v66, v68, v69
    v_cvt_pk_bf16_f32 v67, v70, v71
    v_cvt_pk_bf16_f32 v68, v72, v73
    v_cvt_pk_bf16_f32 v69, v74, v75
    v_cvt_pk_bf16_f32 v70, v76, v77
    v_cvt_pk_bf16_f32 v71, v78, v79
    v_or_b32 v48, v48, v9
    v_or_b32 v49, v49, v9
    v_or_b32 v50, v50, v9
    v_or_b32 v51, v51, v9
    v_or_b32 v52, v52, v9
    v_or_b32 v53, v53, v9
    v_or_b32 v54, v54, v9
    v_or_b32 v55, v55, v9
    v_or_b32 v64, v64, v9
    v_or_b32 v65, v65, v9
    v_or_b32 v66, v66, v9
    v_or_b32 v67, v67, v9
    v_or_b32 v68, v68, v9
    v_or_b32 v69, v69, v9
    v_or_b32 v70, v70, v9
    v_or_b32 v71, v71, v9
    v_mov_b32 v9, 0x3f803f80
    v_pk_add_f32 v[100:101], v[32:33], v[34:35]
    v_pk_add_f32 v[102:103], v[16:17], v[18:19]
    v_pk_add_f32 v[100:101], v[100:101], v[36:37]
    v_pk_add_f32 v[102:103], v[102:103], v[20:21]
    v_pk_add_f32 v[100:101], v[100:101], v[38:39]
    v_pk_add_f32 v[102:103], v[102:103], v[22:23]
    v_add_f32 v1, v100, v101
    v_add_f32 v3, v102, v103
    v_pk_add_f32 v[100:101], v[40:41], v[42:43]
    v_pk_add_f32 v[102:103], v[24:25], v[26:27]
    v_pk_add_f32 v[100:101], v[100:101], v[44:45]
    v_pk_add_f32 v[102:103], v[102:103], v[28:29]
    v_pk_add_f32 v[100:101], v[100:101], v[46:47]
    v_pk_add_f32 v[102:103], v[102:103], v[30:31]
    v_add_f32 v2, v100, v101
    v_add_f32 v4, v102, v103
    s_nop 0
    v_permlane32_swap_b32 v1, v2
    v_permlane32_swap_b32 v3, v4
    v_add_f32 v1, v1, v2
    v_add_f32 v3, v3, v4
    v_rcp_f32 v1, v1
    v_rcp_f32 v3, v3
    v_mov_b32 v2, v1
    v_mov_b32 v4, v3
    s_nop 0
    v_permlane32_swap_b32 v1, v2
    v_permlane32_swap_b32 v3, v4
    v_pk_mul_f32 v[32:33], v[32:33], v[0:1] op_sel:[0,1] op_sel_hi:[1,1]
    v_pk_mul_f32 v[34:35], v[34:35], v[0:1] op_sel:[0,1] op_sel_hi:[1,1]
    v_pk_mul_f32 v[36:37], v[36:37], v[0:1] op_sel:[0,1] op_sel_hi:[1,1]
    v_pk_mul_f32 v[38:39], v[38:39], v[0:1] op_sel:[0,1] op_sel_hi:[1,1]
    v_cvt_pk_bf16_f32 v80, v32, v33
    v_cvt_pk_bf16_f32 v81, v34, v35
    v_cvt_pk_bf16_f32 v82, v36, v37
    v_cvt_pk_bf16_f32 v83, v38, v39
    v_pk_mul_f32 v[16:17], v[16:17], v[2:3] op_sel:[0,1] op_sel_hi:[1,1]
    v_pk_mul_f32 v[18:19], v[18:19], v[2:3] op_sel:[0,1] op_sel_hi:[1,1]
    v_pk_mul_f32 v[20:21], v[20:21], v[2:3] op_sel:[0,1] op_sel_hi:[1,1]
    v_pk_mul_f32 v[22:23], v[22:23], v[2:3] op_sel:[0,1] op_sel_hi:[1,1]
    v_cvt_pk_bf16_f32 v84, v16, v17
    v_cvt_pk_bf16_f32 v85, v18, v19
    v_cvt_pk_bf16_f32 v86, v20, v21
    v_cvt_pk_bf16_f32 v87, v22, v23
    v_pk_mul_f32 v[40:41], v[40:41], v[2:3] op_sel:[0,0] op_sel_hi:[1,0]
    v_pk_mul_f32 v[42:43], v[42:43], v[2:3] op_sel:[0,0] op_sel_hi:[1,0]
    v_pk_mul_f32 v[44:45], v[44:45], v[2:3] op_sel:[0,0] op_sel_hi:[1,0]
    v_pk_mul_f32 v[46:47], v[46:47], v[2:3] op_sel:[0,0] op_sel_hi:[1,0]
    v_cvt_pk_bf16_f32 v88, v40, v41
    v_cvt_pk_bf16_f32 v89, v42, v43
    v_cvt_pk_bf16_f32 v90, v44, v45
    v_cvt_pk_bf16_f32 v91, v46, v47
    v_pk_mul_f32 v[24:25], v[24:25], v[4:5] op_sel:[0,0] op_sel_hi:[1,0]
    v_pk_mul_f32 v[26:27], v[26:27], v[4:5] op_sel:[0,0] op_sel_hi:[1,0]
    v_pk_mul_f32 v[28:29], v[28:29], v[4:5] op_sel:[0,0] op_sel_hi:[1,0]
    v_pk_mul_f32 v[30:31], v[30:31], v[4:5] op_sel:[0,0] op_sel_hi:[1,0]
    v_cvt_pk_bf16_f32 v92, v24, v25
    v_cvt_pk_bf16_f32 v93, v26, v27
    v_cvt_pk_bf16_f32 v94, v28, v29
    v_cvt_pk_bf16_f32 v95, v30, v31
    v_mfma_f32_32x32x16_bf16 v[16:31], v[80:83], v[120:123], 0
    v_mfma_f32_32x32x16_bf16 v[32:47], v[88:91], v[120:123], 0
    v_mfma_f32_32x32x16_bf16 v[16:31], v[84:87], v[124:127], v[16:31]
    v_mfma_f32_32x32x16_bf16 v[32:47], v[92:95], v[124:127], v[32:47]
    v_mov_b32 v1, 0xff
    s_nop 9
    v_cvt_pk_bf16_f32 v80, v16, v17
    v_cvt_pk_bf16_f32 v81, v18, v19
    v_cvt_pk_bf16_f32 v82, v20, v21
    v_cvt_pk_bf16_f32 v83, v22, v23
    v_cvt_pk_bf16_f32 v84, v24, v25
    v_cvt_pk_bf16_f32 v85, v26, v27
    v_cvt_pk_bf16_f32 v86, v28, v29
    v_cvt_pk_bf16_f32 v87, v30, v31
    v_mfma_f32_32x32x16_bf16 v[16:31], v[80:83], v[48:51], 0
    s_nop 0
    v_mfma_f32_32x32x16_bf16 v[16:31], v[84:87], v[52:55], v[16:31]
    v_cvt_pk_bf16_f32 v88, v32, v33
    v_cvt_pk_bf16_f32 v89, v34, v35
    v_cvt_pk_bf16_f32 v90, v36, v37
    v_cvt_pk_bf16_f32 v91, v38, v39
    v_cvt_pk_bf16_f32 v92, v40, v41
    v_cvt_pk_bf16_f32 v93, v42, v43
    v_cvt_pk_bf16_f32 v94, v44, v45
    v_cvt_pk_bf16_f32 v95, v46, v47
    v_mfma_f32_32x32x16_bf16 v[16:31], v[88:91], v[64:67], v[16:31]
    s_nop 0
    v_mfma_f32_32x32x16_bf16 v[16:31], v[92:95], v[68:71], v[16:31]
    s_mov_b32 exec_lo, 0x1ffff
    s_mov_b32 exec_hi, 0x1ffff
    s_nop 9
    v_bfi_b32 v16, v1, v12, v16
    v_bfi_b32 v17, v1, v13, v17
    v_bfi_b32 v18, v1, v14, v18
    v_bfi_b32 v19, v1, v15, v19
    buffer_store_dwordx4 v[16:19], v108, s[32:35], s47 offen sc1
    v_bfi_b32 v20, v1, v12, v20
    v_bfi_b32 v21, v1, v13, v21
    v_bfi_b32 v22, v1, v14, v22
    v_bfi_b32 v23, v1, v15, v23
    buffer_store_dwordx4 v[20:23], v109, s[32:35], s47 offen sc1
    v_bfi_b32 v24, v1, v12, v24
    v_bfi_b32 v25, v1, v13, v25
    v_bfi_b32 v26, v1, v14, v26
    v_bfi_b32 v27, v1, v15, v27
    buffer_store_dwordx4 v[24:27], v110, s[32:35], s47 offen sc1
    v_bfi_b32 v28, v1, v12, v28
    v_bfi_b32 v29, v1, v13, v29
    v_bfi_b32 v30, v1, v14, v30
    v_bfi_b32 v31, v1, v15, v31
    buffer_store_dwordx4 v[28:31], v111, s[32:35], s47 offen sc1
    s_mov_b64 exec, -1
    s_mov_b64 exec, 1
    ds_add_u32 v11, v7 offset:0
    s_mov_b64 exec, -1
    s_lshl_b32 s100, s46, 1
    s_add_u32 s101, s100, 1
    v_lshrrev_b32 v1, 5, v0
    v_bfe_u32 v2, v0, 4, 1
    v_bfe_u32 v3, v0, 2, 2
    v_and_b32 v4, 3, v0
    v_lshl_add_u32 v5, v1, 2, v3
    v_lshlrev_b32 v5, 5, v5
    v_lshl_add_u32 v5, v4, 3, v5
    s_lshl_b32 s98, s100, 9
    s_lshl_b32 s99, s101, 9
    s_sub_u32 s99, s99, s98
    v_mul_lo_u32 v6, v2, s99
    v_add3_u32 v5, v5, v6, s98
    v_add_u32 v5, 157696, v5
    ds_read_b64_tr_b16 v[84:85], v5 offset:0
    ds_read_b64_tr_b16 v[86:87], v5 offset:256
    v_cmp_eq_u32 vcc, 0, v2
    s_waitcnt lgkmcnt(1)
    s_nop 0
    v_cndmask_b32 v112, 0, v84, vcc
    v_cndmask_b32 v116, v84, 0, vcc
    v_cndmask_b32 v113, 0, v85, vcc
    v_cndmask_b32 v117, v85, 0, vcc
    s_waitcnt lgkmcnt(0)
    v_cndmask_b32 v114, 0, v86, vcc
    v_cndmask_b32 v118, v86, 0, vcc
    v_cndmask_b32 v115, 0, v87, vcc
    v_cndmask_b32 v119, v87, 0, vcc
    s_lshl_b32 s98, s46, 9
    s_add_u32 s98, s98, 161792
    v_lshlrev_b32 v1, 3, v0
    v_add_u32 v1, s98, v1
    ds_read_b64 v[88:89], v1
    v_mov_b32 v90, 0
    v_mov_b32 v91, 0
    s_waitcnt lgkmcnt(0)
    s_nop 0
    v_mfma_f32_32x32x16_bf16 v[192:207], v[88:91], v[96:99], v[192:207]
    s_lshr_b32 s47, s6, 2
    s_lshl_b32 s98, s44, 1
    s_add_u32 s47, s47, s98
    s_nop 8
    v_cvt_pk_bf16_f32 v80, v192, v193
    v_cvt_pk_bf16_f32 v81, v194, v195
    v_cvt_pk_bf16_f32 v82, v196, v197
    v_cvt_pk_bf16_f32 v83, v198, v199
    v_cvt_pk_bf16_f32 v84, v200, v201
    v_cvt_pk_bf16_f32 v85, v202, v203
    v_cvt_pk_bf16_f32 v86, v204, v205
    v_cvt_pk_bf16_f32 v87, v206, v207
    v_mfma_f32_32x32x16_bf16 v[16:31], v[112:115], v[80:83], 0
    s_nop 0
    v_mfma_f32_32x32x16_bf16 v[16:31], v[116:119], v[84:87], v[16:31]
    s_lshl_b32 s99, s3, 2
    v_lshrrev_b32 v1, 5, v0
    v_bfe_u32 v2, v0, 4, 1
    v_bfe_u32 v3, v0, 2, 2
    v_and_b32 v4, 3, v0
    v_lshrrev_b32 v5, 1, v4
    v_lshl_add_u32 v5, v2, 1, v5
    v_add_u32 v5, s99, v5
    v_lshlrev_b32 v6, 2, v3
    v_xor_b32 v5, v5, v6
    v_lshlrev_b32 v5, 4, v5
    v_and_b32 v6, 1, v4
    v_lshl_add_u32 v5, v6, 3, v5
    v_mul_u32_u24 v6, 4, v1
    v_add_u32 v6, v6, v3
    v_mul_u32_u24 v6, 256, v6
    v_add_u32 v5, v5, v6
    v_add_u32 v10, 0, v5
    v_max3_f32 v1, v16, v17, v18
    v_min3_f32 v3, v16, v17, v18
    v_max3_f32 v1, v1, v19, v20
    v_min3_f32 v3, v3, v19, v20
    v_max3_f32 v1, v1, v21, v22
    v_min3_f32 v3, v3, v21, v22
    v_max_f32 v1, v1, v23
    v_min_f32 v3, v3, v23
    v_max3_f32 v2, v24, v25, v26
    v_min3_f32 v4, v24, v25, v26
    v_max3_f32 v2, v2, v27, v28
    v_min3_f32 v4, v4, v27, v28
    v_max3_f32 v2, v2, v29, v30
    v_min3_f32 v4, v4, v29, v30
    v_max_f32 v2, v2, v31
    v_min_f32 v4, v4, v31
    s_nop 0
    v_permlane32_swap_b32 v1, v2
    v_permlane32_swap_b32 v3, v4
    v_max_f32 v1, v1, v2
    v_min_f32 v3, v3, v4
    v_mov_b32 v2, v1
    v_mov_b32 v4, v3
    s_nop 0
    v_permlane32_swap_b32 v1, v2
    v_permlane32_swap_b32 v3, v4
    v_mul_f32 v1, v1, v105
    v_mul_f32 v3, v3, v105
    v_mul_f32 v2, v2, v105
    v_mul_f32 v4, v4, v105
    v_pk_fma_f32 v[32:33], v[16:17], v[104:105], v[0:1] op_sel:[0,1,1] op_sel_hi:[1,1,1] neg_lo:[0,0,1] neg_hi:[0,0,1]
    v_pk_fma_f32 v[16:17], v[16:17], v[104:105], v[2:3] op_sel:[0,1,1] op_sel_hi:[1,1,1] neg_lo:[1,0,0] neg_hi:[1,0,0]
    v_pk_fma_f32 v[34:35], v[18:19], v[104:105], v[0:1] op_sel:[0,1,1] op_sel_hi:[1,1,1] neg_lo:[0,0,1] neg_hi:[0,0,1]
    v_pk_fma_f32 v[18:19], v[18:19], v[104:105], v[2:3] op_sel:[0,1,1] op_sel_hi:[1,1,1] neg_lo:[1,0,0] neg_hi:[1,0,0]
    v_pk_fma_f32 v[36:37], v[20:21], v[104:105], v[0:1] op_sel:[0,1,1] op_sel_hi:[1,1,1] neg_lo:[0,0,1] neg_hi:[0,0,1]
    v_pk_fma_f32 v[20:21], v[20:21], v[104:105], v[2:3] op_sel:[0,1,1] op_sel_hi:[1,1,1] neg_lo:[1,0,0] neg_hi:[1,0,0]
    v_pk_fma_f32 v[38:39], v[22:23], v[104:105], v[0:1] op_sel:[0,1,1] op_sel_hi:[1,1,1] neg_lo:[0,0,1] neg_hi:[0,0,1]
    v_pk_fma_f32 v[22:23], v[22:23], v[104:105], v[2:3] op_sel:[0,1,1] op_sel_hi:[1,1,1] neg_lo:[1,0,0] neg_hi:[1,0,0]
    v_pk_fma_f32 v[40:41], v[24:25], v[104:105], v[2:3] op_sel:[0,1,0] op_sel_hi:[1,1,0] neg_lo:[0,0,1] neg_hi:[0,0,1]
    v_pk_fma_f32 v[24:25], v[24:25], v[104:105], v[4:5] op_sel:[0,1,0] op_sel_hi:[1,1,0] neg_lo:[1,0,0] neg_hi:[1,0,0]
    v_pk_fma_f32 v[42:43], v[26:27], v[104:105], v[2:3] op_sel:[0,1,0] op_sel_hi:[1,1,0] neg_lo:[0,0,1] neg_hi:[0,0,1]
    v_pk_fma_f32 v[26:27], v[26:27], v[104:105], v[4:5] op_sel:[0,1,0] op_sel_hi:[1,1,0] neg_lo:[1,0,0] neg_hi:[1,0,0]
    v_pk_fma_f32 v[44:45], v[28:29], v[104:105], v[2:3] op_sel:[0,1,0] op_sel_hi:[1,1,0] neg_lo:[0,0,1] neg_hi:[0,0,1]
    v_pk_fma_f32 v[28:29], v[28:29], v[104:105], v[4:5] op_sel:[0,1,0] op_sel_hi:[1,1,0] neg_lo:[1,0,0] neg_hi:[1,0,0]
    v_pk_fma_f32 v[46:47], v[30:31], v[104:105], v[2:3] op_sel:[0,1,0] op_sel_hi:[1,1,0] neg_lo:[0,0,1] neg_hi:[0,0,1]
    v_pk_fma_f32 v[30:31], v[30:31], v[104:105], v[4:5] op_sel:[0,1,0] op_sel_hi:[1,1,0] neg_lo:[1,0,0] neg_hi:[1,0,0]
    v_exp_f32 v32, v32
    v_exp_f32 v16, v16
    v_exp_f32 v33, v33
    v_exp_f32 v17, v17
    v_exp_f32 v34, v34
    v_exp_f32 v18, v18
    v_exp_f32 v35, v35
    v_exp_f32 v19, v19
    v_exp_f32 v36, v36
    v_exp_f32 v20, v20
    v_exp_f32 v37, v37
    v_exp_f32 v21, v21
    v_exp_f32 v38, v38
    v_exp_f32 v22, v22
    v_exp_f32 v39, v39
    v_exp_f32 v23, v23
    v_exp_f32 v40, v40
    v_exp_f32 v24, v24
    v_exp_f32 v41, v41
    v_exp_f32 v25, v25
    v_exp_f32 v42, v42
    v_exp_f32 v26, v26
    v_exp_f32 v43, v43
    v_exp_f32 v27, v27
    v_exp_f32 v44, v44
    v_exp_f32 v28, v28
    v_exp_f32 v45, v45
    v_exp_f32 v29, v29
    v_exp_f32 v46, v46
    v_exp_f32 v30, v30
    v_exp_f32 v47, v47
    v_exp_f32 v31, v31
    v_pk_add_f32 v[100:101], v[32:33], v[34:35]
    v_pk_add_f32 v[102:103], v[16:17], v[18:19]
    v_pk_add_f32 v[100:101], v[100:101], v[36:37]
    v_pk_add_f32 v[102:103], v[102:103], v[20:21]
    v_pk_add_f32 v[100:101], v[100:101], v[38:39]
    v_pk_add_f32 v[102:103], v[102:103], v[22:23]
    v_add_f32 v1, v100, v101
    v_add_f32 v3, v102, v103
    v_pk_add_f32 v[100:101], v[40:41], v[42:43]
    v_pk_add_f32 v[102:103], v[24:25], v[26:27]
    v_pk_add_f32 v[100:101], v[100:101], v[44:45]
    v_pk_add_f32 v[102:103], v[102:103], v[28:29]
    v_pk_add_f32 v[100:101], v[100:101], v[46:47]
    v_pk_add_f32 v[102:103], v[102:103], v[30:31]
    v_add_f32 v2, v100, v101
    v_add_f32 v4, v102, v103
    s_nop 0
    v_permlane32_swap_b32 v1, v2
    v_permlane32_swap_b32 v3, v4
    v_add_f32 v1, v1, v2
    v_add_f32 v3, v3, v4
    v_rcp_f32 v1, v1
    v_rcp_f32 v3, v3
    v_mov_b32 v2, v1
    v_mov_b32 v4, v3
    s_nop 0
    v_permlane32_swap_b32 v1, v2
    v_permlane32_swap_b32 v3, v4
    v_pk_mul_f32 v[32:33], v[32:33], v[0:1] op_sel:[0,1] op_sel_hi:[1,1]
    v_pk_mul_f32 v[34:35], v[34:35], v[0:1] op_sel:[0,1] op_sel_hi:[1,1]
    v_pk_mul_f32 v[36:37], v[36:37], v[0:1] op_sel:[0,1] op_sel_hi:[1,1]
    v_pk_mul_f32 v[38:39], v[38:39], v[0:1] op_sel:[0,1] op_sel_hi:[1,1]
    v_cvt_pk_bf16_f32 v80, v32, v33
    v_cvt_pk_bf16_f32 v81, v34, v35
    v_cvt_pk_bf16_f32 v82, v36, v37
    v_cvt_pk_bf16_f32 v83, v38, v39
    v_pk_mul_f32 v[16:17], v[16:17], v[2:3] op_sel:[0,1] op_sel_hi:[1,1]
    v_pk_mul_f32 v[18:19], v[18:19], v[2:3] op_sel:[0,1] op_sel_hi:[1,1]
    v_pk_mul_f32 v[20:21], v[20:21], v[2:3] op_sel:[0,1] op_sel_hi:[1,1]
    v_pk_mul_f32 v[22:23], v[22:23], v[2:3] op_sel:[0,1] op_sel_hi:[1,1]
    v_cvt_pk_bf16_f32 v84, v16, v17
    v_cvt_pk_bf16_f32 v85, v18, v19
    v_cvt_pk_bf16_f32 v86, v20, v21
    v_cvt_pk_bf16_f32 v87, v22, v23
    v_pk_mul_f32 v[40:41], v[40:41], v[2:3] op_sel:[0,0] op_sel_hi:[1,0]
    v_pk_mul_f32 v[42:43], v[42:43], v[2:3] op_sel:[0,0] op_sel_hi:[1,0]
    v_pk_mul_f32 v[44:45], v[44:45], v[2:3] op_sel:[0,0] op_sel_hi:[1,0]
    v_pk_mul_f32 v[46:47], v[46:47], v[2:3] op_sel:[0,0] op_sel_hi:[1,0]
    v_cvt_pk_bf16_f32 v88, v40, v41
    v_cvt_pk_bf16_f32 v89, v42, v43
    v_cvt_pk_bf16_f32 v90, v44, v45
    v_cvt_pk_bf16_f32 v91, v46, v47
    v_pk_mul_f32 v[24:25], v[24:25], v[4:5] op_sel:[0,0] op_sel_hi:[1,0]
    v_pk_mul_f32 v[26:27], v[26:27], v[4:5] op_sel:[0,0] op_sel_hi:[1,0]
    v_pk_mul_f32 v[28:29], v[28:29], v[4:5] op_sel:[0,0] op_sel_hi:[1,0]
    v_pk_mul_f32 v[30:31], v[30:31], v[4:5] op_sel:[0,0] op_sel_hi:[1,0]
    v_cvt_pk_bf16_f32 v92, v24, v25
    v_cvt_pk_bf16_f32 v93, v26, v27
    v_cvt_pk_bf16_f32 v94, v28, v29
    v_cvt_pk_bf16_f32 v95, v30, v31
    v_add_u32 v2, 65536, v10
    v_add_u32 v3, 131072, v10
    s_mov_b32 s95, 0
C_cw_3:
    ds_read_b32 v1, v11 offset:8
    s_add_u32 s95, s95, 1
    s_cmp_gt_u32 s95, 16777216
    s_cbranch_scc1 C_cb_4
    s_waitcnt lgkmcnt(0)
    v_readfirstlane_b32 s98, v1
    s_nop 1
    s_cmp_lt_u32 s98, 2
    s_nop 0
    s_cbranch_scc1 C_cw_3
C_cb_4:
    s_waitcnt lgkmcnt(0)
    ds_read_b64_tr_b16 v[128:129], v3 offset:0
    ds_read_b64_tr_b16 v[130:131], v3 offset:2048
    ds_read_b64_tr_b16 v[132:133], v3 offset:4096
    ds_read_b64_tr_b16 v[134:135], v3 offset:6144
    ds_read_b64_tr_b16 v[136:137], v3 offset:8192
    ds_read_b64_tr_b16 v[138:139], v3 offset:10240
    ds_read_b64_tr_b16 v[140:141], v3 offset:12288
    ds_read_b64_tr_b16 v[142:143], v3 offset:14336
    ds_read_b64_tr_b16 v[144:145], v3 offset:16384
    ds_read_b64_tr_b16 v[146:147], v3 offset:18432
    ds_read_b64_tr_b16 v[148:149], v3 offset:20480
    ds_read_b64_tr_b16 v[150:151], v3 offset:22528
    ds_read_b64_tr_b16 v[152:153], v10 offset:0
    ds_read_b64_tr_b16 v[154:155], v10 offset:2048
    ds_read_b64_tr_b16 v[156:157], v10 offset:4096
    ds_read_b64_tr_b16 v[158:159], v10 offset:6144
    ds_read_b64_tr_b16 v[160:161], v10 offset:8192
    ds_read_b64_tr_b16 v[162:163], v10 offset:10240
    ds_read_b64_tr_b16 v[164:165], v10 offset:12288
    ds_read_b64_tr_b16 v[166:167], v10 offset:14336
    ds_read_b64_tr_b16 v[168:169], v10 offset:16384
    ds_read_b64_tr_b16 v[170:171], v10 offset:18432
    ds_read_b64_tr_b16 v[172:173], v10 offset:20480
    ds_read_b64_tr_b16 v[174:175], v10 offset:22528
    ds_read_b64_tr_b16 v[176:177], v10 offset:24576
    ds_read_b64_tr_b16 v[178:179], v10 offset:26624
    ds_read_b64_tr_b16 v[180:181], v10 offset:28672
    ds_read_b64_tr_b16 v[182:183], v10 offset:30720
    ds_read_b64_tr_b16 v[184:185], v10 offset:32768
    ds_read_b64_tr_b16 v[186:187], v10 offset:34816
    ds_read_b64_tr_b16 v[188:189], v10 offset:36864
    ds_read_b64_tr_b16 v[190:191], v10 offset:38912
    ds_read_b64_tr_b16 v[192:193], v10 offset:40960
    ds_read_b64_tr_b16 v[194:195], v10 offset:43008
    ds_read_b64_tr_b16 v[196:197], v10 offset:45056
    ds_read_b64_tr_b16 v[198:199], v10 offset:47104
    ds_read_b64_tr_b16 v[200:201], v10 offset:49152
    ds_read_b64_tr_b16 v[202:203], v10 offset:51200
    ds_read_b64_tr_b16 v[204:205], v10 offset:53248
    ds_read_b64_tr_b16 v[206:207], v10 offset:55296
    ds_read_b64_tr_b16 v[208:209], v10 offset:57344
    ds_read_b64_tr_b16 v[210:211], v10 offset:59392
    ds_read_b64_tr_b16 v[212:213], v10 offset:61440
    ds_read_b64_tr_b16 v[214:215], v10 offset:63488
    ds_read_b64_tr_b16 v[216:217], v2 offset:0
    ds_read_b64_tr_b16 v[218:219], v2 offset:2048
    ds_read_b64_tr_b16 v[220:221], v2 offset:4096
    ds_read_b64_tr_b16 v[222:223], v2 offset:6144
    ds_read_b64_tr_b16 v[224:225], v2 offset:8192
    ds_read_b64_tr_b16 v[226:227], v2 offset:10240
    ds_read_b64_tr_b16 v[228:229], v2 offset:12288
    ds_read_b64_tr_b16 v[230:231], v2 offset:14336
    ds_read_b64_tr_b16 v[232:233], v2 offset:16384
    ds_read_b64_tr_b16 v[234:235], v2 offset:18432
    ds_read_b64_tr_b16 v[236:237], v2 offset:20480
    ds_read_b64_tr_b16 v[238:239], v2 offset:22528
    ds_read_b64_tr_b16 v[240:241], v2 offset:24576
    ds_read_b64_tr_b16 v[242:243], v2 offset:26624
    ds_read_b64_tr_b16 v[244:245], v2 offset:28672
    ds_read_b64_tr_b16 v[246:247], v2 offset:30720
    ds_read_b64_tr_b16 v[248:249], v2 offset:32768
    ds_read_b64_tr_b16 v[250:251], v2 offset:34816
    ds_read_b64_tr_b16 v[252:253], v2 offset:36864
    ds_read_b64_tr_b16 v[254:255], v2 offset:38912
    v_and_b32 v1, 31, v0
    v_lshrrev_b32 v6, 5, v0
    v_lshlrev_b32 v4, 4, v1
    v_lshl_add_u32 v4, v6, 8, v4
    s_lshl_b32 s98, s46, 12
    v_add_u32 v4, s98, v4
    s_lshl_b32 s98, s46, 8
    s_add_u32 s98, s98, 8192
    v_lshlrev_b32 v6, 4, v6
    v_add_u32 v6, s98, v6
    v_cmp_gt_u32 vcc, 16, v1
    v_mov_b32 v5, 512
    s_nop 0
    v_cndmask_b32 v104, v6, v4, vcc
    v_cndmask_b32 v5, 32, v5, vcc
    v_add_u32 v105, v104, v5
    v_add_u32 v106, v105, v5
    v_add_u32 v107, v106, v5
    v_add_u32 v108, v107, v5
    v_add_u32 v109, v108, v5
    v_add_u32 v110, v109, v5
    v_add_u32 v111, v110, v5
    s_mul_i32 s99, s6, 8704
    s_add_u32 s99, s99, 65536
    s_waitcnt lgkmcnt(0)
    s_mov_b64 exec, 1
    ds_add_u32 v11, v7 offset:12
    s_mov_b64 exec, -1
    s_mov_b32 s95, 0
C_cw_5:
    ds_read_b32 v1, v11 offset:20
    s_add_u32 s95, s95, 1
    s_cmp_gt_u32 s95, 16777216
    s_cbranch_scc1 C_cb_6
    s_waitcnt lgkmcnt(0)
    v_readfirstlane_b32 s97, v1
    s_nop 1
    s_cmp_lt_u32 s97, 1
    s_nop 0
    s_cbranch_scc1 C_cw_5
C_cb_6:
    s_waitcnt lgkmcnt(0)
    s_sub_u32 s97, s97, 1
    s_lshl_b32 s48, s44, 1
    s_add_u32 s48, s48, s45
    s_lshl_b32 s49, s48, 6
    s_lshl_b32 s48, s48, 15
    s_lshl_b32 s98, s6, 1
    s_add_u32 s98, s98, s46
    s_lshl_b32 s101, s98, 2
    s_add_u32 s49, s49, s101
    s_add_u32 s49, s49, 8192
    s_lshl_b32 s98, s98, 11
    s_add_u32 s48, s48, s98
    s_add_u32 s48, s48, 4194304
    v_lshlrev_b32 v6, 4, v0
    v_lshlrev_b32 v3, 2, v0
    v_mov_b32 v5, s96
    v_mov_b32 v4, 0
    s_mov_b32 s95, 0
C_cw_7:
    s_sleep 1
    ds_read_b32 v1, v11 offset:32
    s_add_u32 s95, s95, 1
    s_cmp_gt_u32 s95, 16777216
    s_cbranch_scc1 C_cb_8
    s_waitcnt lgkmcnt(0)
    v_readfirstlane_b32 s98, v1
    s_nop 1
    s_cmp_lt_u32 s98, 1
    s_nop 0
    s_cbranch_scc1 C_cw_7
C_cb_8:
    s_waitcnt lgkmcnt(0)
    s_mov_b32 s95, 0
C_h2_9:
    buffer_load_dwordx4 v[16:19], v104, s[32:35], s99 offen sc1
    buffer_load_dwordx4 v[20:23], v105, s[32:35], s99 offen sc1
    buffer_load_dwordx4 v[24:27], v106, s[32:35], s99 offen sc1
    buffer_load_dwordx4 v[28:31], v107, s[32:35], s99 offen sc1
    buffer_load_dwordx4 v[32:35], v108, s[32:35], s99 offen sc1
    buffer_load_dwordx4 v[36:39], v109, s[32:35], s99 offen sc1
    buffer_load_dwordx4 v[40:43], v110, s[32:35], s99 offen sc1
    buffer_load_dwordx4 v[44:47], v111, s[32:35], s99 offen sc1
    s_add_u32 s95, s95, 1
    s_cmp_gt_u32 s95, 262144
    s_cbranch_scc1 C_h2b_10
    v_mov_b32 v1, 0
    s_waitcnt vmcnt(7)
    v_bitop3_b32 v1, v1, v16, v12 bitop3:0xf6
    v_bitop3_b32 v1, v1, v17, v13 bitop3:0xf6
    v_bitop3_b32 v1, v1, v18, v14 bitop3:0xf6
    v_bitop3_b32 v1, v1, v19, v15 bitop3:0xf6
    s_waitcnt vmcnt(6)
    v_bitop3_b32 v1, v1, v20, v12 bitop3:0xf6
    v_bitop3_b32 v1, v1, v21, v13 bitop3:0xf6
    v_bitop3_b32 v1, v1, v22, v14 bitop3:0xf6
    v_bitop3_b32 v1, v1, v23, v15 bitop3:0xf6
    s_waitcnt vmcnt(5)
    v_bitop3_b32 v1, v1, v24, v12 bitop3:0xf6
    v_bitop3_b32 v1, v1, v25, v13 bitop3:0xf6
    v_bitop3_b32 v1, v1, v26, v14 bitop3:0xf6
    v_bitop3_b32 v1, v1, v27, v15 bitop3:0xf6
    s_waitcnt vmcnt(4)
    v_bitop3_b32 v1, v1, v28, v12 bitop3:0xf6
    v_bitop3_b32 v1, v1, v29, v13 bitop3:0xf6
    v_bitop3_b32 v1, v1, v30, v14 bitop3:0xf6
    v_bitop3_b32 v1, v1, v31, v15 bitop3:0xf6
    s_waitcnt vmcnt(3)
    v_bitop3_b32 v1, v1, v32, v12 bitop3:0xf6
    v_bitop3_b32 v1, v1, v33, v13 bitop3:0xf6
    v_bitop3_b32 v1, v1, v34, v14 bitop3:0xf6
    v_bitop3_b32 v1, v1, v35, v15 bitop3:0xf6
    s_waitcnt vmcnt(2)
    v_bitop3_b32 v1, v1, v36, v12 bitop3:0xf6
    v_bitop3_b32 v1, v1, v37, v13 bitop3:0xf6
    v_bitop3_b32 v1, v1, v38, v14 bitop3:0xf6
    v_bitop3_b32 v1, v1, v39, v15 bitop3:0xf6
    s_waitcnt vmcnt(1)
    v_bitop3_b32 v1, v1, v40, v12 bitop3:0xf6
    v_bitop3_b32 v1, v1, v41, v13 bitop3:0xf6
    v_bitop3_b32 v1, v1, v42, v14 bitop3:0xf6
    v_bitop3_b32 v1, v1, v43, v15 bitop3:0xf6
    s_waitcnt vmcnt(0)
    v_bitop3_b32 v1, v1, v44, v12 bitop3:0xf6
    v_bitop3_b32 v1, v1, v45, v13 bitop3:0xf6
    v_bitop3_b32 v1, v1, v46, v14 bitop3:0xf6
    v_bitop3_b32 v1, v1, v47, v15 bitop3:0xf6
    v_and_b32 v1, 0xff, v1
    v_cmp_ne_u32 vcc, 0, v1
    s_nop 3
    s_cbranch_vccnz C_h2_9
C_h2b_10:
    s_waitcnt vmcnt(0)
    s_mov_b64 exec, 1
    ds_add_u32 v11, v7 offset:36
    s_mov_b64 exec, -1
    v_cvt_pk_bf16_f32 v96, v16, v17
    v_cvt_pk_bf16_f32 v97, v18, v19
    v_cvt_pk_bf16_f32 v98, v20, v21
    v_cvt_pk_bf16_f32 v99, v22, v23
    v_cvt_pk_bf16_f32 v100, v24, v25
    v_cvt_pk_bf16_f32 v101, v26, v27
    v_cvt_pk_bf16_f32 v102, v28, v29
    v_cvt_pk_bf16_f32 v103, v30, v31
    v_mfma_f32_32x32x16_bf16 v[48:63], v[96:99], v[80:83], 0
    v_cvt_pk_bf16_f32 v104, v32, v33
    v_cvt_pk_bf16_f32 v105, v34, v35
    v_cvt_pk_bf16_f32 v106, v36, v37
    v_cvt_pk_bf16_f32 v107, v38, v39
    v_mfma_f32_32x32x16_bf16 v[48:63], v[100:103], v[84:87], v[48:63]
    v_cvt_pk_bf16_f32 v108, v40, v41
    v_cvt_pk_bf16_f32 v109, v42, v43
    v_cvt_pk_bf16_f32 v110, v44, v45
    v_cvt_pk_bf16_f32 v111, v46, v47
    v_mfma_f32_32x32x16_bf16 v[64:79], v[104:107], v[88:91], 0
    s_nop 0
    v_mfma_f32_32x32x16_bf16 v[64:79], v[108:111], v[92:95], v[64:79]
    s_nop 4
    v_add_f32 v1, 0x358637bd, v56
    v_rcp_f32 v2, v1
    s_nop 0
    v_pk_mul_f32 v[48:49], v[48:49], v[2:3] op_sel:[0,0] op_sel_hi:[1,0]
    v_pk_mul_f32 v[50:51], v[50:51], v[2:3] op_sel:[0,0] op_sel_hi:[1,0]
    v_pk_mul_f32 v[52:53], v[52:53], v[2:3] op_sel:[0,0] op_sel_hi:[1,0]
    v_pk_mul_f32 v[54:55], v[54:55], v[2:3] op_sel:[0,0] op_sel_hi:[1,0]
    v_cvt_pk_bf16_f32 v96, v48, v49
    v_cvt_pk_bf16_f32 v97, v50, v51
    v_cvt_pk_bf16_f32 v98, v52, v53
    v_cvt_pk_bf16_f32 v99, v54, v55
    s_cmp_eq_u32 s97, 0
    s_cbranch_scc1 C_sl_11
    buffer_store_dwordx4 v[96:99], v6, s[32:35], s48 offen offset:0
C_dn_12:
    v_add_f32 v1, 0x358637bd, v72
    v_rcp_f32 v2, v1
    s_nop 0
    v_pk_mul_f32 v[64:65], v[64:65], v[2:3] op_sel:[0,0] op_sel_hi:[1,0]
    v_pk_mul_f32 v[66:67], v[66:67], v[2:3] op_sel:[0,0] op_sel_hi:[1,0]
    v_pk_mul_f32 v[68:69], v[68:69], v[2:3] op_sel:[0,0] op_sel_hi:[1,0]
    v_pk_mul_f32 v[70:71], v[70:71], v[2:3] op_sel:[0,0] op_sel_hi:[1,0]
    v_cvt_pk_bf16_f32 v100, v64, v65
    v_cvt_pk_bf16_f32 v101, v66, v67
    v_cvt_pk_bf16_f32 v102, v68, v69
    v_cvt_pk_bf16_f32 v103, v70, v71
    s_cmp_eq_u32 s97, 0
    s_cbranch_scc1 C_sl_13
    buffer_store_dwordx4 v[100:103], v6, s[32:35], s48 offen offset:1024
C_dn_14:
    v_add_u32 v2, 99328, v6
    s_waitcnt vmcnt(0)
    s_mov_b64 exec, 1
    s_cmp_eq_u32 s97, 0
    s_cbranch_scc1 C_sl_15
    buffer_store_dword v5, v4, s[32:35], s49 offen
C_dn_16:
    s_mov_b64 exec, -1
    s_and_b32 s99, s6, 3
    s_lshl_b32 s99, s99, 2
    s_add_u32 s99, s99, s3
    s_lshl_b32 s48, s47, 15
    s_lshl_b32 s100, s99, 11
    s_add_u32 s48, s48, s100
    s_add_u32 s48, s48, 6291456
    s_lshl_b32 s49, s47, 12
    s_lshl_b32 s101, s99, 8
    s_add_u32 s49, s49, s101
    s_add_u32 s49, s49, 262144
    s_lshl_b32 s58, s47, 6
    s_lshl_b32 s99, s99, 2
    s_add_u32 s58, s58, s99
    s_add_u32 s58, s58, 12288
    s_lshr_b32 s50, s44, 1
    s_lshl_b32 s50, s50, 2
    s_add_u32 s50, s50, s3
    s_and_b32 s51, s5, 15
    s_lshl_b32 s98, s50, 15
    s_add_u32 s98, s98, 6291456
    s_lshr_b32 s99, s5, 4
    s_lshl_b32 s99, s99, 14
    s_add_u32 s52, s98, s99
    s_xor_b32 s99, s99, 16384
    s_add_u32 s53, s98, s99
    s_lshl_b32 s54, s50, 6
    s_lshl_b32 s98, s51, 2
    s_add_u32 s56, s54, s98
    s_add_u32 s54, s54, 12288
    s_mul_i32 s55, s50, 114688
    s_add_u32 s55, s55, 8388608
    v_lshrrev_b32 v120, 5, v0
    v_bfe_u32 v121, v0, 4, 1
    v_bfe_u32 v122, v0, 2, 2
    v_and_b32 v123, 3, v0
    v_lshrrev_b32 v124, 1, v123
    v_lshlrev_b32 v124, 4, v124
    v_and_b32 v125, 1, v123
    v_lshl_add_u32 v124, v125, 3, v124
    v_mul_u32_u24 v125, 4, v120
    v_add_u32 v125, v125, v122
    v_mul_u32_u24 v125, 96, v125
    v_add_u32 v124, v124, v125
    v_mul_u32_u24 v125, 6272, v121
    v_add_u32 v124, v124, v125
    v_add_u32 v10, 0, v124
    v_lshrrev_b32 v120, 5, v0
    v_bfe_u32 v121, v0, 4, 1
    v_bfe_u32 v122, v0, 2, 2
    v_and_b32 v123, 3, v0
    v_lshrrev_b32 v124, 1, v123
    v_and_b32 v125, 2, v122
    v_lshl_add_u32 v125, v121, 2, v125
    v_xor_b32 v124, v124, v125
    v_lshlrev_b32 v124, 4, v124
    v_and_b32 v125, 1, v123
    v_lshl_add_u32 v124, v125, 3, v124
    v_mul_u32_u24 v125, 4, v120
    v_add_u32 v125, v125, v122
    v_mul_u32_u24 v125, 128, v125
    v_add_u32 v124, v124, v125
    v_mul_u32_u24 v125, 8192, v121
    v_add_u32 v124, v124, v125
    v_add_u32 v13, 0, v124
    v_add_u32 v12, 49152, v10
    v_add_u32 v13, 132096, v13
    v_lshlrev_b32 v8, 3, v0
    v_add_u32 v8, 159744, v8
    s_lshr_b32 s57, s3, 1
    s_and_b32 s59, s3, 1
    s_lshl_b32 s98, s44, 1
    s_add_u32 s59, s59, s98
    s_mul_i32 s60, s59, 114688
    s_add_u32 s60, s60, 8388608
    s_mul_i32 s98, s57, 2097152
    s_lshl_b32 s61, s59, 15
    s_add_u32 s61, s61, s98
    s_add_u32 s61, s61, 4194304
    s_mul_i32 s98, s57, 24576
    s_add_u32 s60, s60, s98
    s_lshl_b32 s62, s59, 6
    s_lshl_b32 s98, s57, 5
    s_add_u32 s62, s62, s98
    s_add_u32 s62, s62, 16384
    s_lshl_b32 s99, s57, 2
    v_lshrrev_b32 v120, 5, v0
    v_bfe_u32 v121, v0, 4, 1
    v_bfe_u32 v122, v0, 2, 2
    v_and_b32 v123, 3, v0
    v_lshrrev_b32 v124, 1, v123
    v_lshl_add_u32 v124, v121, 1, v124
    v_add_u32 v124, s99, v124
    v_and_b32 v125, 2, v122
    v_lshlrev_b32 v125, 1, v125
    v_xor_b32 v124, v124, v125
    v_lshlrev_b32 v124, 4, v124
    v_and_b32 v125, 1, v123
    v_lshl_add_u32 v124, v125, 3, v124
    v_mul_u32_u24 v125, 4, v120
    v_add_u32 v125, v125, v122
    v_mul_u32_u24 v125, 128, v125
    v_add_u32 v124, v124, v125
    v_add_u32 v14, 0, v124
    v_xor_b32 v15, 64, v14
    v_and_b32 v120, 31, v0
    v_and_b32 v121, 15, v0
    s_lshl_b32 s98, s3, 2
    v_xor_b32 v121, s98, v121
    v_lshlrev_b32 v121, 4, v121
    v_lshl_add_u32 v121, v120, 8, v121
    v_lshrrev_b32 v120, 5, v0
    v_lshl_add_u32 v121, v120, 3, v121
    v_add_u32 v121, 148480, v121
    s_mov_b32 s95, 0
C_cw_17:
    ds_read_b32 v1, v11 offset:24
    s_add_u32 s95, s95, 1
    s_cmp_gt_u32 s95, 16777216
    s_cbranch_scc1 C_cb_18
    s_waitcnt lgkmcnt(0)
    v_readfirstlane_b32 s98, v1
    s_nop 1
    s_cmp_lt_u32 s98, 1
    s_nop 0
    s_cbranch_scc1 C_cw_17
C_cb_18:
    s_waitcnt lgkmcnt(0)
    v_xor_b32 v120, 0, v121
    ds_read_b64 v[112:113], v120
    v_xor_b32 v120, 16, v121
    ds_read_b64 v[114:115], v120
    v_xor_b32 v120, 32, v121
    ds_read_b64 v[116:117], v120
    v_xor_b32 v120, 48, v121
    ds_read_b64 v[118:119], v120
    s_waitcnt lgkmcnt(3)
    v_lshlrev_b32 v16, 16, v112
    v_and_b32 v17, 0xffff0000, v112
    v_lshlrev_b32 v18, 16, v113
    v_and_b32 v19, 0xffff0000, v113
    s_waitcnt lgkmcnt(2)
    v_lshlrev_b32 v20, 16, v114
    v_and_b32 v21, 0xffff0000, v114
    v_lshlrev_b32 v22, 16, v115
    v_and_b32 v23, 0xffff0000, v115
    s_waitcnt lgkmcnt(1)
    v_lshlrev_b32 v24, 16, v116
    v_and_b32 v25, 0xffff0000, v116
    v_lshlrev_b32 v26, 16, v117
    v_and_b32 v27, 0xffff0000, v117
    s_waitcnt lgkmcnt(0)
    v_lshlrev_b32 v28, 16, v118
    v_and_b32 v29, 0xffff0000, v118
    v_lshlrev_b32 v30, 16, v119
    v_and_b32 v31, 0xffff0000, v119
    s_add_u32 s98, s7, s6
    s_add_u32 s98, s98, 0
    s_mul_i32 s99, s98, 86
    s_lshr_b32 s99, s99, 8
    s_mul_i32 s99, s99, 3
    s_sub_u32 s98, s98, s99
    s_lshl_b32 s98, s98, 13
    s_add_u32 s16, s98, s60
    s_add_u32 s98, s7, s6
    s_add_u32 s98, s98, 1
    s_mul_i32 s99, s98, 86
    s_lshr_b32 s99, s99, 8
    s_mul_i32 s99, s99, 3
    s_sub_u32 s98, s98, s99
    s_lshl_b32 s98, s98, 13
    s_add_u32 s17, s98, s60
    s_add_u32 s98, s7, s6
    s_add_u32 s98, s98, 2
    s_mul_i32 s99, s98, 86
    s_lshr_b32 s99, s99, 8
    s_mul_i32 s99, s99, 3
    s_sub_u32 s98, s98, s99
    s_lshl_b32 s98, s98, 13
    s_add_u32 s18, s98, s60
    s_add_u32 s98, s7, s6
    s_add_u32 s98, s98, 0
    s_and_b32 s98, s98, 3
    s_lshl_b32 s98, s98, 13
    s_add_u32 s19, s98, s61
    s_add_u32 s98, s7, s6
    s_add_u32 s98, s98, 1
    s_and_b32 s98, s98, 3
    s_lshl_b32 s98, s98, 13
    s_add_u32 s20, s98, s61
    s_add_u32 s98, s7, s6
    s_add_u32 s98, s98, 2
    s_and_b32 s98, s98, 3
    s_lshl_b32 s98, s98, 13
    s_add_u32 s21, s98, s61
    s_add_u32 s98, s7, s6
    s_add_u32 s98, s98, 3
    s_and_b32 s98, s98, 3
    s_lshl_b32 s98, s98, 13
    s_add_u32 s22, s98, s61
    s_mov_b32 s95, 0
C_cw_19:
    ds_read_b32 v1, v11 offset:16
    s_add_u32 s95, s95, 1
    s_cmp_gt_u32 s95, 16777216
    s_cbranch_scc1 C_cb_20
    s_waitcnt lgkmcnt(0)
    v_readfirstlane_b32 s98, v1
    s_nop 1
    s_cmp_lt_u32 s98, 1
    s_nop 0
    s_cbranch_scc1 C_cw_19
C_cb_20:
    s_waitcnt lgkmcnt(0)
    ds_read_b128 v[32:35], v2 offset:0
    ds_read_b128 v[36:39], v2 offset:1024
    ds_read_b128 v[40:43], v2 offset:2048
    ds_read_b128 v[44:47], v2 offset:3072
    ds_read_b128 v[48:51], v2 offset:4096
    ds_read_b128 v[52:55], v2 offset:5120
    ds_read_b128 v[56:59], v2 offset:6144
    ds_read_b32 v1, v11 offset:16
    ds_read_b128 v[60:63], v2 offset:7168
    s_waitcnt lgkmcnt(8)
    v_mfma_f32_32x32x16_bf16 v[16:31], v[128:131], v[32:35], v[16:31]
    s_waitcnt lgkmcnt(1)
    v_readfirstlane_b32 s95, v1
    s_nop 1
    s_cmp_lt_u32 s95, 2
    s_cbranch_scc1 C_rare_21
C_back_22:
    ds_read_b128 v[32:35], v2 offset:8192
    v_mfma_f32_32x32x16_bf16 v[16:31], v[132:135], v[36:39], v[16:31]
    ds_read_b128 v[36:39], v2 offset:9216
    v_mfma_f32_32x32x16_bf16 v[16:31], v[136:139], v[40:43], v[16:31]
    ds_read_b128 v[40:43], v2 offset:10240
    v_mfma_f32_32x32x16_bf16 v[16:31], v[140:143], v[44:47], v[16:31]
    ds_read_b128 v[44:47], v2 offset:11264
    v_mfma_f32_32x32x16_bf16 v[16:31], v[144:147], v[48:51], v[16:31]
    ds_read_b128 v[48:51], v2 offset:12288
    v_mfma_f32_32x32x16_bf16 v[16:31], v[148:151], v[52:55], v[16:31]
    ds_read_b128 v[52:55], v2 offset:13312
    v_mfma_f32_32x32x16_bf16 v[16:31], v[152:155], v[56:59], v[16:31]
    ds_read_b128 v[56:59], v2 offset:14336
    s_waitcnt lgkmcnt(7)
    v_mfma_f32_32x32x16_bf16 v[16:31], v[156:159], v[60:63], v[16:31]
    ds_read_b32 v1, v11 offset:16
    ds_read_b128 v[60:63], v2 offset:15360
    s_waitcnt lgkmcnt(8)
    v_mfma_f32_32x32x16_bf16 v[16:31], v[160:163], v[32:35], v[16:31]
    s_waitcnt lgkmcnt(1)
    v_readfirstlane_b32 s95, v1
    s_nop 1
    s_cmp_lt_u32 s95, 3
    s_cbranch_scc1 C_rare_24
C_back_25:
    ds_read_b128 v[32:35], v2 offset:16384
    v_mfma_f32_32x32x16_bf16 v[16:31], v[164:167], v[36:39], v[16:31]
    ds_read_b128 v[36:39], v2 offset:17408
    v_mfma_f32_32x32x16_bf16 v[16:31], v[168:171], v[40:43], v[16:31]
    ds_read_b128 v[40:43], v2 offset:18432
    v_mfma_f32_32x32x16_bf16 v[16:31], v[172:175], v[44:47], v[16:31]
    ds_read_b128 v[44:47], v2 offset:19456
    v_mfma_f32_32x32x16_bf16 v[16:31], v[176:179], v[48:51], v[16:31]
    ds_read_b128 v[48:51], v2 offset:20480
    v_mfma_f32_32x32x16_bf16 v[16:31], v[180:183], v[52:55], v[16:31]
    ds_read_b128 v[52:55], v2 offset:21504
    v_mfma_f32_32x32x16_bf16 v[16:31], v[184:187], v[56:59], v[16:31]
    ds_read_b128 v[56:59], v2 offset:22528
    s_waitcnt lgkmcnt(7)
    v_mfma_f32_32x32x16_bf16 v[16:31], v[188:191], v[60:63], v[16:31]
    ds_read_b32 v1, v11 offset:16
    ds_read_b128 v[60:63], v2 offset:23552
    s_waitcnt lgkmcnt(8)
    v_mfma_f32_32x32x16_bf16 v[16:31], v[192:195], v[32:35], v[16:31]
    s_waitcnt lgkmcnt(1)
    v_readfirstlane_b32 s95, v1
    s_nop 1
    s_cmp_lt_u32 s95, 4
    s_cbranch_scc1 C_rare_27
C_back_28:
    ds_read_b128 v[32:35], v2 offset:24576
    v_mfma_f32_32x32x16_bf16 v[16:31], v[196:199], v[36:39], v[16:31]
    ds_read_b128 v[36:39], v2 offset:25600
    v_mfma_f32_32x32x16_bf16 v[16:31], v[200:203], v[40:43], v[16:31]
    ds_read_b128 v[40:43], v2 offset:26624
    v_mfma_f32_32x32x16_bf16 v[16:31], v[204:207], v[44:47], v[16:31]
    ds_read_b128 v[44:47], v2 offset:27648
    v_mfma_f32_32x32x16_bf16 v[16:31], v[208:211], v[48:51], v[16:31]
    ds_read_b128 v[48:51], v2 offset:28672
    v_mfma_f32_32x32x16_bf16 v[16:31], v[212:215], v[52:55], v[16:31]
    ds_read_b128 v[52:55], v2 offset:29696
    v_mfma_f32_32x32x16_bf16 v[16:31], v[216:219], v[56:59], v[16:31]
    ds_read_b128 v[56:59], v2 offset:30720
    s_waitcnt lgkmcnt(7)
    v_mfma_f32_32x32x16_bf16 v[16:31], v[220:223], v[60:63], v[16:31]
    ds_read_b128 v[60:63], v2 offset:31744
    s_waitcnt lgkmcnt(7)
    v_mfma_f32_32x32x16_bf16 v[16:31], v[224:227], v[32:35], v[16:31]
    s_waitcnt lgkmcnt(6)
    v_mfma_f32_32x32x16_bf16 v[16:31], v[228:231], v[36:39], v[16:31]
    s_waitcnt lgkmcnt(5)
    v_mfma_f32_32x32x16_bf16 v[16:31], v[232:235], v[40:43], v[16:31]
    s_waitcnt lgkmcnt(4)
    v_mfma_f32_32x32x16_bf16 v[16:31], v[236:239], v[44:47], v[16:31]
    s_waitcnt lgkmcnt(3)
    v_mfma_f32_32x32x16_bf16 v[16:31], v[240:243], v[48:51], v[16:31]
    s_waitcnt lgkmcnt(2)
    v_mfma_f32_32x32x16_bf16 v[16:31], v[244:247], v[52:55], v[16:31]
    s_waitcnt lgkmcnt(1)
    v_mfma_f32_32x32x16_bf16 v[16:31], v[248:251], v[56:59], v[16:31]
    s_waitcnt lgkmcnt(0)
    v_mfma_f32_32x32x16_bf16 v[16:31], v[252:255], v[60:63], v[16:31]
    v_mov_b32 v1, 0
    v_mov_b32 v2, 0
    s_nop 9
    v_cvt_pk_bf16_f32 v96, v16, v17
    v_cvt_pk_bf16_f32 v97, v18, v19
    v_cvt_pk_bf16_f32 v98, v20, v21
    v_cvt_pk_bf16_f32 v99, v22, v23
    v_cvt_pk_bf16_f32 v100, v24, v25
    v_cvt_pk_bf16_f32 v101, v26, v27
    v_cvt_pk_bf16_f32 v102, v28, v29
    v_cvt_pk_bf16_f32 v103, v30, v31
    s_cmp_eq_u32 s97, 0
    s_cbranch_scc1 C_sl_30
    buffer_store_dwordx4 v[96:99], v6, s[32:35], s48 offen
    buffer_store_dwordx4 v[100:103], v6, s[32:35], s48 offen offset:1024
C_dn_31:
    v_dot2_f32_bf16 v1, v96, v9, v1
    v_dot2_f32_bf16 v2, v96, v96, v2
    v_dot2_f32_bf16 v1, v97, v9, v1
    v_dot2_f32_bf16 v2, v97, v97, v2
    v_dot2_f32_bf16 v1, v98, v9, v1
    v_dot2_f32_bf16 v2, v98, v98, v2
    v_dot2_f32_bf16 v1, v99, v9, v1
    v_dot2_f32_bf16 v2, v99, v99, v2
    v_dot2_f32_bf16 v1, v100, v9, v1
    v_dot2_f32_bf16 v2, v100, v100, v2
    v_dot2_f32_bf16 v1, v101, v9, v1
    v_dot2_f32_bf16 v2, v101, v101, v2
    v_dot2_f32_bf16 v1, v102, v9, v1
    v_dot2_f32_bf16 v2, v102, v102, v2
    v_dot2_f32_bf16 v1, v103, v9, v1
    v_dot2_f32_bf16 v2, v103, v103, v2
    s_nop 2
    v_permlane32_swap_b32 v1, v2
    v_add_f32 v1, v1, v2
    s_cmp_eq_u32 s97, 0
    s_cbranch_scc1 C_sl_32
    buffer_store_dword v1, v3, s[32:35], s49 offen
C_dn_33:
    s_waitcnt vmcnt(0)
    s_mov_b64 exec, 1
    s_cmp_eq_u32 s97, 0
    s_cbranch_scc1 C_sl_34
    buffer_store_dword v5, v4, s[32:35], s58 offen
C_dn_35:
    s_or_b32 s98, s2, s3
    s_cmp_lg_u32 s98, 0
    s_cbranch_scc1 C_ne_36
    buffer_store_dword v5, v4, s[32:35], 0 offen sc1
C_ne_36:
    s_mov_b64 exec, -1
    s_mov_b64 exec, 0xffff
    s_mov_b32 s95, 0
C_pf_37:
    buffer_load_dword v1, v3, s[32:35], s54 offen sc1
    s_add_u32 s95, s95, 1
    s_cmp_gt_u32 s95, 262144
    s_cbranch_scc1 C_pb_38
    s_waitcnt vmcnt(0)
    v_cmp_ne_u32 vcc, s96, v1
    s_nop 3
    s_cbranch_vccnz C_pf_37
C_pb_38:
    s_waitcnt vmcnt(0)
    s_mov_b64 exec, -1
    s_add_u32 s1, s52, 0
    buffer_load_dwordx4 v[128:131], v6, s[32:35], s1 offen sc1
    buffer_load_dwordx4 v[132:135], v6, s[32:35], s1 offen offset:1024 sc1
    buffer_load_dwordx4 v[136:139], v6, s[32:35], s1 offen offset:2048 sc1
    buffer_load_dwordx4 v[140:143], v6, s[32:35], s1 offen offset:3072 sc1
    s_add_u32 s1, s52, 4096
    buffer_load_dwordx4 v[144:147], v6, s[32:35], s1 offen sc1
    buffer_load_dwordx4 v[148:151], v6, s[32:35], s1 offen offset:1024 sc1
    s_lshl_b32 s100, s50, 12
    s_add_u32 s100, s100, 262144
    v_xor_b32 v2, 0, v13
    v_xor_b32 v9, 32, v13
    v_xor_b32 v11, 64, v13
    v_and_b32 v7, 7, v0
    v_lshlrev_b32 v7, 2, v7
    s_barrier
    ds_read_b64_tr_b16 v[80:81], v10 offset:0
    ds_read_b64_tr_b16 v[82:83], v10 offset:768
    ds_read_b64_tr_b16 v[84:85], v10 offset:32
    ds_read_b64_tr_b16 v[86:87], v10 offset:800
    ds_read_b64_tr_b16 v[88:89], v10 offset:64
    ds_read_b64_tr_b16 v[90:91], v10 offset:832
    ds_read_b64_tr_b16 v[92:93], v10 offset:1536
    ds_read_b64_tr_b16 v[94:95], v10 offset:2304
    ds_read_b64_tr_b16 v[96:97], v10 offset:1568
    ds_read_b64_tr_b16 v[98:99], v10 offset:2336
    ds_read_b64_tr_b16 v[100:101], v10 offset:1600
    ds_read_b64_tr_b16 v[102:103], v10 offset:2368
    ds_read_b64_tr_b16 v[104:105], v10 offset:3072
    ds_read_b64_tr_b16 v[106:107], v10 offset:3840
    ds_read_b64_tr_b16 v[108:109], v10 offset:3104
    ds_read_b64_tr_b16 v[110:111], v10 offset:3872
    s_waitcnt vmcnt(5) lgkmcnt(12)
    v_mfma_f32_32x32x16_bf16 v[16:31], v[80:83], v[128:131], 0
    buffer_load_dwordx4 v[152:155], v6, s[32:35], s1 offen offset:2048 sc1
    ds_read_b64_tr_b16 v[80:81], v10 offset:3136
    ds_read_b64_tr_b16 v[82:83], v10 offset:3904
    v_mfma_f32_32x32x16_bf16 v[32:47], v[84:87], v[128:131], 0
    buffer_load_dword v64, v3, s[32:35], s100 offen offset:0 sc1
    ds_read_b64_tr_b16 v[84:85], v10 offset:4608
    ds_read_b64_tr_b16 v[86:87], v10 offset:5376
    s_waitcnt lgkmcnt(12)
    v_mfma_f32_32x32x16_bf16 v[48:63], v[88:91], v[128:131], 0
    ds_read_b64_tr_b16 v[88:89], v10 offset:4640
    ds_read_b64_tr_b16 v[90:91], v10 offset:5408
    s_waitcnt vmcnt(6)
    v_mfma_f32_32x32x16_bf16 v[16:31], v[92:95], v[132:135], v[16:31]
    buffer_load_dwordx4 v[156:159], v6, s[32:35], s1 offen offset:3072 sc1
    ds_read_b64_tr_b16 v[92:93], v10 offset:4672
    ds_read_b64_tr_b16 v[94:95], v10 offset:5440
    s_waitcnt lgkmcnt(12)
    v_mfma_f32_32x32x16_bf16 v[32:47], v[96:99], v[132:135], v[32:47]
    buffer_load_dword v65, v3, s[32:35], s100 offen offset:256 sc1
    ds_read_b64_tr_b16 v[96:97], v10 offset:12416
    ds_read_b64_tr_b16 v[98:99], v10 offset:13184
    v_mfma_f32_32x32x16_bf16 v[48:63], v[100:103], v[132:135], v[48:63]
    ds_read_b64_tr_b16 v[100:101], v10 offset:12448
    ds_read_b64_tr_b16 v[102:103], v10 offset:13216
    s_waitcnt vmcnt(7) lgkmcnt(12)
    v_mfma_f32_32x32x16_bf16 v[16:31], v[104:107], v[136:139], v[16:31]
    s_add_u32 s1, s52, 8192
    buffer_load_dwordx4 v[160:163], v6, s[32:35], s1 offen sc1
    ds_read_b64_tr_b16 v[104:105], v10 offset:12480
    ds_read_b64_tr_b16 v[106:107], v10 offset:13248
    v_mfma_f32_32x32x16_bf16 v[32:47], v[108:111], v[136:139], v[32:47]
    buffer_load_dword v66, v3, s[32:35], s100 offen offset:512 sc1
    ds_read_b64_tr_b16 v[108:109], v10 offset:13952
    ds_read_b64_tr_b16 v[110:111], v10 offset:14720
    s_waitcnt lgkmcnt(12)
    v_mfma_f32_32x32x16_bf16 v[48:63], v[80:83], v[136:139], v[48:63]
    ds_read_b64_tr_b16 v[80:81], v10 offset:13984
    ds_read_b64_tr_b16 v[82:83], v10 offset:14752
    s_waitcnt vmcnt(8)
    v_mfma_f32_32x32x16_bf16 v[16:31], v[84:87], v[140:143], v[16:31]
    buffer_load_dwordx4 v[164:167], v6, s[32:35], s1 offen offset:1024 sc1
    ds_read_b64_tr_b16 v[84:85], v10 offset:14016
    ds_read_b64_tr_b16 v[86:87], v10 offset:14784
    s_waitcnt lgkmcnt(12)
    v_mfma_f32_32x32x16_bf16 v[32:47], v[88:91], v[140:143], v[32:47]
    buffer_load_dword v67, v3, s[32:35], s100 offen offset:768 sc1
    ds_read_b64_tr_b16 v[88:89], v10 offset:15488
    ds_read_b64_tr_b16 v[90:91], v10 offset:16256
    v_mfma_f32_32x32x16_bf16 v[48:63], v[92:95], v[140:143], v[48:63]
    s_barrier
    ds_read_b64_tr_b16 v[92:93], v10 offset:15520
    ds_read_b64_tr_b16 v[94:95], v10 offset:16288
    s_waitcnt vmcnt(9) lgkmcnt(12)
    v_mfma_f32_32x32x16_bf16 v[16:31], v[96:99], v[144:147], v[16:31]
    buffer_load_dwordx4 v[168:171], v6, s[32:35], s1 offen offset:2048 sc1
    ds_read_b64_tr_b16 v[96:97], v10 offset:15552
    ds_read_b64_tr_b16 v[98:99], v10 offset:16320
    v_mfma_f32_32x32x16_bf16 v[32:47], v[100:103], v[144:147], v[32:47]
    buffer_load_dword v68, v3, s[32:35], s100 offen offset:1024 sc1
    ds_read_b64_tr_b16 v[100:101], v10 offset:17024
    ds_read_b64_tr_b16 v[102:103], v10 offset:17792
    s_waitcnt lgkmcnt(12)
    v_mfma_f32_32x32x16_bf16 v[48:63], v[104:107], v[144:147], v[48:63]
    ds_read_b64_tr_b16 v[104:105], v10 offset:17056
    ds_read_b64_tr_b16 v[106:107], v10 offset:17824
    s_waitcnt vmcnt(10)
    v_mfma_f32_32x32x16_bf16 v[16:31], v[108:111], v[148:151], v[16:31]
    buffer_load_dwordx4 v[172:175], v6, s[32:35], s1 offen offset:3072 sc1
    ds_read_b64_tr_b16 v[108:109], v10 offset:17088
    ds_read_b64_tr_b16 v[110:111], v10 offset:17856
    s_waitcnt lgkmcnt(12)
    v_mfma_f32_32x32x16_bf16 v[32:47], v[80:83], v[148:151], v[32:47]
    buffer_load_dword v69, v3, s[32:35], s100 offen offset:1280 sc1
    ds_read_b64_tr_b16 v[80:81], v10 offset:24832
    ds_read_b64_tr_b16 v[82:83], v10 offset:25600
    v_mfma_f32_32x32x16_bf16 v[48:63], v[84:87], v[148:151], v[48:63]
    ds_read_b64_tr_b16 v[84:85], v10 offset:24864
    ds_read_b64_tr_b16 v[86:87], v10 offset:25632
    s_waitcnt vmcnt(11) lgkmcnt(12)
    v_mfma_f32_32x32x16_bf16 v[16:31], v[88:91], v[152:155], v[16:31]
    s_add_u32 s1, s52, 12288
    buffer_load_dwordx4 v[176:179], v6, s[32:35], s1 offen sc1
    ds_read_b64_tr_b16 v[88:89], v10 offset:24896
    ds_read_b64_tr_b16 v[90:91], v10 offset:25664
    v_mfma_f32_32x32x16_bf16 v[32:47], v[92:95], v[152:155], v[32:47]
    buffer_load_dword v70, v3, s[32:35], s100 offen offset:1536 sc1
    ds_read_b64_tr_b16 v[92:93], v10 offset:26368
    ds_read_b64_tr_b16 v[94:95], v10 offset:27136
    s_waitcnt lgkmcnt(12)
    v_mfma_f32_32x32x16_bf16 v[48:63], v[96:99], v[152:155], v[48:63]
    ds_read_b64_tr_b16 v[96:97], v10 offset:26400
    ds_read_b64_tr_b16 v[98:99], v10 offset:27168
    s_waitcnt vmcnt(11)
    v_mfma_f32_32x32x16_bf16 v[16:31], v[100:103], v[156:159], v[16:31]
    buffer_load_dwordx4 v[180:183], v6, s[32:35], s1 offen offset:1024 sc1
    ds_read_b64_tr_b16 v[100:101], v10 offset:26432
    ds_read_b64_tr_b16 v[102:103], v10 offset:27200
    s_waitcnt lgkmcnt(12)
    v_mfma_f32_32x32x16_bf16 v[32:47], v[104:107], v[156:159], v[32:47]
    buffer_load_dword v71, v3, s[32:35], s100 offen offset:1792 sc1
    ds_read_b64_tr_b16 v[104:105], v10 offset:27904
    ds_read_b64_tr_b16 v[106:107], v10 offset:28672
    v_mfma_f32_32x32x16_bf16 v[48:63], v[108:111], v[156:159], v[48:63]
    s_barrier
    ds_read_b64_tr_b16 v[108:109], v10 offset:27936
    ds_read_b64_tr_b16 v[110:111], v10 offset:28704
    s_waitcnt vmcnt(11) lgkmcnt(12)
    v_mfma_f32_32x32x16_bf16 v[16:31], v[80:83], v[160:163], v[16:31]
    buffer_load_dwordx4 v[184:187], v6, s[32:35], s1 offen offset:2048 sc1
    ds_read_b64_tr_b16 v[80:81], v10 offset:27968
    ds_read_b64_tr_b16 v[82:83], v10 offset:28736
    v_mfma_f32_32x32x16_bf16 v[32:47], v[84:87], v[160:163], v[32:47]
    buffer_load_dword v72, v3, s[32:35], s100 offen offset:2048 sc1
    ds_read_b64_tr_b16 v[84:85], v10 offset:29440
    ds_read_b64_tr_b16 v[86:87], v10 offset:30208
    s_waitcnt lgkmcnt(12)
    v_mfma_f32_32x32x16_bf16 v[48:63], v[88:91], v[160:163], v[48:63]
    s_lshl_b32 s98, s59, 15
    s_lshl_b32 s99, s6, 12
    s_add_u32 s98, s98, s99
    s_lshl_b32 s99, s57, 11
    s_add_u32 s98, s98, s99
    s_add_u32 s98, s98, 6291456
    s_lshl_b32 s26, s3, 11
    s_add_u32 s26, s26, 148480
    s_mov_b32 m0, s26
    s_nop 0
    buffer_load_dwordx4 v6, s[32:35], s98 offen sc1 lds
    buffer_load_dwordx4 v6, s[32:35], s98 offen offset:1024 sc1 lds
    ds_read_b64_tr_b16 v[88:89], v10 offset:29472
    ds_read_b64_tr_b16 v[90:91], v10 offset:30240
    s_waitcnt vmcnt(13)
    v_mfma_f32_32x32x16_bf16 v[16:31], v[92:95], v[164:167], v[16:31]
    buffer_load_dwordx4 v[188:191], v6, s[32:35], s1 offen offset:3072 sc1
    ds_read_b64_tr_b16 v[92:93], v10 offset:29504
    ds_read_b64_tr_b16 v[94:95], v10 offset:30272
    s_waitcnt lgkmcnt(12)
    v_mfma_f32_32x32x16_bf16 v[32:47], v[96:99], v[164:167], v[32:47]
    buffer_load_dword v73, v3, s[32:35], s100 offen offset:2304 sc1
    ds_read_b64_tr_b16 v[96:97], v10 offset:37248
    ds_read_b64_tr_b16 v[98:99], v10 offset:38016
    v_mfma_f32_32x32x16_bf16 v[48:63], v[100:103], v[164:167], v[48:63]
    ds_read_b64_tr_b16 v[100:101], v10 offset:37280
    ds_read_b64_tr_b16 v[102:103], v10 offset:38048
    s_waitcnt vmcnt(13) lgkmcnt(12)
    v_mfma_f32_32x32x16_bf16 v[16:31], v[104:107], v[168:171], v[16:31]
    s_add_u32 s1, s53, 0
    buffer_load_dwordx4 v[192:195], v6, s[32:35], s1 offen sc1
    ds_read_b64_tr_b16 v[104:105], v10 offset:37312
    ds_read_b64_tr_b16 v[106:107], v10 offset:38080
    v_mfma_f32_32x32x16_bf16 v[32:47], v[108:111], v[168:171], v[32:47]
    buffer_load_dword v74, v3, s[32:35], s100 offen offset:2560 sc1
    ds_read_b64_tr_b16 v[108:109], v10 offset:38784
    ds_read_b64_tr_b16 v[110:111], v10 offset:39552
    s_waitcnt lgkmcnt(12)
    v_mfma_f32_32x32x16_bf16 v[48:63], v[80:83], v[168:171], v[48:63]
    ds_read_b64_tr_b16 v[80:81], v10 offset:38816
    ds_read_b64_tr_b16 v[82:83], v10 offset:39584
    s_waitcnt vmcnt(13)
    v_mfma_f32_32x32x16_bf16 v[16:31], v[84:87], v[172:175], v[16:31]
    buffer_load_dwordx4 v[196:199], v6, s[32:35], s1 offen offset:1024 sc1
    ds_read_b64_tr_b16 v[84:85], v10 offset:38848
    ds_read_b64_tr_b16 v[86:87], v10 offset:39616
    s_waitcnt lgkmcnt(12)
    v_mfma_f32_32x32x16_bf16 v[32:47], v[88:91], v[172:175], v[32:47]
    buffer_load_dword v75, v3, s[32:35], s100 offen offset:2816 sc1
    ds_read_b64_tr_b16 v[88:89], v10 offset:40320
    ds_read_b64_tr_b16 v[90:91], v10 offset:41088
    v_mfma_f32_32x32x16_bf16 v[48:63], v[92:95], v[172:175], v[48:63]
    s_barrier
    ds_read_b64_tr_b16 v[92:93], v10 offset:40352
    ds_read_b64_tr_b16 v[94:95], v10 offset:41120
    s_waitcnt vmcnt(13) lgkmcnt(12)
    v_mfma_f32_32x32x16_bf16 v[16:31], v[96:99], v[176:179], v[16:31]
    buffer_load_dwordx4 v[200:203], v6, s[32:35], s1 offen offset:2048 sc1
    ds_read_b64_tr_b16 v[96:97], v10 offset:40384
    ds_read_b64_tr_b16 v[98:99], v10 offset:41152
    v_mfma_f32_32x32x16_bf16 v[32:47], v[100:103], v[176:179], v[32:47]
    buffer_load_dword v76, v3, s[32:35], s100 offen offset:3072 sc1
    ds_read_b64_tr_b16 v[100:101], v10 offset:41856
    ds_read_b64_tr_b16 v[102:103], v10 offset:42624
    s_waitcnt lgkmcnt(12)
    v_mfma_f32_32x32x16_bf16 v[48:63], v[104:107], v[176:179], v[48:63]
    ds_read_b64_tr_b16 v[104:105], v10 offset:41888
    ds_read_b64_tr_b16 v[106:107], v10 offset:42656
    s_waitcnt vmcnt(13)
    v_mfma_f32_32x32x16_bf16 v[16:31], v[108:111], v[180:183], v[16:31]
    buffer_load_dwordx4 v[204:207], v6, s[32:35], s1 offen offset:3072 sc1
    ds_read_b64_tr_b16 v[108:109], v10 offset:41920
    ds_read_b64_tr_b16 v[110:111], v10 offset:42688
    s_waitcnt lgkmcnt(12)
    v_mfma_f32_32x32x16_bf16 v[32:47], v[80:83], v[180:183], v[32:47]
    buffer_load_dword v77, v3, s[32:35], s100 offen offset:3328 sc1
    s_mul_i32 s48, s51, 3072
    s_add_u32 s48, s48, s55
    ds_read_b64_tr_b16 v[80:81], v12 offset:512
    ds_read_b64_tr_b16 v[82:83], v12 offset:1280
    v_mfma_f32_32x32x16_bf16 v[48:63], v[84:87], v[180:183], v[48:63]
    s_lshr_b32 s24, s51, 3
    s_mul_i32 s24, s24, 2064384
    s_lshl_b32 s49, s51, 12
    s_add_u32 s49, s49, s24
    s_lshl_b32 s24, s50, 15
    s_add_u32 s49, s49, s24
    s_add_u32 s49, s49, 4194304
    s_lshl_b32 s25, s50, 6
    s_add_u32 s25, s25, 16384
    ds_read_b64_tr_b16 v[84:85], v12 offset:544
    ds_read_b64_tr_b16 v[86:87], v12 offset:1312
    s_waitcnt vmcnt(13) lgkmcnt(12)
    v_mfma_f32_32x32x16_bf16 v[16:31], v[88:91], v[184:187], v[16:31]
    s_add_u32 s1, s53, 4096
    buffer_load_dwordx4 v[208:211], v6, s[32:35], s1 offen sc1
    ds_read_b64_tr_b16 v[88:89], v12 offset:576
    ds_read_b64_tr_b16 v[90:91], v12 offset:1344
    v_mfma_f32_32x32x16_bf16 v[32:47], v[92:95], v[184:187], v[32:47]
    buffer_load_dword v78, v3, s[32:35], s100 offen offset:3584 sc1
    ds_read_b64_tr_b16 v[92:93], v12 offset:2048
    ds_read_b64_tr_b16 v[94:95], v12 offset:2816
    s_waitcnt lgkmcnt(12)
    v_mfma_f32_32x32x16_bf16 v[48:63], v[96:99], v[184:187], v[48:63]
    ds_read_b64_tr_b16 v[96:97], v12 offset:2080
    ds_read_b64_tr_b16 v[98:99], v12 offset:2848
    s_waitcnt vmcnt(11)
    v_mfma_f32_32x32x16_bf16 v[16:31], v[100:103], v[188:191], v[16:31]
    buffer_load_dwordx4 v[212:215], v6, s[32:35], s1 offen offset:1024 sc1
    ds_read_b64_tr_b16 v[100:101], v12 offset:2112
    ds_read_b64_tr_b16 v[102:103], v12 offset:2880
    s_waitcnt lgkmcnt(12)
    v_mfma_f32_32x32x16_bf16 v[32:47], v[104:107], v[188:191], v[32:47]
    buffer_load_dword v79, v3, s[32:35], s100 offen offset:3840 sc1
    ds_read_b64_tr_b16 v[104:105], v12 offset:3584
    ds_read_b64_tr_b16 v[106:107], v12 offset:4352
    v_mfma_f32_32x32x16_bf16 v[48:63], v[108:111], v[188:191], v[48:63]
    s_barrier
    ds_read_b64_tr_b16 v[108:109], v12 offset:3616
    ds_read_b64_tr_b16 v[110:111], v12 offset:4384
    s_waitcnt vmcnt(11) lgkmcnt(12)
    v_mfma_f32_32x32x16_bf16 v[16:31], v[80:83], v[192:195], v[16:31]
    buffer_load_dwordx4 v[216:219], v6, s[32:35], s1 offen offset:2048 sc1
    ds_read_b64_tr_b16 v[80:81], v12 offset:3648
    ds_read_b64_tr_b16 v[82:83], v12 offset:4416
    v_mfma_f32_32x32x16_bf16 v[32:47], v[84:87], v[192:195], v[32:47]
    ds_read_b64_tr_b16 v[84:85], v12 offset:5120
    ds_read_b64_tr_b16 v[86:87], v12 offset:5888
    s_waitcnt lgkmcnt(12)
    v_mfma_f32_32x32x16_bf16 v[48:63], v[88:91], v[192:195], v[48:63]
    ds_read_b64_tr_b16 v[88:89], v12 offset:5152
    ds_read_b64_tr_b16 v[90:91], v12 offset:5920
    s_waitcnt vmcnt(10)
    v_mfma_f32_32x32x16_bf16 v[16:31], v[92:95], v[196:199], v[16:31]
    buffer_load_dwordx4 v[220:223], v6, s[32:35], s1 offen offset:3072 sc1
    ds_read_b64_tr_b16 v[92:93], v12 offset:5184
    ds_read_b64_tr_b16 v[94:95], v12 offset:5952
    s_waitcnt lgkmcnt(12)
    v_mfma_f32_32x32x16_bf16 v[32:47], v[96:99], v[196:199], v[32:47]
    ds_read_b64_tr_b16 v[96:97], v12 offset:12928
    ds_read_b64_tr_b16 v[98:99], v12 offset:13696
    v_mfma_f32_32x32x16_bf16 v[48:63], v[100:103], v[196:199], v[48:63]
    ds_read_b64_tr_b16 v[100:101], v12 offset:12960
    ds_read_b64_tr_b16 v[102:103], v12 offset:13728
    s_waitcnt vmcnt(9) lgkmcnt(12)
    v_mfma_f32_32x32x16_bf16 v[16:31], v[104:107], v[200:203], v[16:31]
    s_add_u32 s1, s53, 8192
    buffer_load_dwordx4 v[224:227], v6, s[32:35], s1 offen sc1
    ds_read_b64_tr_b16 v[104:105], v12 offset:12992
    ds_read_b64_tr_b16 v[106:107], v12 offset:13760
    v_mfma_f32_32x32x16_bf16 v[32:47], v[108:111], v[200:203], v[32:47]
    ds_read_b64_tr_b16 v[108:109], v12 offset:14464
    ds_read_b64_tr_b16 v[110:111], v12 offset:15232
    s_waitcnt lgkmcnt(12)
    v_mfma_f32_32x32x16_bf16 v[48:63], v[80:83], v[200:203], v[48:63]
    ds_read_b64_tr_b16 v[80:81], v12 offset:14496
    ds_read_b64_tr_b16 v[82:83], v12 offset:15264
    s_waitcnt vmcnt(8)
    v_mfma_f32_32x32x16_bf16 v[16:31], v[84:87], v[204:207], v[16:31]
    buffer_load_dwordx4 v[228:231], v6, s[32:35], s1 offen offset:1024 sc1
    ds_read_b64_tr_b16 v[84:85], v12 offset:14528
    ds_read_b64_tr_b16 v[86:87], v12 offset:15296
    s_waitcnt lgkmcnt(12)
    v_mfma_f32_32x32x16_bf16 v[32:47], v[88:91], v[204:207], v[32:47]
    ds_read_b64_tr_b16 v[88:89], v12 offset:16000
    ds_read_b64_tr_b16 v[90:91], v12 offset:16768
    v_mfma_f32_32x32x16_bf16 v[48:63], v[92:95], v[204:207], v[48:63]
    s_barrier
    ds_read_b64_tr_b16 v[92:93], v12 offset:16032
    ds_read_b64_tr_b16 v[94:95], v12 offset:16800
    s_waitcnt vmcnt(7) lgkmcnt(12)
    v_mfma_f32_32x32x16_bf16 v[16:31], v[96:99], v[208:211], v[16:31]
    v_xor_b32 v10, 96, v2
    buffer_load_dwordx4 v[232:235], v6, s[32:35], s1 offen offset:2048 sc1
    ds_read_b64_tr_b16 v[96:97], v12 offset:16064
    ds_read_b64_tr_b16 v[98:99], v12 offset:16832
    v_mfma_f32_32x32x16_bf16 v[32:47], v[100:103], v[208:211], v[32:47]
    ds_read_b64_tr_b16 v[100:101], v12 offset:17536
    ds_read_b64_tr_b16 v[102:103], v12 offset:18304
    s_waitcnt lgkmcnt(12)
    v_mfma_f32_32x32x16_bf16 v[48:63], v[104:107], v[208:211], v[48:63]
    ds_read_b64_tr_b16 v[104:105], v12 offset:17568
    ds_read_b64_tr_b16 v[106:107], v12 offset:18336
    s_waitcnt vmcnt(6)
    v_mfma_f32_32x32x16_bf16 v[16:31], v[108:111], v[212:215], v[16:31]
    buffer_load_dwordx4 v[236:239], v6, s[32:35], s1 offen offset:3072 sc1
    v_pk_add_f32 v[64:65], v[64:65], v[72:73]
    v_pk_add_f32 v[66:67], v[66:67], v[74:75]
    ds_read_b64_tr_b16 v[108:109], v12 offset:17600
    ds_read_b64_tr_b16 v[110:111], v12 offset:18368
    s_waitcnt lgkmcnt(12)
    v_mfma_f32_32x32x16_bf16 v[32:47], v[80:83], v[212:215], v[32:47]
    v_pk_add_f32 v[68:69], v[68:69], v[76:77]
    s_waitcnt vmcnt(6)
    v_pk_add_f32 v[70:71], v[70:71], v[78:79]
    ds_read_b64_tr_b16 v[80:81], v12 offset:25344
    ds_read_b64_tr_b16 v[82:83], v12 offset:26112
    v_mfma_f32_32x32x16_bf16 v[48:63], v[84:87], v[212:215], v[48:63]
    v_pk_add_f32 v[64:65], v[64:65], v[68:69]
    v_pk_add_f32 v[66:67], v[66:67], v[70:71]
    ds_read_b64_tr_b16 v[84:85], v12 offset:25376
    ds_read_b64_tr_b16 v[86:87], v12 offset:26144
    s_waitcnt vmcnt(5) lgkmcnt(12)
    v_mfma_f32_32x32x16_bf16 v[16:31], v[88:91], v[216:219], v[16:31]
    s_add_u32 s1, s53, 12288
    buffer_load_dwordx4 v[240:243], v6, s[32:35], s1 offen sc1
    v_pk_add_f32 v[64:65], v[64:65], v[66:67]
    v_add_f32 v64, v64, v65
    v_mov_b32 v126, 0
    v_mov_b32 v127, 0
    ds_read_b64_tr_b16 v[88:89], v12 offset:25408
    ds_read_b64_tr_b16 v[90:91], v12 offset:26176
    v_mfma_f32_32x32x16_bf16 v[32:47], v[92:95], v[216:219], v[32:47]
    v_mov_b32 v65, v64
    s_nop 1
    v_permlane32_swap_b32 v64, v65
    ds_read_b64_tr_b16 v[92:93], v12 offset:26880
    ds_read_b64_tr_b16 v[94:95], v12 offset:27648
    s_waitcnt lgkmcnt(12)
    v_mfma_f32_32x32x16_bf16 v[48:63], v[96:99], v[216:219], v[48:63]
    v_mul_f32 v64, 0xbb000000, v64
    v_mul_f32 v65, 0x3b000000, v65
    ds_read_b64_tr_b16 v[96:97], v12 offset:26912
    ds_read_b64_tr_b16 v[98:99], v12 offset:27680
    s_waitcnt vmcnt(5)
    v_mfma_f32_32x32x16_bf16 v[16:31], v[100:103], v[220:223], v[16:31]
    buffer_load_dwordx4 v[244:247], v6, s[32:35], s1 offen offset:1024 sc1
    v_fma_f32 v65, -v64, v64, v65
    v_add_f32 v65, 0x3727c5ac, v65
    ds_read_b64_tr_b16 v[100:101], v12 offset:26944
    ds_read_b64_tr_b16 v[102:103], v12 offset:27712
    s_waitcnt lgkmcnt(12)
    v_mfma_f32_32x32x16_bf16 v[32:47], v[104:107], v[220:223], v[32:47]
    v_rcp_f32 v13, v65
    v_and_b32 v66, 0xffff0000, v64
    v_sub_f32 v113, v64, v66
    v_cvt_pk_bf16_f32 v113, v113, 0
    v_cvt_pk_bf16_f32 v112, v66, v66
    ds_read_b64_tr_b16 v[104:105], v12 offset:28416
    ds_read_b64_tr_b16 v[106:107], v12 offset:29184
    v_mfma_f32_32x32x16_bf16 v[48:63], v[108:111], v[220:223], v[48:63]
    v_mov_b32 v114, 0
    v_mov_b32 v115, 0
    ds_read_b64 v[116:117], v8 offset:0
    s_barrier
    ds_read_b64_tr_b16 v[108:109], v12 offset:28448
    ds_read_b64_tr_b16 v[110:111], v12 offset:29216
    s_waitcnt vmcnt(5) lgkmcnt(13)
    v_mfma_f32_32x32x16_bf16 v[16:31], v[80:83], v[224:227], v[16:31]
    buffer_load_dwordx4 v[248:251], v6, s[32:35], s1 offen offset:2048 sc1
    v_mov_b32 v118, 0
    v_mov_b32 v119, 0
    ds_read_b64_tr_b16 v[80:81], v12 offset:28480
    ds_read_b64_tr_b16 v[82:83], v12 offset:29248
    v_mfma_f32_32x32x16_bf16 v[32:47], v[84:87], v[224:227], v[32:47]
    ds_read_b64_tr_b16 v[84:85], v12 offset:29952
    ds_read_b64_tr_b16 v[86:87], v12 offset:30720
    s_waitcnt lgkmcnt(13)
    v_mfma_f32_32x32x16_bf16 v[48:63], v[88:91], v[224:227], v[48:63]
    ds_read_b64_tr_b16 v[88:89], v12 offset:29984
    ds_read_b64_tr_b16 v[90:91], v12 offset:30752
    s_waitcnt vmcnt(5)
    v_mfma_f32_32x32x16_bf16 v[16:31], v[92:95], v[228:231], v[16:31]
    buffer_load_dwordx4 v[252:255], v6, s[32:35], s1 offen offset:3072 sc1
    ds_read_b64_tr_b16 v[92:93], v12 offset:30016
    ds_read_b64_tr_b16 v[94:95], v12 offset:30784
    s_waitcnt lgkmcnt(13)
    v_mfma_f32_32x32x16_bf16 v[32:47], v[96:99], v[228:231], v[32:47]
    ds_read_b64_tr_b16 v[96:97], v12 offset:37760
    ds_read_b64_tr_b16 v[98:99], v12 offset:38528
    v_mfma_f32_32x32x16_bf16 v[48:63], v[100:103], v[228:231], v[48:63]
    ds_read_b64_tr_b16 v[100:101], v12 offset:37792
    ds_read_b64_tr_b16 v[102:103], v12 offset:38560
    s_waitcnt vmcnt(5) lgkmcnt(13)
    v_mfma_f32_32x32x16_bf16 v[16:31], v[104:107], v[232:235], v[16:31]
    v_mfma_f32_32x32x16_bf16 v[16:31], v[116:119], v[112:115], v[16:31]
    ds_read_b64 v[124:125], v8 offset:512
    ds_read_b64_tr_b16 v[104:105], v12 offset:37824
    ds_read_b64_tr_b16 v[106:107], v12 offset:38592
    s_waitcnt lgkmcnt(13)
    v_mfma_f32_32x32x16_bf16 v[32:47], v[108:111], v[232:235], v[32:47]
    ds_read_b64_tr_b16 v[108:109], v12 offset:39296
    ds_read_b64_tr_b16 v[110:111], v12 offset:40064
    v_mfma_f32_32x32x16_bf16 v[48:63], v[80:83], v[232:235], v[48:63]
    ds_read_b64_tr_b16 v[80:81], v12 offset:39328
    ds_read_b64_tr_b16 v[82:83], v12 offset:40096
    s_waitcnt vmcnt(4) lgkmcnt(13)
    v_mfma_f32_32x32x16_bf16 v[16:31], v[84:87], v[236:239], v[16:31]
    ds_read_b64_tr_b16 v[84:85], v12 offset:39360
    ds_read_b64_tr_b16 v[86:87], v12 offset:40128
    v_mfma_f32_32x32x16_bf16 v[32:47], v[88:91], v[236:239], v[32:47]
    ds_read_b64_tr_b16 v[88:89], v12 offset:40832
    ds_read_b64_tr_b16 v[90:91], v12 offset:41600
    s_waitcnt lgkmcnt(13)
    v_mfma_f32_32x32x16_bf16 v[48:63], v[92:95], v[236:239], v[48:63]
    s_barrier
    ds_read_b64_tr_b16 v[92:93], v12 offset:40864
    ds_read_b64_tr_b16 v[94:95], v12 offset:41632
    s_waitcnt vmcnt(3)
    v_mfma_f32_32x32x16_bf16 v[16:31], v[96:99], v[240:243], v[16:31]
    ds_read_b64_tr_b16 v[96:97], v12 offset:40896
    ds_read_b64_tr_b16 v[98:99], v12 offset:41664
    s_waitcnt lgkmcnt(13)
    v_mfma_f32_32x32x16_bf16 v[32:47], v[100:103], v[240:243], v[32:47]
    v_mfma_f32_32x32x16_bf16 v[32:47], v[124:127], v[112:115], v[32:47]
    ds_read_b64 v[116:117], v8 offset:1024
    ds_read_b64_tr_b16 v[100:101], v12 offset:42368
    ds_read_b64_tr_b16 v[102:103], v12 offset:43136
    s_waitcnt lgkmcnt(13)
    v_mfma_f32_32x32x16_bf16 v[48:63], v[104:107], v[240:243], v[48:63]
    ds_read_b64_tr_b16 v[104:105], v12 offset:42400
    ds_read_b64_tr_b16 v[106:107], v12 offset:43168
    s_waitcnt vmcnt(2)
    v_mfma_f32_32x32x16_bf16 v[16:31], v[108:111], v[244:247], v[16:31]
    ds_read_b64_tr_b16 v[108:109], v12 offset:42432
    ds_read_b64_tr_b16 v[110:111], v12 offset:43200
    s_waitcnt lgkmcnt(13)
    v_mfma_f32_32x32x16_bf16 v[32:47], v[80:83], v[244:247], v[32:47]
    ds_read_b64_tr_b16 v[80:81], v10 offset:0
    ds_read_b64_tr_b16 v[82:83], v10 offset:1024
    v_mfma_f32_32x32x16_bf16 v[48:63], v[84:87], v[244:247], v[48:63]
    ds_read_b64_tr_b16 v[84:85], v10 offset:2048
    ds_read_b64_tr_b16 v[86:87], v10 offset:3072
    s_waitcnt vmcnt(1) lgkmcnt(13)
    v_mfma_f32_32x32x16_bf16 v[16:31], v[88:91], v[248:251], v[16:31]
    ds_read_b64_tr_b16 v[88:89], v10 offset:4096
    ds_read_b64_tr_b16 v[90:91], v10 offset:5120
    v_mfma_f32_32x32x16_bf16 v[32:47], v[92:95], v[248:251], v[32:47]
    ds_read_b64_tr_b16 v[92:93], v10 offset:6144
    ds_read_b64_tr_b16 v[94:95], v10 offset:7168
    s_waitcnt lgkmcnt(13)
    v_mfma_f32_32x32x16_bf16 v[48:63], v[96:99], v[248:251], v[48:63]
    v_mfma_f32_32x32x16_bf16 v[48:63], v[116:119], v[112:115], v[48:63]
    ds_read_b64_tr_b16 v[96:97], v2 offset:0
    ds_read_b64_tr_b16 v[98:99], v2 offset:1024
    s_waitcnt vmcnt(0) lgkmcnt(12)
    v_mfma_f32_32x32x16_bf16 v[16:31], v[100:103], v[252:255], v[16:31]
    ds_read_b64_tr_b16 v[100:101], v2 offset:2048
    ds_read_b64_tr_b16 v[102:103], v2 offset:3072
    v_mfma_f32_32x32x16_bf16 v[32:47], v[104:107], v[252:255], v[32:47]
    ds_read_b64_tr_b16 v[104:105], v2 offset:4096
    ds_read_b64_tr_b16 v[106:107], v2 offset:5120
    s_waitcnt lgkmcnt(12)
    v_mfma_f32_32x32x16_bf16 v[48:63], v[108:111], v[252:255], v[48:63]
    s_barrier
    ds_read_b64_tr_b16 v[108:109], v2 offset:6144
    ds_read_b64_tr_b16 v[110:111], v2 offset:7168
    v_mfma_f32_32x32x16_bf16 v[64:79], v[80:83], v[128:131], 0
    s_nop 0
    v_mul_f32 v120, v16, v24
    v_mul_f32 v121, v17, v25
    v_mul_f32 v122, v18, v26
    v_mul_f32 v123, v19, v27
    v_mul_f32 v124, v20, v28
    ds_read_b64_tr_b16 v[80:81], v9 offset:0
    ds_read_b64_tr_b16 v[82:83], v9 offset:1024
    s_waitcnt lgkmcnt(12)
    v_mfma_f32_32x32x16_bf16 v[64:79], v[84:87], v[132:135], v[64:79]
    v_mul_f32 v125, v21, v29
    v_mul_f32 v126, v22, v30
    v_mul_f32 v127, v23, v31
    v_mul_f32 v120, v120, v13
    v_mul_f32 v121, v121, v13
    ds_read_b64_tr_b16 v[84:85], v9 offset:2048
    ds_read_b64_tr_b16 v[86:87], v9 offset:3072
    v_mfma_f32_32x32x16_bf16 v[64:79], v[88:91], v[136:139], v[64:79]
    v_mul_f32 v122, v122, v13
    v_mul_f32 v123, v123, v13
    v_mul_f32 v124, v124, v13
    v_mul_f32 v125, v125, v13
    v_mul_f32 v126, v126, v13
    ds_read_b64_tr_b16 v[88:89], v9 offset:4096
    ds_read_b64_tr_b16 v[90:91], v9 offset:5120
    s_waitcnt lgkmcnt(12)
    v_mfma_f32_32x32x16_bf16 v[64:79], v[92:95], v[140:143], v[64:79]
    v_mul_f32 v127, v127, v13
    v_cvt_pk_bf16_f32 v120, v120, v121
    v_cvt_pk_bf16_f32 v121, v122, v123
    v_cvt_pk_bf16_f32 v122, v124, v125
    v_cvt_pk_bf16_f32 v123, v126, v127
    ds_read_b64_tr_b16 v[92:93], v9 offset:6144
    ds_read_b64_tr_b16 v[94:95], v9 offset:7168
    v_mfma_f32_32x32x16_bf16 v[16:31], v[96:99], v[128:131], 0
    buffer_store_dwordx4 v[120:123], v6, s[32:35], s48 offen offset:0 sc1
    s_nop 1
    v_mul_f32 v120, v32, v40
    v_mul_f32 v121, v33, v41
    v_mul_f32 v122, v34, v42
    v_mul_f32 v123, v35, v43
    v_mul_f32 v124, v36, v44
    ds_read_b64_tr_b16 v[96:97], v11 offset:0
    ds_read_b64_tr_b16 v[98:99], v11 offset:1024
    s_waitcnt lgkmcnt(12)
    v_mfma_f32_32x32x16_bf16 v[16:31], v[100:103], v[132:135], v[16:31]
    v_mul_f32 v125, v37, v45
    v_mul_f32 v126, v38, v46
    v_mul_f32 v127, v39, v47
    v_mul_f32 v120, v120, v13
    v_mul_f32 v121, v121, v13
    ds_read_b64_tr_b16 v[100:101], v11 offset:2048
    ds_read_b64_tr_b16 v[102:103], v11 offset:3072
    v_mfma_f32_32x32x16_bf16 v[16:31], v[104:107], v[136:139], v[16:31]
    v_mul_f32 v122, v122, v13
    v_mul_f32 v123, v123, v13
    v_mul_f32 v124, v124, v13
    v_mul_f32 v125, v125, v13
    v_mul_f32 v126, v126, v13
    ds_read_b64_tr_b16 v[104:105], v11 offset:4096
    ds_read_b64_tr_b16 v[106:107], v11 offset:5120
    s_waitcnt lgkmcnt(12)
    v_mfma_f32_32x32x16_bf16 v[16:31], v[108:111], v[140:143], v[16:31]
    v_mul_f32 v127, v127, v13
    v_cvt_pk_bf16_f32 v120, v120, v121
    v_cvt_pk_bf16_f32 v121, v122, v123
    v_cvt_pk_bf16_f32 v122, v124, v125
    v_cvt_pk_bf16_f32 v123, v126, v127
    ds_read_b64_tr_b16 v[108:109], v11 offset:6144
    ds_read_b64_tr_b16 v[110:111], v11 offset:7168
    v_mfma_f32_32x32x16_bf16 v[32:47], v[80:83], v[128:131], 0
    buffer_store_dwordx4 v[120:123], v6, s[32:35], s48 offen offset:1024 sc1
    s_nop 1
    v_mul_f32 v120, v48, v56
    v_mul_f32 v121, v49, v57
    v_mul_f32 v122, v50, v58
    v_mul_f32 v123, v51, v59
    v_mul_f32 v124, v52, v60
    v_subrev_u32 v2, 32768, v2
    v_subrev_u32 v9, 32768, v9
    v_subrev_u32 v11, 32768, v11
    v_subrev_u32 v10, 32768, v10
    ds_read_b64_tr_b16 v[80:81], v2 offset:0
    ds_read_b64_tr_b16 v[82:83], v2 offset:1024
    s_waitcnt lgkmcnt(12)
    v_mfma_f32_32x32x16_bf16 v[32:47], v[84:87], v[132:135], v[32:47]
    v_mul_f32 v125, v53, v61
    v_mul_f32 v126, v54, v62
    v_mul_f32 v127, v55, v63
    v_mul_f32 v120, v120, v13
    v_mul_f32 v121, v121, v13
    ds_read_b64_tr_b16 v[84:85], v9 offset:0
    ds_read_b64_tr_b16 v[86:87], v9 offset:1024
    v_mfma_f32_32x32x16_bf16 v[32:47], v[88:91], v[136:139], v[32:47]
    v_mul_f32 v122, v122, v13
    v_mul_f32 v123, v123, v13
    v_mul_f32 v124, v124, v13
    v_mul_f32 v125, v125, v13
    v_mul_f32 v126, v126, v13
    ds_read_b64_tr_b16 v[88:89], v11 offset:0
    ds_read_b64_tr_b16 v[90:91], v11 offset:1024
    s_waitcnt lgkmcnt(12)
    v_mfma_f32_32x32x16_bf16 v[32:47], v[92:95], v[140:143], v[32:47]
    v_mul_f32 v127, v127, v13
    v_cvt_pk_bf16_f32 v120, v120, v121
    v_cvt_pk_bf16_f32 v121, v122, v123
    v_cvt_pk_bf16_f32 v122, v124, v125
    v_cvt_pk_bf16_f32 v123, v126, v127
    ds_read_b64_tr_b16 v[92:93], v10 offset:0
    ds_read_b64_tr_b16 v[94:95], v10 offset:1024
    v_mfma_f32_32x32x16_bf16 v[48:63], v[96:99], v[128:131], 0
    buffer_store_dwordx4 v[120:123], v6, s[32:35], s48 offen offset:2048 sc1
    ds_read_b64_tr_b16 v[96:97], v2 offset:2048
    ds_read_b64_tr_b16 v[98:99], v2 offset:3072
    s_waitcnt lgkmcnt(12)
    v_mfma_f32_32x32x16_bf16 v[48:63], v[100:103], v[132:135], v[48:63]
    ds_read_b64_tr_b16 v[100:101], v9 offset:2048
    ds_read_b64_tr_b16 v[102:103], v9 offset:3072
    v_mfma_f32_32x32x16_bf16 v[48:63], v[104:107], v[136:139], v[48:63]
    ds_read_b64_tr_b16 v[104:105], v11 offset:2048
    ds_read_b64_tr_b16 v[106:107], v11 offset:3072
    s_waitcnt lgkmcnt(12)
    v_mfma_f32_32x32x16_bf16 v[48:63], v[108:111], v[140:143], v[48:63]
    s_barrier
    ds_read_b64_tr_b16 v[108:109], v10 offset:2048
    ds_read_b64_tr_b16 v[110:111], v10 offset:3072
    v_mfma_f32_32x32x16_bf16 v[16:31], v[80:83], v[144:147], v[16:31]
    ds_read_b64_tr_b16 v[80:81], v2 offset:4096
    ds_read_b64_tr_b16 v[82:83], v2 offset:5120
    s_waitcnt lgkmcnt(12)
    v_mfma_f32_32x32x16_bf16 v[32:47], v[84:87], v[144:147], v[32:47]
    ds_read_b64_tr_b16 v[84:85], v9 offset:4096
    ds_read_b64_tr_b16 v[86:87], v9 offset:5120
    v_mfma_f32_32x32x16_bf16 v[48:63], v[88:91], v[144:147], v[48:63]
    ds_read_b64_tr_b16 v[88:89], v11 offset:4096
    ds_read_b64_tr_b16 v[90:91], v11 offset:5120
    s_waitcnt lgkmcnt(12)
    v_mfma_f32_32x32x16_bf16 v[64:79], v[92:95], v[144:147], v[64:79]
    ds_read_b64_tr_b16 v[92:93], v10 offset:4096
    ds_read_b64_tr_b16 v[94:95], v10 offset:5120
    v_mfma_f32_32x32x16_bf16 v[16:31], v[96:99], v[148:151], v[16:31]
    v_mov_b32 v126, 0
    v_mov_b32 v127, 0
    ds_read_b64_tr_b16 v[96:97], v2 offset:6144
    ds_read_b64_tr_b16 v[98:99], v2 offset:7168
    s_waitcnt lgkmcnt(12)
    v_mfma_f32_32x32x16_bf16 v[32:47], v[100:103], v[148:151], v[32:47]
    ds_read_b64_tr_b16 v[100:101], v9 offset:6144
    ds_read_b64_tr_b16 v[102:103], v9 offset:7168
    v_mfma_f32_32x32x16_bf16 v[48:63], v[104:107], v[148:151], v[48:63]
    ds_read_b64_tr_b16 v[104:105], v11 offset:6144
    ds_read_b64_tr_b16 v[106:107], v11 offset:7168
    s_waitcnt lgkmcnt(12)
    v_mfma_f32_32x32x16_bf16 v[64:79], v[108:111], v[148:151], v[64:79]
    ds_read_b64_tr_b16 v[108:109], v10 offset:6144
    ds_read_b64_tr_b16 v[110:111], v10 offset:7168
    v_mfma_f32_32x32x16_bf16 v[16:31], v[80:83], v[152:155], v[16:31]
    v_add_u32 v2, 16384, v2
    v_add_u32 v9, 16384, v9
    v_add_u32 v11, 16384, v11
    v_add_u32 v10, 16384, v10
    ds_read_b64_tr_b16 v[80:81], v2 offset:0
    ds_read_b64_tr_b16 v[82:83], v2 offset:1024
    s_waitcnt lgkmcnt(12)
    v_mfma_f32_32x32x16_bf16 v[32:47], v[84:87], v[152:155], v[32:47]
    ds_read_b64 v[116:117], v8 offset:1536
    ds_read_b64_tr_b16 v[84:85], v9 offset:0
    ds_read_b64_tr_b16 v[86:87], v9 offset:1024
    v_mfma_f32_32x32x16_bf16 v[48:63], v[88:91], v[152:155], v[48:63]
    ds_read_b64_tr_b16 v[88:89], v11 offset:0
    ds_read_b64_tr_b16 v[90:91], v11 offset:1024
    s_waitcnt lgkmcnt(13)
    v_mfma_f32_32x32x16_bf16 v[64:79], v[92:95], v[152:155], v[64:79]
    ds_read_b64_tr_b16 v[92:93], v10 offset:0
    ds_read_b64_tr_b16 v[94:95], v10 offset:1024
    v_mfma_f32_32x32x16_bf16 v[16:31], v[96:99], v[156:159], v[16:31]
    ds_read_b64_tr_b16 v[96:97], v2 offset:2048
    ds_read_b64_tr_b16 v[98:99], v2 offset:3072
    s_waitcnt lgkmcnt(13)
    v_mfma_f32_32x32x16_bf16 v[32:47], v[100:103], v[156:159], v[32:47]
    ds_read_b64_tr_b16 v[100:101], v9 offset:2048
    ds_read_b64_tr_b16 v[102:103], v9 offset:3072
    v_mfma_f32_32x32x16_bf16 v[48:63], v[104:107], v[156:159], v[48:63]
    ds_read_b64_tr_b16 v[104:105], v11 offset:2048
    ds_read_b64_tr_b16 v[106:107], v11 offset:3072
    s_waitcnt lgkmcnt(13)
    v_mfma_f32_32x32x16_bf16 v[64:79], v[108:111], v[156:159], v[64:79]
    s_barrier
    ds_read_b64_tr_b16 v[108:109], v10 offset:2048
    ds_read_b64_tr_b16 v[110:111], v10 offset:3072
    v_mfma_f32_32x32x16_bf16 v[16:31], v[80:83], v[160:163], v[16:31]
    s_waitcnt vmcnt(0)
    s_add_u32 s98, s56, 16384
    s_mov_b64 exec, 1
    buffer_store_dword v5, v4, s[32:35], s98 offen sc1
    s_mov_b64 exec, -1
    s_waitcnt lgkmcnt(12)
    v_mfma_f32_32x32x16_bf16 v[16:31], v[116:119], v[112:115], v[16:31]
    ds_read_b64_tr_b16 v[80:81], v2 offset:4096
    ds_read_b64_tr_b16 v[82:83], v2 offset:5120
    v_mfma_f32_32x32x16_bf16 v[32:47], v[84:87], v[160:163], v[32:47]
    ds_read_b64_tr_b16 v[84:85], v9 offset:4096
    ds_read_b64_tr_b16 v[86:87], v9 offset:5120
    s_waitcnt lgkmcnt(12)
    v_mfma_f32_32x32x16_bf16 v[48:63], v[88:91], v[160:163], v[48:63]
    ds_read_b64 v[124:125], v8 offset:2048
    ds_read_b64_tr_b16 v[88:89], v11 offset:4096
    ds_read_b64_tr_b16 v[90:91], v11 offset:5120
    v_mfma_f32_32x32x16_bf16 v[64:79], v[92:95], v[160:163], v[64:79]
    ds_read_b64_tr_b16 v[92:93], v10 offset:4096
    ds_read_b64_tr_b16 v[94:95], v10 offset:5120
    s_waitcnt lgkmcnt(13)
    v_mfma_f32_32x32x16_bf16 v[16:31], v[96:99], v[164:167], v[16:31]
    ds_read_b64_tr_b16 v[96:97], v2 offset:6144
    ds_read_b64_tr_b16 v[98:99], v2 offset:7168
    v_mfma_f32_32x32x16_bf16 v[32:47], v[100:103], v[164:167], v[32:47]
    ds_read_b64_tr_b16 v[100:101], v9 offset:6144
    ds_read_b64_tr_b16 v[102:103], v9 offset:7168
    s_waitcnt lgkmcnt(13)
    v_mfma_f32_32x32x16_bf16 v[48:63], v[104:107], v[164:167], v[48:63]
    ds_read_b64_tr_b16 v[104:105], v11 offset:6144
    ds_read_b64_tr_b16 v[106:107], v11 offset:7168
    v_mfma_f32_32x32x16_bf16 v[64:79], v[108:111], v[164:167], v[64:79]
    ds_read_b64_tr_b16 v[108:109], v10 offset:6144
    ds_read_b64_tr_b16 v[110:111], v10 offset:7168
    s_waitcnt lgkmcnt(13)
    v_mfma_f32_32x32x16_bf16 v[16:31], v[80:83], v[168:171], v[16:31]
    v_subrev_u32 v2, 115712, v2
    v_subrev_u32 v9, 115712, v9
    v_subrev_u32 v11, 115712, v11
    v_subrev_u32 v10, 115712, v10
    ds_read_b64_tr_b16 v[80:81], v2 offset:0
    ds_read_b64_tr_b16 v[82:83], v2 offset:1024
    v_mfma_f32_32x32x16_bf16 v[32:47], v[84:87], v[168:171], v[32:47]
    s_waitcnt lgkmcnt(12)
    v_mfma_f32_32x32x16_bf16 v[32:47], v[124:127], v[112:115], v[32:47]
    ds_read_b64_tr_b16 v[84:85], v9 offset:0
    ds_read_b64_tr_b16 v[86:87], v9 offset:1024
    v_mfma_f32_32x32x16_bf16 v[48:63], v[88:91], v[168:171], v[48:63]
    ds_read_b64_tr_b16 v[88:89], v11 offset:0
    ds_read_b64_tr_b16 v[90:91], v11 offset:1024
    s_waitcnt lgkmcnt(12)
    v_mfma_f32_32x32x16_bf16 v[64:79], v[92:95], v[168:171], v[64:79]
    ds_read_b64 v[116:117], v8 offset:2560
    ds_read_b64_tr_b16 v[92:93], v10 offset:0
    ds_read_b64_tr_b16 v[94:95], v10 offset:1024
    v_mfma_f32_32x32x16_bf16 v[16:31], v[96:99], v[172:175], v[16:31]
    ds_read_b64_tr_b16 v[96:97], v2 offset:2048
    ds_read_b64_tr_b16 v[98:99], v2 offset:3072
    s_waitcnt lgkmcnt(13)
    v_mfma_f32_32x32x16_bf16 v[32:47], v[100:103], v[172:175], v[32:47]
    ds_read_b64_tr_b16 v[100:101], v9 offset:2048
    ds_read_b64_tr_b16 v[102:103], v9 offset:3072
    v_mfma_f32_32x32x16_bf16 v[48:63], v[104:107], v[172:175], v[48:63]
    ds_read_b64_tr_b16 v[104:105], v11 offset:2048
    ds_read_b64_tr_b16 v[106:107], v11 offset:3072
    s_waitcnt lgkmcnt(13)
    v_mfma_f32_32x32x16_bf16 v[64:79], v[108:111], v[172:175], v[64:79]
    s_barrier
    ds_read_b64_tr_b16 v[108:109], v10 offset:2048
    ds_read_b64_tr_b16 v[110:111], v10 offset:3072
    v_mfma_f32_32x32x16_bf16 v[16:31], v[80:83], v[176:179], v[16:31]
    ds_read_b64_tr_b16 v[80:81], v2 offset:4096
    ds_read_b64_tr_b16 v[82:83], v2 offset:5120
    s_waitcnt lgkmcnt(13)
    v_mfma_f32_32x32x16_bf16 v[32:47], v[84:87], v[176:179], v[32:47]
    ds_read_b64_tr_b16 v[84:85], v9 offset:4096
    ds_read_b64_tr_b16 v[86:87], v9 offset:5120
    v_mfma_f32_32x32x16_bf16 v[48:63], v[88:91], v[176:179], v[48:63]
    s_waitcnt lgkmcnt(12)
    v_mfma_f32_32x32x16_bf16 v[48:63], v[116:119], v[112:115], v[48:63]
    ds_read_b64_tr_b16 v[88:89], v11 offset:4096
    ds_read_b64_tr_b16 v[90:91], v11 offset:5120
    v_mfma_f32_32x32x16_bf16 v[64:79], v[92:95], v[176:179], v[64:79]
    ds_read_b64_tr_b16 v[92:93], v10 offset:4096
    ds_read_b64_tr_b16 v[94:95], v10 offset:5120
    s_waitcnt lgkmcnt(12)
    v_mfma_f32_32x32x16_bf16 v[16:31], v[96:99], v[180:183], v[16:31]
    ds_read_b64 v[124:125], v8 offset:3072
    ds_read_b64_tr_b16 v[96:97], v2 offset:6144
    ds_read_b64_tr_b16 v[98:99], v2 offset:7168
    v_mfma_f32_32x32x16_bf16 v[32:47], v[100:103], v[180:183], v[32:47]
    ds_read_b64_tr_b16 v[100:101], v9 offset:6144
    ds_read_b64_tr_b16 v[102:103], v9 offset:7168
    s_waitcnt lgkmcnt(13)
    v_mfma_f32_32x32x16_bf16 v[48:63], v[104:107], v[180:183], v[48:63]
    ds_read_b64_tr_b16 v[104:105], v11 offset:6144
    ds_read_b64_tr_b16 v[106:107], v11 offset:7168
    v_mfma_f32_32x32x16_bf16 v[64:79], v[108:111], v[180:183], v[64:79]
    ds_read_b64_tr_b16 v[108:109], v10 offset:6144
    ds_read_b64_tr_b16 v[110:111], v10 offset:7168
    s_waitcnt lgkmcnt(13)
    v_mfma_f32_32x32x16_bf16 v[16:31], v[80:83], v[184:187], v[16:31]
    v_add_u32 v2, 16384, v2
    v_add_u32 v9, 16384, v9
    v_add_u32 v11, 16384, v11
    v_add_u32 v10, 16384, v10
    ds_read_b64_tr_b16 v[80:81], v2 offset:0
    ds_read_b64_tr_b16 v[82:83], v2 offset:1024
    v_mfma_f32_32x32x16_bf16 v[32:47], v[84:87], v[184:187], v[32:47]
    ds_read_b64_tr_b16 v[84:85], v9 offset:0
    ds_read_b64_tr_b16 v[86:87], v9 offset:1024
    s_waitcnt lgkmcnt(13)
    v_mfma_f32_32x32x16_bf16 v[48:63], v[88:91], v[184:187], v[48:63]
    ds_read_b64_tr_b16 v[88:89], v11 offset:0
    ds_read_b64_tr_b16 v[90:91], v11 offset:1024
    v_mfma_f32_32x32x16_bf16 v[64:79], v[92:95], v[184:187], v[64:79]
    s_waitcnt lgkmcnt(12)
    v_mfma_f32_32x32x16_bf16 v[64:79], v[124:127], v[112:115], v[64:79]
    ds_read_b64_tr_b16 v[92:93], v10 offset:0
    ds_read_b64_tr_b16 v[94:95], v10 offset:1024
    v_mfma_f32_32x32x16_bf16 v[16:31], v[96:99], v[188:191], v[16:31]
    ds_read_b64_tr_b16 v[96:97], v2 offset:2048
    ds_read_b64_tr_b16 v[98:99], v2 offset:3072
    s_waitcnt lgkmcnt(12)
    v_mfma_f32_32x32x16_bf16 v[32:47], v[100:103], v[188:191], v[32:47]
    ds_read_b64_tr_b16 v[100:101], v9 offset:2048
    ds_read_b64_tr_b16 v[102:103], v9 offset:3072
    v_mfma_f32_32x32x16_bf16 v[48:63], v[104:107], v[188:191], v[48:63]
    ds_read_b64_tr_b16 v[104:105], v11 offset:2048
    ds_read_b64_tr_b16 v[106:107], v11 offset:3072
    s_waitcnt lgkmcnt(12)
    v_mfma_f32_32x32x16_bf16 v[64:79], v[108:111], v[188:191], v[64:79]
    s_barrier
    ds_read_b64_tr_b16 v[108:109], v10 offset:2048
    ds_read_b64_tr_b16 v[110:111], v10 offset:3072
    v_mfma_f32_32x32x16_bf16 v[16:31], v[80:83], v[192:195], v[16:31]
    buffer_load_dword v1, v7, s[32:35], s62 offen sc1
    ds_read_b64_tr_b16 v[80:81], v2 offset:4096
    ds_read_b64_tr_b16 v[82:83], v2 offset:5120
    s_waitcnt lgkmcnt(12)
    v_mfma_f32_32x32x16_bf16 v[32:47], v[84:87], v[192:195], v[32:47]
    ds_read_b64_tr_b16 v[84:85], v9 offset:4096
    ds_read_b64_tr_b16 v[86:87], v9 offset:5120
    v_mfma_f32_32x32x16_bf16 v[48:63], v[88:91], v[192:195], v[48:63]
    ds_read_b64_tr_b16 v[88:89], v11 offset:4096
    ds_read_b64_tr_b16 v[90:91], v11 offset:5120
    s_waitcnt lgkmcnt(12)
    v_mfma_f32_32x32x16_bf16 v[64:79], v[92:95], v[192:195], v[64:79]
    ds_read_b64_tr_b16 v[92:93], v10 offset:4096
    ds_read_b64_tr_b16 v[94:95], v10 offset:5120
    v_mfma_f32_32x32x16_bf16 v[16:31], v[96:99], v[196:199], v[16:31]
    ds_read_b64_tr_b16 v[96:97], v2 offset:6144
    ds_read_b64_tr_b16 v[98:99], v2 offset:7168
    s_waitcnt lgkmcnt(12)
    v_mfma_f32_32x32x16_bf16 v[32:47], v[100:103], v[196:199], v[32:47]
    ds_read_b64_tr_b16 v[100:101], v9 offset:6144
    ds_read_b64_tr_b16 v[102:103], v9 offset:7168
    v_mfma_f32_32x32x16_bf16 v[48:63], v[104:107], v[196:199], v[48:63]
    ds_read_b64_tr_b16 v[104:105], v11 offset:6144
    ds_read_b64_tr_b16 v[106:107], v11 offset:7168
    s_waitcnt lgkmcnt(12)
    v_mfma_f32_32x32x16_bf16 v[64:79], v[108:111], v[196:199], v[64:79]
    ds_read_b64_tr_b16 v[108:109], v10 offset:6144
    ds_read_b64_tr_b16 v[110:111], v10 offset:7168
    v_mfma_f32_32x32x16_bf16 v[16:31], v[80:83], v[200:203], v[16:31]
    v_add_u32 v2, 16384, v2
    v_add_u32 v9, 16384, v9
    v_add_u32 v11, 16384, v11
    v_add_u32 v10, 16384, v10
    ds_read_b64_tr_b16 v[80:81], v2 offset:0
    ds_read_b64_tr_b16 v[82:83], v2 offset:1024
    s_waitcnt lgkmcnt(12)
    v_mfma_f32_32x32x16_bf16 v[32:47], v[84:87], v[200:203], v[32:47]
    ds_read_b64_tr_b16 v[84:85], v9 offset:0
    ds_read_b64_tr_b16 v[86:87], v9 offset:1024
    v_mfma_f32_32x32x16_bf16 v[48:63], v[88:91], v[200:203], v[48:63]
    ds_read_b64_tr_b16 v[88:89], v11 offset:0
    ds_read_b64_tr_b16 v[90:91], v11 offset:1024
    s_waitcnt lgkmcnt(12)
    v_mfma_f32_32x32x16_bf16 v[64:79], v[92:95], v[200:203], v[64:79]
    ds_read_b64_tr_b16 v[92:93], v10 offset:0
    ds_read_b64_tr_b16 v[94:95], v10 offset:1024
    v_mfma_f32_32x32x16_bf16 v[16:31], v[96:99], v[204:207], v[16:31]
    ds_read_b64_tr_b16 v[96:97], v2 offset:2048
    ds_read_b64_tr_b16 v[98:99], v2 offset:3072
    s_waitcnt lgkmcnt(12)
    v_mfma_f32_32x32x16_bf16 v[32:47], v[100:103], v[204:207], v[32:47]
    ds_read_b64_tr_b16 v[100:101], v9 offset:2048
    ds_read_b64_tr_b16 v[102:103], v9 offset:3072
    v_mfma_f32_32x32x16_bf16 v[48:63], v[104:107], v[204:207], v[48:63]
    ds_read_b64_tr_b16 v[104:105], v11 offset:2048
    ds_read_b64_tr_b16 v[106:107], v11 offset:3072
    s_waitcnt lgkmcnt(12)
    v_mfma_f32_32x32x16_bf16 v[64:79], v[108:111], v[204:207], v[64:79]
    s_barrier
    ds_read_b64_tr_b16 v[108:109], v10 offset:2048
    ds_read_b64_tr_b16 v[110:111], v10 offset:3072
    v_mfma_f32_32x32x16_bf16 v[16:31], v[80:83], v[208:211], v[16:31]
    ds_read_b64_tr_b16 v[80:81], v2 offset:4096
    ds_read_b64_tr_b16 v[82:83], v2 offset:5120
    s_waitcnt lgkmcnt(12)
    v_mfma_f32_32x32x16_bf16 v[32:47], v[84:87], v[208:211], v[32:47]
    ds_read_b64_tr_b16 v[84:85], v9 offset:4096
    ds_read_b64_tr_b16 v[86:87], v9 offset:5120
    v_mfma_f32_32x32x16_bf16 v[48:63], v[88:91], v[208:211], v[48:63]
    ds_read_b64_tr_b16 v[88:89], v11 offset:4096
    ds_read_b64_tr_b16 v[90:91], v11 offset:5120
    s_waitcnt lgkmcnt(12)
    v_mfma_f32_32x32x16_bf16 v[64:79], v[92:95], v[208:211], v[64:79]
    ds_read_b64_tr_b16 v[92:93], v10 offset:4096
    ds_read_b64_tr_b16 v[94:95], v10 offset:5120
    v_mfma_f32_32x32x16_bf16 v[16:31], v[96:99], v[212:215], v[16:31]
    s_waitcnt vmcnt(0)
    v_cmp_ne_u32 vcc, s96, v1
    s_nop 1
    s_cbranch_vccnz C_rare_39
C_back_40:
    ds_read_b64_tr_b16 v[96:97], v2 offset:6144
    ds_read_b64_tr_b16 v[98:99], v2 offset:7168
    s_waitcnt lgkmcnt(12)
    v_mfma_f32_32x32x16_bf16 v[32:47], v[100:103], v[212:215], v[32:47]
    s_add_u32 s1, s16, 0
    buffer_load_dwordx4 v[128:131], v6, s[32:35], s1 offen sc1
    ds_read_b64_tr_b16 v[100:101], v9 offset:6144
    ds_read_b64_tr_b16 v[102:103], v9 offset:7168
    v_mfma_f32_32x32x16_bf16 v[48:63], v[104:107], v[212:215], v[48:63]
    buffer_load_dwordx4 v[132:135], v6, s[32:35], s1 offen offset:1024 sc1
    ds_read_b64_tr_b16 v[104:105], v11 offset:6144
    ds_read_b64_tr_b16 v[106:107], v11 offset:7168
    s_waitcnt lgkmcnt(12)
    v_mfma_f32_32x32x16_bf16 v[64:79], v[108:111], v[212:215], v[64:79]
    buffer_load_dwordx4 v[136:139], v6, s[32:35], s1 offen offset:2048 sc1
    ds_read_b64_tr_b16 v[108:109], v10 offset:6144
    ds_read_b64_tr_b16 v[110:111], v10 offset:7168
    v_mfma_f32_32x32x16_bf16 v[16:31], v[80:83], v[216:219], v[16:31]
    buffer_load_dwordx4 v[140:143], v6, s[32:35], s1 offen offset:3072 sc1
    v_add_u32 v2, 16384, v2
    v_add_u32 v9, 16384, v9
    v_add_u32 v11, 16384, v11
    v_add_u32 v10, 16384, v10
    ds_read_b64_tr_b16 v[80:81], v2 offset:0
    ds_read_b64_tr_b16 v[82:83], v2 offset:1024
    s_waitcnt lgkmcnt(12)
    v_mfma_f32_32x32x16_bf16 v[32:47], v[84:87], v[216:219], v[32:47]
    s_add_u32 s1, s16, 4096
    buffer_load_dwordx4 v[144:147], v6, s[32:35], s1 offen sc1
    ds_read_b64_tr_b16 v[84:85], v9 offset:0
    ds_read_b64_tr_b16 v[86:87], v9 offset:1024
    v_mfma_f32_32x32x16_bf16 v[48:63], v[88:91], v[216:219], v[48:63]
    buffer_load_dwordx4 v[148:151], v6, s[32:35], s1 offen offset:1024 sc1
    ds_read_b64_tr_b16 v[88:89], v11 offset:0
    ds_read_b64_tr_b16 v[90:91], v11 offset:1024
    s_waitcnt lgkmcnt(12)
    v_mfma_f32_32x32x16_bf16 v[64:79], v[92:95], v[216:219], v[64:79]
    buffer_load_dwordx4 v[152:155], v6, s[32:35], s1 offen offset:2048 sc1
    ds_read_b64_tr_b16 v[92:93], v10 offset:0
    ds_read_b64_tr_b16 v[94:95], v10 offset:1024
    v_mfma_f32_32x32x16_bf16 v[16:31], v[96:99], v[220:223], v[16:31]
    buffer_load_dwordx4 v[156:159], v6, s[32:35], s1 offen offset:3072 sc1
    ds_read_b64_tr_b16 v[96:97], v2 offset:2048
    ds_read_b64_tr_b16 v[98:99], v2 offset:3072
    s_waitcnt lgkmcnt(12)
    v_mfma_f32_32x32x16_bf16 v[32:47], v[100:103], v[220:223], v[32:47]
    s_add_u32 s1, s17, 0
    buffer_load_dwordx4 v[160:163], v6, s[32:35], s1 offen sc1
    ds_read_b64_tr_b16 v[100:101], v9 offset:2048
    ds_read_b64_tr_b16 v[102:103], v9 offset:3072
    v_mfma_f32_32x32x16_bf16 v[48:63], v[104:107], v[220:223], v[48:63]
    buffer_load_dwordx4 v[164:167], v6, s[32:35], s1 offen offset:1024 sc1
    ds_read_b64_tr_b16 v[104:105], v11 offset:2048
    ds_read_b64_tr_b16 v[106:107], v11 offset:3072
    s_waitcnt lgkmcnt(12)
    v_mfma_f32_32x32x16_bf16 v[64:79], v[108:111], v[220:223], v[64:79]
    buffer_load_dwordx4 v[168:171], v6, s[32:35], s1 offen offset:2048 sc1
    s_barrier
    ds_read_b64_tr_b16 v[108:109], v10 offset:2048
    ds_read_b64_tr_b16 v[110:111], v10 offset:3072
    v_mfma_f32_32x32x16_bf16 v[16:31], v[80:83], v[224:227], v[16:31]
    v_and_b32 v3, 60, v3
    buffer_load_dwordx4 v[172:175], v6, s[32:35], s1 offen offset:3072 sc1
    ds_read_b64_tr_b16 v[80:81], v2 offset:4096
    ds_read_b64_tr_b16 v[82:83], v2 offset:5120
    s_waitcnt lgkmcnt(12)
    v_mfma_f32_32x32x16_bf16 v[32:47], v[84:87], v[224:227], v[32:47]
    buffer_load_dword v1, v3, s[32:35], s25 offen sc1
    s_add_u32 s1, s17, 4096
    buffer_load_dwordx4 v[176:179], v6, s[32:35], s1 offen sc1
    ds_read_b64_tr_b16 v[84:85], v9 offset:4096
    ds_read_b64_tr_b16 v[86:87], v9 offset:5120
    v_mfma_f32_32x32x16_bf16 v[48:63], v[88:91], v[224:227], v[48:63]
    buffer_load_dwordx4 v[180:183], v6, s[32:35], s1 offen offset:1024 sc1
    ds_read_b64_tr_b16 v[88:89], v11 offset:4096
    ds_read_b64_tr_b16 v[90:91], v11 offset:5120
    s_waitcnt lgkmcnt(12)
    v_mfma_f32_32x32x16_bf16 v[64:79], v[92:95], v[224:227], v[64:79]
    buffer_load_dwordx4 v[184:187], v6, s[32:35], s1 offen offset:2048 sc1
    ds_read_b64_tr_b16 v[92:93], v10 offset:4096
    ds_read_b64_tr_b16 v[94:95], v10 offset:5120
    v_mfma_f32_32x32x16_bf16 v[16:31], v[96:99], v[228:231], v[16:31]
    buffer_load_dwordx4 v[188:191], v6, s[32:35], s1 offen offset:3072 sc1
    ds_read_b64_tr_b16 v[96:97], v2 offset:6144
    ds_read_b64_tr_b16 v[98:99], v2 offset:7168
    s_waitcnt lgkmcnt(12)
    v_mfma_f32_32x32x16_bf16 v[32:47], v[100:103], v[228:231], v[32:47]
    s_add_u32 s1, s18, 0
    buffer_load_dwordx4 v[192:195], v6, s[32:35], s1 offen sc1
    ds_read_b64_tr_b16 v[100:101], v9 offset:6144
    ds_read_b64_tr_b16 v[102:103], v9 offset:7168
    v_mfma_f32_32x32x16_bf16 v[48:63], v[104:107], v[228:231], v[48:63]
    buffer_load_dwordx4 v[196:199], v6, s[32:35], s1 offen offset:1024 sc1
    ds_read_b64_tr_b16 v[104:105], v11 offset:6144
    ds_read_b64_tr_b16 v[106:107], v11 offset:7168
    s_waitcnt lgkmcnt(12)
    v_mfma_f32_32x32x16_bf16 v[64:79], v[108:111], v[228:231], v[64:79]
    buffer_load_dwordx4 v[200:203], v6, s[32:35], s1 offen offset:2048 sc1
    ds_read_b64_tr_b16 v[108:109], v10 offset:6144
    ds_read_b64_tr_b16 v[110:111], v10 offset:7168
    v_mfma_f32_32x32x16_bf16 v[16:31], v[80:83], v[232:235], v[16:31]
    buffer_load_dwordx4 v[204:207], v6, s[32:35], s1 offen offset:3072 sc1
    v_add_u32 v2, 16384, v2
    v_add_u32 v9, 16384, v9
    v_add_u32 v11, 16384, v11
    v_add_u32 v10, 16384, v10
    ds_read_b64_tr_b16 v[80:81], v2 offset:0
    ds_read_b64_tr_b16 v[82:83], v2 offset:1024
    s_waitcnt lgkmcnt(12)
    v_mfma_f32_32x32x16_bf16 v[32:47], v[84:87], v[232:235], v[32:47]
    s_add_u32 s1, s18, 4096
    buffer_load_dwordx4 v[208:211], v6, s[32:35], s1 offen sc1
    ds_read_b64_tr_b16 v[84:85], v9 offset:0
    ds_read_b64_tr_b16 v[86:87], v9 offset:1024
    v_mfma_f32_32x32x16_bf16 v[48:63], v[88:91], v[232:235], v[48:63]
    buffer_load_dwordx4 v[212:215], v6, s[32:35], s1 offen offset:1024 sc1
    ds_read_b64_tr_b16 v[88:89], v11 offset:0
    ds_read_b64_tr_b16 v[90:91], v11 offset:1024
    s_waitcnt lgkmcnt(12)
    v_mfma_f32_32x32x16_bf16 v[64:79], v[92:95], v[232:235], v[64:79]
    buffer_load_dwordx4 v[216:219], v6, s[32:35], s1 offen offset:2048 sc1
    ds_read_b64_tr_b16 v[92:93], v10 offset:0
    ds_read_b64_tr_b16 v[94:95], v10 offset:1024
    v_mfma_f32_32x32x16_bf16 v[16:31], v[96:99], v[236:239], v[16:31]
    buffer_load_dwordx4 v[220:223], v6, s[32:35], s1 offen offset:3072 sc1
    ds_read_b64_tr_b16 v[96:97], v2 offset:2048
    ds_read_b64_tr_b16 v[98:99], v2 offset:3072
    s_waitcnt lgkmcnt(12)
    v_mfma_f32_32x32x16_bf16 v[32:47], v[100:103], v[236:239], v[32:47]
    ds_read_b64_tr_b16 v[100:101], v9 offset:2048
    ds_read_b64_tr_b16 v[102:103], v9 offset:3072
    v_mfma_f32_32x32x16_bf16 v[48:63], v[104:107], v[236:239], v[48:63]
    ds_read_b64_tr_b16 v[104:105], v11 offset:2048
    ds_read_b64_tr_b16 v[106:107], v11 offset:3072
    s_waitcnt lgkmcnt(12)
    v_mfma_f32_32x32x16_bf16 v[64:79], v[108:111], v[236:239], v[64:79]
    s_barrier
    ds_read_b64_tr_b16 v[108:109], v10 offset:2048
    ds_read_b64_tr_b16 v[110:111], v10 offset:3072
    v_mfma_f32_32x32x16_bf16 v[16:31], v[80:83], v[240:243], v[16:31]
    ds_read_b64_tr_b16 v[80:81], v2 offset:4096
    ds_read_b64_tr_b16 v[82:83], v2 offset:5120
    s_waitcnt lgkmcnt(12)
    v_mfma_f32_32x32x16_bf16 v[32:47], v[84:87], v[240:243], v[32:47]
    ds_read_b64_tr_b16 v[84:85], v9 offset:4096
    ds_read_b64_tr_b16 v[86:87], v9 offset:5120
    v_mfma_f32_32x32x16_bf16 v[48:63], v[88:91], v[240:243], v[48:63]
    ds_read_b64_tr_b16 v[88:89], v11 offset:4096
    ds_read_b64_tr_b16 v[90:91], v11 offset:5120
    s_waitcnt lgkmcnt(12)
    v_mfma_f32_32x32x16_bf16 v[64:79], v[92:95], v[240:243], v[64:79]
    ds_read_b64_tr_b16 v[92:93], v10 offset:4096
    ds_read_b64_tr_b16 v[94:95], v10 offset:5120
    v_mfma_f32_32x32x16_bf16 v[16:31], v[96:99], v[244:247], v[16:31]
    s_waitcnt vmcnt(12)
    v_cmp_ne_u32 vcc, s96, v1
    s_nop 1
    s_cbranch_vccnz C_rare_42
C_back_43:
    ds_read_b64_tr_b16 v[96:97], v2 offset:6144
    ds_read_b64_tr_b16 v[98:99], v2 offset:7168
    s_waitcnt lgkmcnt(12)
    v_mfma_f32_32x32x16_bf16 v[32:47], v[100:103], v[244:247], v[32:47]
    ds_read_b64_tr_b16 v[100:101], v9 offset:6144
    ds_read_b64_tr_b16 v[102:103], v9 offset:7168
    v_mfma_f32_32x32x16_bf16 v[48:63], v[104:107], v[244:247], v[48:63]
    ds_read_b64_tr_b16 v[104:105], v11 offset:6144
    ds_read_b64_tr_b16 v[106:107], v11 offset:7168
    s_waitcnt lgkmcnt(12)
    v_mfma_f32_32x32x16_bf16 v[64:79], v[108:111], v[244:247], v[64:79]
    ds_read_b64_tr_b16 v[108:109], v10 offset:6144
    ds_read_b64_tr_b16 v[110:111], v10 offset:7168
    v_mfma_f32_32x32x16_bf16 v[16:31], v[80:83], v[248:251], v[16:31]
    s_mul_i32 s98, s57, 50176
    s_add_u32 s98, s98, 81920
    v_add_u32 v9, s98, v14
    v_add_u32 v10, s98, v15
    ds_read_b64_tr_b16 v[80:81], v9 offset:0
    ds_read_b64_tr_b16 v[82:83], v9 offset:1024
    s_waitcnt lgkmcnt(12)
    v_mfma_f32_32x32x16_bf16 v[32:47], v[84:87], v[248:251], v[32:47]
    ds_read_b64_tr_b16 v[84:85], v10 offset:0
    ds_read_b64_tr_b16 v[86:87], v10 offset:1024
    v_mfma_f32_32x32x16_bf16 v[48:63], v[88:91], v[248:251], v[48:63]
    ds_read_b64_tr_b16 v[88:89], v9 offset:2048
    ds_read_b64_tr_b16 v[90:91], v9 offset:3072
    s_waitcnt lgkmcnt(12)
    v_mfma_f32_32x32x16_bf16 v[64:79], v[92:95], v[248:251], v[64:79]
    ds_read_b64_tr_b16 v[92:93], v10 offset:2048
    ds_read_b64_tr_b16 v[94:95], v10 offset:3072
    v_mfma_f32_32x32x16_bf16 v[16:31], v[96:99], v[252:255], v[16:31]
    ds_read_b64_tr_b16 v[96:97], v9 offset:4096
    ds_read_b64_tr_b16 v[98:99], v9 offset:5120
    s_waitcnt lgkmcnt(12)
    v_mfma_f32_32x32x16_bf16 v[32:47], v[100:103], v[252:255], v[32:47]
    ds_read_b64_tr_b16 v[100:101], v10 offset:4096
    ds_read_b64_tr_b16 v[102:103], v10 offset:5120
    v_mfma_f32_32x32x16_bf16 v[48:63], v[104:107], v[252:255], v[48:63]
    ds_read_b64_tr_b16 v[104:105], v9 offset:6144
    ds_read_b64_tr_b16 v[106:107], v9 offset:7168
    s_waitcnt lgkmcnt(12)
    v_mfma_f32_32x32x16_bf16 v[64:79], v[108:111], v[252:255], v[64:79]
    s_barrier
    ds_read_b64_tr_b16 v[108:109], v10 offset:6144
    ds_read_b64_tr_b16 v[110:111], v10 offset:7168
    v_mfma_f32_32x32x16_bf16 v[224:239], v[80:83], v[128:131], 0
    v_mul_f32 v120, v16, v24
    v_mul_f32 v121, v17, v25
    v_mul_f32 v122, v18, v26
    v_mul_f32 v123, v19, v27
    v_mul_f32 v124, v20, v28
    ds_read_b64_tr_b16 v[80:81], v9 offset:8192
    ds_read_b64_tr_b16 v[82:83], v9 offset:9216
    s_waitcnt lgkmcnt(12)
    v_mfma_f32_32x32x16_bf16 v[240:255], v[84:87], v[128:131], 0
    v_mul_f32 v125, v21, v29
    v_mul_f32 v126, v22, v30
    v_mul_f32 v127, v23, v31
    v_mul_f32 v120, v120, v13
    v_mul_f32 v121, v121, v13
    ds_read_b64_tr_b16 v[84:85], v10 offset:8192
    ds_read_b64_tr_b16 v[86:87], v10 offset:9216
    v_mfma_f32_32x32x16_bf16 v[224:239], v[88:91], v[132:135], v[224:239]
    v_mul_f32 v122, v122, v13
    v_mul_f32 v123, v123, v13
    v_mul_f32 v124, v124, v13
    v_mul_f32 v125, v125, v13
    v_mul_f32 v126, v126, v13
    ds_read_b64_tr_b16 v[88:89], v9 offset:10240
    ds_read_b64_tr_b16 v[90:91], v9 offset:11264
    s_waitcnt lgkmcnt(12)
    v_mfma_f32_32x32x16_bf16 v[240:255], v[92:95], v[132:135], v[240:255]
    v_mul_f32 v127, v127, v13
    v_cvt_pk_bf16_f32 v120, v120, v121
    v_cvt_pk_bf16_f32 v121, v122, v123
    v_cvt_pk_bf16_f32 v122, v124, v125
    v_cvt_pk_bf16_f32 v123, v126, v127
    ds_read_b64_tr_b16 v[92:93], v10 offset:10240
    ds_read_b64_tr_b16 v[94:95], v10 offset:11264
    v_mfma_f32_32x32x16_bf16 v[224:239], v[96:99], v[136:139], v[224:239]
    s_cmp_eq_u32 s97, 0
    s_cbranch_scc1 C_sl_45
    buffer_store_dwordx4 v[120:123], v6, s[32:35], s49 offen offset:0
C_dn_46:
    ds_read_b64_tr_b16 v[96:97], v9 offset:12288
    ds_read_b64_tr_b16 v[98:99], v9 offset:13312
    s_waitcnt lgkmcnt(12)
    v_mfma_f32_32x32x16_bf16 v[240:255], v[100:103], v[136:139], v[240:255]
    v_mul_f32 v120, v32, v40
    v_mul_f32 v121, v33, v41
    v_mul_f32 v122, v34, v42
    v_mul_f32 v123, v35, v43
    v_mul_f32 v124, v36, v44
    ds_read_b64_tr_b16 v[100:101], v10 offset:12288
    ds_read_b64_tr_b16 v[102:103], v10 offset:13312
    v_mfma_f32_32x32x16_bf16 v[224:239], v[104:107], v[140:143], v[224:239]
    v_mul_f32 v125, v37, v45
    v_mul_f32 v126, v38, v46
    v_mul_f32 v127, v39, v47
    v_mul_f32 v120, v120, v13
    v_mul_f32 v121, v121, v13
    ds_read_b64_tr_b16 v[104:105], v9 offset:14336
    ds_read_b64_tr_b16 v[106:107], v9 offset:15360
    s_waitcnt lgkmcnt(12)
    v_mfma_f32_32x32x16_bf16 v[240:255], v[108:111], v[140:143], v[240:255]
    v_mul_f32 v122, v122, v13
    v_mul_f32 v123, v123, v13
    v_mul_f32 v124, v124, v13
    v_mul_f32 v125, v125, v13
    v_mul_f32 v126, v126, v13
    ds_read_b64_tr_b16 v[108:109], v10 offset:14336
    ds_read_b64_tr_b16 v[110:111], v10 offset:15360
    v_mfma_f32_32x32x16_bf16 v[224:239], v[80:83], v[144:147], v[224:239]
    v_mul_f32 v127, v127, v13
    v_cvt_pk_bf16_f32 v120, v120, v121
    v_cvt_pk_bf16_f32 v121, v122, v123
    v_cvt_pk_bf16_f32 v122, v124, v125
    v_cvt_pk_bf16_f32 v123, v126, v127
    s_mul_i32 s98, s57, 16384
    s_add_u32 s98, s98, 99328
    v_add_u32 v12, s98, v14
    v_add_u32 v2, s98, v15
    ds_read_b64_tr_b16 v[80:81], v12 offset:0
    ds_read_b64_tr_b16 v[82:83], v12 offset:1024
    s_waitcnt lgkmcnt(12)
    v_mfma_f32_32x32x16_bf16 v[240:255], v[84:87], v[144:147], v[240:255]
    s_cmp_eq_u32 s97, 0
    s_cbranch_scc1 C_sl_47
    buffer_store_dwordx4 v[120:123], v6, s[32:35], s49 offen offset:1024
C_dn_48:
    ds_read_b64_tr_b16 v[84:85], v2 offset:0
    ds_read_b64_tr_b16 v[86:87], v2 offset:1024
    v_mfma_f32_32x32x16_bf16 v[224:239], v[88:91], v[148:151], v[224:239]
    v_mul_f32 v120, v48, v56
    v_mul_f32 v121, v49, v57
    v_mul_f32 v122, v50, v58
    v_mul_f32 v123, v51, v59
    v_mul_f32 v124, v52, v60
    ds_read_b64_tr_b16 v[88:89], v12 offset:2048
    ds_read_b64_tr_b16 v[90:91], v12 offset:3072
    s_waitcnt lgkmcnt(12)
    v_mfma_f32_32x32x16_bf16 v[240:255], v[92:95], v[148:151], v[240:255]
    v_mul_f32 v125, v53, v61
    v_mul_f32 v126, v54, v62
    v_mul_f32 v127, v55, v63
    v_mul_f32 v120, v120, v13
    v_mul_f32 v121, v121, v13
    ds_read_b64_tr_b16 v[92:93], v2 offset:2048
    ds_read_b64_tr_b16 v[94:95], v2 offset:3072
    v_mfma_f32_32x32x16_bf16 v[224:239], v[96:99], v[152:155], v[224:239]
    v_mul_f32 v122, v122, v13
    v_mul_f32 v123, v123, v13
    v_mul_f32 v124, v124, v13
    v_mul_f32 v125, v125, v13
    v_mul_f32 v126, v126, v13
    ds_read_b64_tr_b16 v[96:97], v12 offset:4096
    ds_read_b64_tr_b16 v[98:99], v12 offset:5120
    s_waitcnt lgkmcnt(12)
    v_mfma_f32_32x32x16_bf16 v[240:255], v[100:103], v[152:155], v[240:255]
    v_mul_f32 v127, v127, v13
    v_cvt_pk_bf16_f32 v120, v120, v121
    v_cvt_pk_bf16_f32 v121, v122, v123
    v_cvt_pk_bf16_f32 v122, v124, v125
    v_cvt_pk_bf16_f32 v123, v126, v127
    ds_read_b64_tr_b16 v[100:101], v2 offset:4096
    ds_read_b64_tr_b16 v[102:103], v2 offset:5120
    v_mfma_f32_32x32x16_bf16 v[224:239], v[104:107], v[156:159], v[224:239]
    s_cmp_eq_u32 s97, 0
    s_cbranch_scc1 C_sl_49
    buffer_store_dwordx4 v[120:123], v6, s[32:35], s49 offen offset:2048
C_dn_50:
    ds_read_b64_tr_b16 v[104:105], v12 offset:6144
    ds_read_b64_tr_b16 v[106:107], v12 offset:7168
    s_waitcnt lgkmcnt(12)
    v_mfma_f32_32x32x16_bf16 v[240:255], v[108:111], v[156:159], v[240:255]
    v_mul_f32 v120, v64, v72
    v_mul_f32 v121, v65, v73
    v_mul_f32 v122, v66, v74
    v_mul_f32 v123, v67, v75
    v_mul_f32 v124, v68, v76
    s_barrier
    ds_read_b64_tr_b16 v[108:109], v2 offset:6144
    ds_read_b64_tr_b16 v[110:111], v2 offset:7168
    v_mfma_f32_32x32x16_bf16 v[224:239], v[80:83], v[160:163], v[224:239]
    v_mul_f32 v125, v69, v77
    v_mul_f32 v126, v70, v78
    v_mul_f32 v127, v71, v79
    v_mul_f32 v120, v120, v13
    v_mul_f32 v121, v121, v13
    ds_read_b64_tr_b16 v[80:81], v12 offset:8192
    ds_read_b64_tr_b16 v[82:83], v12 offset:9216
    s_waitcnt lgkmcnt(12)
    v_mfma_f32_32x32x16_bf16 v[240:255], v[84:87], v[160:163], v[240:255]
    v_mul_f32 v122, v122, v13
    v_mul_f32 v123, v123, v13
    v_mul_f32 v124, v124, v13
    v_mul_f32 v125, v125, v13
    v_mul_f32 v126, v126, v13
    ds_read_b64_tr_b16 v[84:85], v2 offset:8192
    ds_read_b64_tr_b16 v[86:87], v2 offset:9216
    v_mfma_f32_32x32x16_bf16 v[224:239], v[88:91], v[164:167], v[224:239]
    v_mul_f32 v127, v127, v13
    v_cvt_pk_bf16_f32 v120, v120, v121
    v_cvt_pk_bf16_f32 v121, v122, v123
    v_cvt_pk_bf16_f32 v122, v124, v125
    v_cvt_pk_bf16_f32 v123, v126, v127
    ds_read_b64_tr_b16 v[88:89], v12 offset:10240
    ds_read_b64_tr_b16 v[90:91], v12 offset:11264
    s_waitcnt lgkmcnt(12)
    v_mfma_f32_32x32x16_bf16 v[240:255], v[92:95], v[164:167], v[240:255]
    s_cmp_eq_u32 s97, 0
    s_cbranch_scc1 C_sl_51
    buffer_store_dwordx4 v[120:123], v6, s[32:35], s49 offen offset:3072
C_dn_52:
    ds_read_b64_tr_b16 v[92:93], v2 offset:10240
    ds_read_b64_tr_b16 v[94:95], v2 offset:11264
    v_mfma_f32_32x32x16_bf16 v[224:239], v[96:99], v[168:171], v[224:239]
    ds_read_b64_tr_b16 v[96:97], v12 offset:12288
    ds_read_b64_tr_b16 v[98:99], v12 offset:13312
    s_waitcnt lgkmcnt(12)
    v_mfma_f32_32x32x16_bf16 v[240:255], v[100:103], v[168:171], v[240:255]
    ds_read_b64_tr_b16 v[100:101], v2 offset:12288
    ds_read_b64_tr_b16 v[102:103], v2 offset:13312
    v_mfma_f32_32x32x16_bf16 v[224:239], v[104:107], v[172:175], v[224:239]
    s_waitcnt vmcnt(0)
    s_add_u32 s98, s56, 20480
    s_mov_b64 exec, 1
    s_cmp_eq_u32 s97, 0
    s_cbranch_scc1 C_sl_53
    buffer_store_dword v5, v4, s[32:35], s98 offen
C_dn_54:
    s_mov_b64 exec, -1
    s_add_u32 s62, s62, 4096
    ds_read_b64_tr_b16 v[104:105], v12 offset:14336
    ds_read_b64_tr_b16 v[106:107], v12 offset:15360
    s_waitcnt lgkmcnt(12)
    v_mfma_f32_32x32x16_bf16 v[240:255], v[108:111], v[172:175], v[240:255]
    ds_read_b64_tr_b16 v[108:109], v2 offset:14336
    ds_read_b64_tr_b16 v[110:111], v2 offset:15360
    v_mfma_f32_32x32x16_bf16 v[224:239], v[80:83], v[176:179], v[224:239]
    s_mul_i32 s98, s57, 16384
    s_add_u32 s98, s98, 0
    v_add_u32 v9, s98, v14
    v_add_u32 v10, s98, v15
    ds_read_b64_tr_b16 v[80:81], v9 offset:0
    ds_read_b64_tr_b16 v[82:83], v9 offset:1024
    s_waitcnt lgkmcnt(12)
    v_mfma_f32_32x32x16_bf16 v[240:255], v[84:87], v[176:179], v[240:255]
    ds_read_b64_tr_b16 v[84:85], v10 offset:0
    ds_read_b64_tr_b16 v[86:87], v10 offset:1024
    v_mfma_f32_32x32x16_bf16 v[224:239], v[88:91], v[180:183], v[224:239]
    buffer_load_dword v1, v7, s[32:35], s62 offen sc1
    ds_read_b64_tr_b16 v[88:89], v9 offset:2048
    ds_read_b64_tr_b16 v[90:91], v9 offset:3072
    s_waitcnt lgkmcnt(12)
    v_mfma_f32_32x32x16_bf16 v[240:255], v[92:95], v[180:183], v[240:255]
    ds_read_b64_tr_b16 v[92:93], v10 offset:2048
    ds_read_b64_tr_b16 v[94:95], v10 offset:3072
    v_mfma_f32_32x32x16_bf16 v[224:239], v[96:99], v[184:187], v[224:239]
    ds_read_b64_tr_b16 v[96:97], v9 offset:4096
    ds_read_b64_tr_b16 v[98:99], v9 offset:5120
    s_waitcnt lgkmcnt(12)
    v_mfma_f32_32x32x16_bf16 v[240:255], v[100:103], v[184:187], v[240:255]
    ds_read_b64_tr_b16 v[100:101], v10 offset:4096
    ds_read_b64_tr_b16 v[102:103], v10 offset:5120
    v_mfma_f32_32x32x16_bf16 v[224:239], v[104:107], v[188:191], v[224:239]
    ds_read_b64_tr_b16 v[104:105], v9 offset:6144
    ds_read_b64_tr_b16 v[106:107], v9 offset:7168
    s_waitcnt lgkmcnt(12)
    v_mfma_f32_32x32x16_bf16 v[240:255], v[108:111], v[188:191], v[240:255]
    s_barrier
    ds_read_b64_tr_b16 v[108:109], v10 offset:6144
    ds_read_b64_tr_b16 v[110:111], v10 offset:7168
    v_mfma_f32_32x32x16_bf16 v[224:239], v[80:83], v[192:195], v[224:239]
    ds_read_b64_tr_b16 v[80:81], v9 offset:8192
    ds_read_b64_tr_b16 v[82:83], v9 offset:9216
    s_waitcnt lgkmcnt(12)
    v_mfma_f32_32x32x16_bf16 v[240:255], v[84:87], v[192:195], v[240:255]
    ds_read_b64_tr_b16 v[84:85], v10 offset:8192
    ds_read_b64_tr_b16 v[86:87], v10 offset:9216
    v_mfma_f32_32x32x16_bf16 v[224:239], v[88:91], v[196:199], v[224:239]
    s_waitcnt vmcnt(0)
    v_cmp_ne_u32 vcc, s96, v1
    s_nop 1
    s_cbranch_vccnz C_rare_55
C_back_56:
    s_add_u32 s1, s19, 0
    buffer_load_dwordx4 v[16:19], v6, s[32:35], s1 offen sc1
    ds_read_b64_tr_b16 v[88:89], v9 offset:10240
    ds_read_b64_tr_b16 v[90:91], v9 offset:11264
    s_waitcnt lgkmcnt(12)
    v_mfma_f32_32x32x16_bf16 v[240:255], v[92:95], v[196:199], v[240:255]
    buffer_load_dwordx4 v[20:23], v6, s[32:35], s1 offen offset:1024 sc1
    ds_read_b64_tr_b16 v[92:93], v10 offset:10240
    ds_read_b64_tr_b16 v[94:95], v10 offset:11264
    v_mfma_f32_32x32x16_bf16 v[224:239], v[96:99], v[200:203], v[224:239]
    buffer_load_dwordx4 v[24:27], v6, s[32:35], s1 offen offset:2048 sc1
    ds_read_b64_tr_b16 v[96:97], v9 offset:12288
    ds_read_b64_tr_b16 v[98:99], v9 offset:13312
    s_waitcnt lgkmcnt(12)
    v_mfma_f32_32x32x16_bf16 v[240:255], v[100:103], v[200:203], v[240:255]
    buffer_load_dwordx4 v[28:31], v6, s[32:35], s1 offen offset:3072 sc1
    ds_read_b64_tr_b16 v[100:101], v10 offset:12288
    ds_read_b64_tr_b16 v[102:103], v10 offset:13312
    v_mfma_f32_32x32x16_bf16 v[224:239], v[104:107], v[204:207], v[224:239]
    s_add_u32 s1, s19, 4096
    buffer_load_dwordx4 v[32:35], v6, s[32:35], s1 offen sc1
    ds_read_b64_tr_b16 v[104:105], v9 offset:14336
    ds_read_b64_tr_b16 v[106:107], v9 offset:15360
    s_waitcnt lgkmcnt(12)
    v_mfma_f32_32x32x16_bf16 v[240:255], v[108:111], v[204:207], v[240:255]
    buffer_load_dwordx4 v[36:39], v6, s[32:35], s1 offen offset:1024 sc1
    ds_read_b64_tr_b16 v[108:109], v10 offset:14336
    ds_read_b64_tr_b16 v[110:111], v10 offset:15360
    v_mfma_f32_32x32x16_bf16 v[224:239], v[80:83], v[208:211], v[224:239]
    buffer_load_dwordx4 v[40:43], v6, s[32:35], s1 offen offset:2048 sc1
    s_mul_i32 s98, s57, 16384
    s_add_u32 s98, s98, 32768
    v_add_u32 v12, s98, v14
    v_add_u32 v2, s98, v15
    ds_read_b64_tr_b16 v[80:81], v12 offset:0
    ds_read_b64_tr_b16 v[82:83], v12 offset:1024
    s_waitcnt lgkmcnt(12)
    v_mfma_f32_32x32x16_bf16 v[240:255], v[84:87], v[208:211], v[240:255]
    buffer_load_dwordx4 v[44:47], v6, s[32:35], s1 offen offset:3072 sc1
    ds_read_b64_tr_b16 v[84:85], v2 offset:0
    ds_read_b64_tr_b16 v[86:87], v2 offset:1024
    v_mfma_f32_32x32x16_bf16 v[224:239], v[88:91], v[212:215], v[224:239]
    s_add_u32 s1, s20, 0
    buffer_load_dwordx4 v[48:51], v6, s[32:35], s1 offen sc1
    ds_read_b64_tr_b16 v[88:89], v12 offset:2048
    ds_read_b64_tr_b16 v[90:91], v12 offset:3072
    s_waitcnt lgkmcnt(12)
    v_mfma_f32_32x32x16_bf16 v[240:255], v[92:95], v[212:215], v[240:255]
    ds_read_b64_tr_b16 v[92:93], v2 offset:2048
    ds_read_b64_tr_b16 v[94:95], v2 offset:3072
    v_mfma_f32_32x32x16_bf16 v[224:239], v[96:99], v[216:219], v[224:239]
    buffer_load_dwordx4 v[52:55], v6, s[32:35], s1 offen offset:1024 sc1
    ds_read_b64_tr_b16 v[96:97], v12 offset:4096
    ds_read_b64_tr_b16 v[98:99], v12 offset:5120
    s_waitcnt lgkmcnt(12)
    v_mfma_f32_32x32x16_bf16 v[240:255], v[100:103], v[216:219], v[240:255]
    ds_read_b64_tr_b16 v[100:101], v2 offset:4096
    ds_read_b64_tr_b16 v[102:103], v2 offset:5120
    v_mfma_f32_32x32x16_bf16 v[224:239], v[104:107], v[220:223], v[224:239]
    buffer_load_dwordx4 v[56:59], v6, s[32:35], s1 offen offset:2048 sc1
    ds_read_b64_tr_b16 v[104:105], v12 offset:6144
    ds_read_b64_tr_b16 v[106:107], v12 offset:7168
    s_waitcnt lgkmcnt(12)
    v_mfma_f32_32x32x16_bf16 v[240:255], v[108:111], v[220:223], v[240:255]
    s_barrier
    ds_read_b64_tr_b16 v[108:109], v2 offset:6144
    ds_read_b64_tr_b16 v[110:111], v2 offset:7168
    s_waitcnt vmcnt(10)
    v_mfma_f32_32x32x16_bf16 v[224:239], v[80:83], v[16:19], v[224:239]
    buffer_load_dwordx4 v[60:63], v6, s[32:35], s1 offen offset:3072 sc1
    ds_read_b64_tr_b16 v[80:81], v12 offset:8192
    ds_read_b64_tr_b16 v[82:83], v12 offset:9216
    s_waitcnt lgkmcnt(12)
    v_mfma_f32_32x32x16_bf16 v[240:255], v[84:87], v[16:19], v[240:255]
    ds_read_b64_tr_b16 v[84:85], v2 offset:8192
    ds_read_b64_tr_b16 v[86:87], v2 offset:9216
    s_waitcnt vmcnt(10)
    v_mfma_f32_32x32x16_bf16 v[224:239], v[88:91], v[20:23], v[224:239]
    s_add_u32 s1, s20, 4096
    buffer_load_dwordx4 v[64:67], v6, s[32:35], s1 offen sc1
    ds_read_b64_tr_b16 v[88:89], v12 offset:10240
    ds_read_b64_tr_b16 v[90:91], v12 offset:11264
    s_waitcnt lgkmcnt(12)
    v_mfma_f32_32x32x16_bf16 v[240:255], v[92:95], v[20:23], v[240:255]
    ds_read_b64_tr_b16 v[92:93], v2 offset:10240
    ds_read_b64_tr_b16 v[94:95], v2 offset:11264
    s_waitcnt vmcnt(10)
    v_mfma_f32_32x32x16_bf16 v[224:239], v[96:99], v[24:27], v[224:239]
    buffer_load_dwordx4 v[68:71], v6, s[32:35], s1 offen offset:1024 sc1
    ds_read_b64_tr_b16 v[96:97], v12 offset:12288
    ds_read_b64_tr_b16 v[98:99], v12 offset:13312
    s_waitcnt lgkmcnt(12)
    v_mfma_f32_32x32x16_bf16 v[240:255], v[100:103], v[24:27], v[240:255]
    ds_read_b64_tr_b16 v[100:101], v2 offset:12288
    ds_read_b64_tr_b16 v[102:103], v2 offset:13312
    s_waitcnt vmcnt(10)
    v_mfma_f32_32x32x16_bf16 v[224:239], v[104:107], v[28:31], v[224:239]
    buffer_load_dwordx4 v[72:75], v6, s[32:35], s1 offen offset:2048 sc1
    ds_read_b64_tr_b16 v[104:105], v12 offset:14336
    ds_read_b64_tr_b16 v[106:107], v12 offset:15360
    s_waitcnt lgkmcnt(12)
    v_mfma_f32_32x32x16_bf16 v[240:255], v[108:111], v[28:31], v[240:255]
    ds_read_b64_tr_b16 v[108:109], v2 offset:14336
    ds_read_b64_tr_b16 v[110:111], v2 offset:15360
    s_waitcnt vmcnt(10)
    v_mfma_f32_32x32x16_bf16 v[224:239], v[80:83], v[32:35], v[224:239]
    buffer_load_dwordx4 v[76:79], v6, s[32:35], s1 offen offset:3072 sc1
    s_mul_i32 s98, s57, 16384
    s_add_u32 s98, s98, 65536
    v_add_u32 v9, s98, v14
    v_add_u32 v10, s98, v15
    ds_read_b64_tr_b16 v[80:81], v9 offset:0
    ds_read_b64_tr_b16 v[82:83], v9 offset:1024
    s_waitcnt lgkmcnt(12)
    v_mfma_f32_32x32x16_bf16 v[240:255], v[84:87], v[32:35], v[240:255]
    ds_read_b64_tr_b16 v[84:85], v10 offset:0
    ds_read_b64_tr_b16 v[86:87], v10 offset:1024
    s_waitcnt vmcnt(10)
    v_mfma_f32_32x32x16_bf16 v[224:239], v[88:91], v[36:39], v[224:239]
    s_add_u32 s1, s21, 0
    buffer_load_dwordx4 v[128:131], v6, s[32:35], s1 offen sc1
    ds_read_b64_tr_b16 v[88:89], v9 offset:2048
    ds_read_b64_tr_b16 v[90:91], v9 offset:3072
    s_waitcnt lgkmcnt(12)
    v_mfma_f32_32x32x16_bf16 v[240:255], v[92:95], v[36:39], v[240:255]
    ds_read_b64_tr_b16 v[92:93], v10 offset:2048
    ds_read_b64_tr_b16 v[94:95], v10 offset:3072
    s_waitcnt vmcnt(10)
    v_mfma_f32_32x32x16_bf16 v[224:239], v[96:99], v[40:43], v[224:239]
    buffer_load_dwordx4 v[132:135], v6, s[32:35], s1 offen offset:1024 sc1
    ds_read_b64_tr_b16 v[96:97], v9 offset:4096
    ds_read_b64_tr_b16 v[98:99], v9 offset:5120
    s_waitcnt lgkmcnt(12)
    v_mfma_f32_32x32x16_bf16 v[240:255], v[100:103], v[40:43], v[240:255]
    ds_read_b64_tr_b16 v[100:101], v10 offset:4096
    ds_read_b64_tr_b16 v[102:103], v10 offset:5120
    s_waitcnt vmcnt(10)
    v_mfma_f32_32x32x16_bf16 v[224:239], v[104:107], v[44:47], v[224:239]
    buffer_load_dwordx4 v[136:139], v6, s[32:35], s1 offen offset:2048 sc1
    ds_read_b64_tr_b16 v[104:105], v9 offset:6144
    ds_read_b64_tr_b16 v[106:107], v9 offset:7168
    s_waitcnt lgkmcnt(12)
    v_mfma_f32_32x32x16_bf16 v[240:255], v[108:111], v[44:47], v[240:255]
    s_barrier
    ds_read_b64_tr_b16 v[108:109], v10 offset:6144
    ds_read_b64_tr_b16 v[110:111], v10 offset:7168
    s_waitcnt vmcnt(10)
    v_mfma_f32_32x32x16_bf16 v[224:239], v[80:83], v[48:51], v[224:239]
    buffer_load_dwordx4 v[140:143], v6, s[32:35], s1 offen offset:3072 sc1
    ds_read_b64_tr_b16 v[80:81], v9 offset:8192
    ds_read_b64_tr_b16 v[82:83], v9 offset:9216
    s_waitcnt lgkmcnt(12)
    v_mfma_f32_32x32x16_bf16 v[240:255], v[84:87], v[48:51], v[240:255]
    ds_read_b64_tr_b16 v[84:85], v10 offset:8192
    ds_read_b64_tr_b16 v[86:87], v10 offset:9216
    s_waitcnt vmcnt(10)
    v_mfma_f32_32x32x16_bf16 v[224:239], v[88:91], v[52:55], v[224:239]
    s_add_u32 s1, s21, 4096
    buffer_load_dwordx4 v[144:147], v6, s[32:35], s1 offen sc1
    ds_read_b64_tr_b16 v[88:89], v9 offset:10240
    ds_read_b64_tr_b16 v[90:91], v9 offset:11264
    s_waitcnt lgkmcnt(12)
    v_mfma_f32_32x32x16_bf16 v[240:255], v[92:95], v[52:55], v[240:255]
    ds_read_b64_tr_b16 v[92:93], v10 offset:10240
    ds_read_b64_tr_b16 v[94:95], v10 offset:11264
    s_waitcnt vmcnt(10)
    v_mfma_f32_32x32x16_bf16 v[224:239], v[96:99], v[56:59], v[224:239]
    buffer_load_dwordx4 v[148:151], v6, s[32:35], s1 offen offset:1024 sc1
    ds_read_b64_tr_b16 v[96:97], v9 offset:12288
    ds_read_b64_tr_b16 v[98:99], v9 offset:13312
    s_waitcnt lgkmcnt(12)
    v_mfma_f32_32x32x16_bf16 v[240:255], v[100:103], v[56:59], v[240:255]
    ds_read_b64_tr_b16 v[100:101], v10 offset:12288
    ds_read_b64_tr_b16 v[102:103], v10 offset:13312
    s_waitcnt vmcnt(10)
    v_mfma_f32_32x32x16_bf16 v[224:239], v[104:107], v[60:63], v[224:239]
    buffer_load_dwordx4 v[152:155], v6, s[32:35], s1 offen offset:2048 sc1
    ds_read_b64_tr_b16 v[104:105], v9 offset:14336
    ds_read_b64_tr_b16 v[106:107], v9 offset:15360
    s_waitcnt lgkmcnt(12)
    v_mfma_f32_32x32x16_bf16 v[240:255], v[108:111], v[60:63], v[240:255]
    ds_read_b64_tr_b16 v[108:109], v10 offset:14336
    ds_read_b64_tr_b16 v[110:111], v10 offset:15360
    s_waitcnt vmcnt(10)
    v_mfma_f32_32x32x16_bf16 v[224:239], v[80:83], v[64:67], v[224:239]
    buffer_load_dwordx4 v[156:159], v6, s[32:35], s1 offen offset:3072 sc1
    s_mul_i32 s98, s57, -32768
    s_add_u32 s98, s98, 132096
    v_add_u32 v12, s98, v14
    v_add_u32 v2, s98, v15
    ds_read_b64_tr_b16 v[80:81], v12 offset:0
    ds_read_b64_tr_b16 v[82:83], v12 offset:1024
    s_waitcnt lgkmcnt(12)
    v_mfma_f32_32x32x16_bf16 v[240:255], v[84:87], v[64:67], v[240:255]
    ds_read_b64_tr_b16 v[84:85], v2 offset:0
    ds_read_b64_tr_b16 v[86:87], v2 offset:1024
    s_waitcnt vmcnt(10)
    v_mfma_f32_32x32x16_bf16 v[224:239], v[88:91], v[68:71], v[224:239]
    s_add_u32 s1, s22, 0
    buffer_load_dwordx4 v[160:163], v6, s[32:35], s1 offen sc1
    ds_read_b64_tr_b16 v[88:89], v12 offset:2048
    ds_read_b64_tr_b16 v[90:91], v12 offset:3072
    s_waitcnt lgkmcnt(12)
    v_mfma_f32_32x32x16_bf16 v[240:255], v[92:95], v[68:71], v[240:255]
    ds_read_b64_tr_b16 v[92:93], v2 offset:2048
    ds_read_b64_tr_b16 v[94:95], v2 offset:3072
    s_waitcnt vmcnt(10)
    v_mfma_f32_32x32x16_bf16 v[224:239], v[96:99], v[72:75], v[224:239]
    buffer_load_dwordx4 v[164:167], v6, s[32:35], s1 offen offset:1024 sc1
    ds_read_b64_tr_b16 v[96:97], v12 offset:4096
    ds_read_b64_tr_b16 v[98:99], v12 offset:5120
    s_waitcnt lgkmcnt(12)
    v_mfma_f32_32x32x16_bf16 v[240:255], v[100:103], v[72:75], v[240:255]
    ds_read_b64_tr_b16 v[100:101], v2 offset:4096
    ds_read_b64_tr_b16 v[102:103], v2 offset:5120
    s_waitcnt vmcnt(10)
    v_mfma_f32_32x32x16_bf16 v[224:239], v[104:107], v[76:79], v[224:239]
    buffer_load_dwordx4 v[168:171], v6, s[32:35], s1 offen offset:2048 sc1
    ds_read_b64_tr_b16 v[104:105], v12 offset:6144
    ds_read_b64_tr_b16 v[106:107], v12 offset:7168
    s_waitcnt lgkmcnt(12)
    v_mfma_f32_32x32x16_bf16 v[240:255], v[108:111], v[76:79], v[240:255]
    s_barrier
    ds_read_b64_tr_b16 v[108:109], v2 offset:6144
    ds_read_b64_tr_b16 v[110:111], v2 offset:7168
    s_waitcnt vmcnt(10)
    v_mfma_f32_32x32x16_bf16 v[224:239], v[80:83], v[128:131], v[224:239]
    buffer_load_dwordx4 v[172:175], v6, s[32:35], s1 offen offset:3072 sc1
    v_add_u32 v124, s26, v6
    ds_read_b64_tr_b16 v[80:81], v12 offset:8192
    ds_read_b64_tr_b16 v[82:83], v12 offset:9216
    s_waitcnt lgkmcnt(12)
    v_mfma_f32_32x32x16_bf16 v[240:255], v[84:87], v[128:131], v[240:255]
    ds_read_b128 v[112:115], v124
    ds_read_b128 v[116:119], v124 offset:1024
    ds_read_b64_tr_b16 v[84:85], v2 offset:8192
    ds_read_b64_tr_b16 v[86:87], v2 offset:9216
    s_waitcnt vmcnt(10)
    v_mfma_f32_32x32x16_bf16 v[224:239], v[88:91], v[132:135], v[224:239]
    s_add_u32 s1, s22, 4096
    buffer_load_dwordx4 v[176:179], v6, s[32:35], s1 offen sc1
    ds_read_b64_tr_b16 v[88:89], v12 offset:10240
    ds_read_b64_tr_b16 v[90:91], v12 offset:11264
    s_waitcnt lgkmcnt(13)
    v_mfma_f32_32x32x16_bf16 v[240:255], v[92:95], v[132:135], v[240:255]
    ds_read_b64_tr_b16 v[92:93], v2 offset:10240
    ds_read_b64_tr_b16 v[94:95], v2 offset:11264
    s_waitcnt vmcnt(10)
    v_mfma_f32_32x32x16_bf16 v[224:239], v[96:99], v[136:139], v[224:239]
    buffer_load_dwordx4 v[180:183], v6, s[32:35], s1 offen offset:1024 sc1
    ds_read_b64_tr_b16 v[96:97], v12 offset:12288
    ds_read_b64_tr_b16 v[98:99], v12 offset:13312
    s_waitcnt lgkmcnt(13)
    v_mfma_f32_32x32x16_bf16 v[240:255], v[100:103], v[136:139], v[240:255]
    ds_read_b64_tr_b16 v[100:101], v2 offset:12288
    ds_read_b64_tr_b16 v[102:103], v2 offset:13312
    s_waitcnt vmcnt(10)
    v_mfma_f32_32x32x16_bf16 v[224:239], v[104:107], v[140:143], v[224:239]
    buffer_load_dwordx4 v[184:187], v6, s[32:35], s1 offen offset:2048 sc1
    ds_read_b64_tr_b16 v[104:105], v12 offset:14336
    ds_read_b64_tr_b16 v[106:107], v12 offset:15360
    s_waitcnt lgkmcnt(13)
    v_mfma_f32_32x32x16_bf16 v[240:255], v[108:111], v[140:143], v[240:255]
    ds_read_b64_tr_b16 v[108:109], v2 offset:14336
    ds_read_b64_tr_b16 v[110:111], v2 offset:15360
    s_waitcnt vmcnt(10)
    v_mfma_f32_32x32x16_bf16 v[224:239], v[80:83], v[144:147], v[224:239]
    buffer_load_dwordx4 v[188:191], v6, s[32:35], s1 offen offset:3072 sc1
    s_lshl_b32 s23, s3, 12
    s_add_u32 s23, s23, 16384
    s_mul_i32 s98, s57, -115712
    s_add_u32 s98, s98, 115712
    v_add_u32 v9, s98, v14
    v_add_u32 v10, s98, v15
    ds_read_b64_tr_b16 v[80:81], v9 offset:0
    ds_read_b64_tr_b16 v[82:83], v9 offset:1024
    s_waitcnt lgkmcnt(12)
    v_mfma_f32_32x32x16_bf16 v[240:255], v[84:87], v[144:147], v[240:255]
    v_add_u32 v120, s23, v6
    v_xor_b32 v121, 8192, v120
    ds_read_b64_tr_b16 v[84:85], v10 offset:0
    ds_read_b64_tr_b16 v[86:87], v10 offset:1024
    s_waitcnt vmcnt(10)
    v_mfma_f32_32x32x16_bf16 v[224:239], v[88:91], v[148:151], v[224:239]
    s_lshl_b32 s101, s59, 15
    s_lshl_b32 s99, s6, 7
    ds_read_b64_tr_b16 v[88:89], v9 offset:2048
    ds_read_b64_tr_b16 v[90:91], v9 offset:3072
    s_waitcnt lgkmcnt(12)
    v_mfma_f32_32x32x16_bf16 v[240:255], v[92:95], v[148:151], v[240:255]
    s_add_u32 s101, s101, s99
    s_lshl_b32 s99, s57, 6
    ds_read_b64_tr_b16 v[92:93], v10 offset:2048
    ds_read_b64_tr_b16 v[94:95], v10 offset:3072
    s_waitcnt vmcnt(9)
    v_mfma_f32_32x32x16_bf16 v[224:239], v[96:99], v[152:155], v[224:239]
    s_add_u32 s101, s101, s99
    v_and_b32 v122, 31, v0
    ds_read_b64_tr_b16 v[96:97], v9 offset:4096
    ds_read_b64_tr_b16 v[98:99], v9 offset:5120
    s_waitcnt lgkmcnt(12)
    v_mfma_f32_32x32x16_bf16 v[240:255], v[100:103], v[152:155], v[240:255]
    v_lshrrev_b32 v123, 5, v0
    v_lshlrev_b32 v122, 10, v122
    ds_read_b64_tr_b16 v[100:101], v10 offset:4096
    ds_read_b64_tr_b16 v[102:103], v10 offset:5120
    s_waitcnt vmcnt(8)
    v_mfma_f32_32x32x16_bf16 v[224:239], v[104:107], v[156:159], v[224:239]
    v_lshl_add_u32 v122, v123, 4, v122
    ds_read_b64_tr_b16 v[104:105], v9 offset:6144
    ds_read_b64_tr_b16 v[106:107], v9 offset:7168
    s_waitcnt lgkmcnt(12)
    v_mfma_f32_32x32x16_bf16 v[240:255], v[108:111], v[156:159], v[240:255]
    ds_read_b64_tr_b16 v[108:109], v10 offset:6144
    ds_read_b64_tr_b16 v[110:111], v10 offset:7168
    s_waitcnt vmcnt(7)
    v_mfma_f32_32x32x16_bf16 v[224:239], v[80:83], v[160:163], v[224:239]
    ds_read_b64_tr_b16 v[80:81], v9 offset:8192
    ds_read_b64_tr_b16 v[82:83], v9 offset:9216
    s_waitcnt lgkmcnt(12)
    v_mfma_f32_32x32x16_bf16 v[240:255], v[84:87], v[160:163], v[240:255]
    ds_read_b64_tr_b16 v[84:85], v10 offset:8192
    ds_read_b64_tr_b16 v[86:87], v10 offset:9216
    s_waitcnt vmcnt(6)
    v_mfma_f32_32x32x16_bf16 v[224:239], v[88:91], v[164:167], v[224:239]
    ds_read_b64_tr_b16 v[88:89], v9 offset:10240
    ds_read_b64_tr_b16 v[90:91], v9 offset:11264
    s_waitcnt lgkmcnt(12)
    v_mfma_f32_32x32x16_bf16 v[240:255], v[92:95], v[164:167], v[240:255]
    ds_read_b64_tr_b16 v[92:93], v10 offset:10240
    ds_read_b64_tr_b16 v[94:95], v10 offset:11264
    s_waitcnt vmcnt(5)
    v_mfma_f32_32x32x16_bf16 v[224:239], v[96:99], v[168:171], v[224:239]
    v_lshlrev_b32 v144, 16, v112
    v_and_b32 v145, 0xffff0000, v112
    ds_read_b64_tr_b16 v[96:97], v9 offset:12288
    ds_read_b64_tr_b16 v[98:99], v9 offset:13312
    s_waitcnt lgkmcnt(12)
    v_mfma_f32_32x32x16_bf16 v[240:255], v[100:103], v[168:171], v[240:255]
    v_lshlrev_b32 v146, 16, v113
    v_and_b32 v147, 0xffff0000, v113
    ds_read_b64_tr_b16 v[100:101], v10 offset:12288
    ds_read_b64_tr_b16 v[102:103], v10 offset:13312
    s_waitcnt vmcnt(4)
    v_mfma_f32_32x32x16_bf16 v[224:239], v[104:107], v[172:175], v[224:239]
    v_lshlrev_b32 v148, 16, v114
    v_and_b32 v149, 0xffff0000, v114
    ds_read_b64_tr_b16 v[104:105], v9 offset:14336
    ds_read_b64_tr_b16 v[106:107], v9 offset:15360
    s_waitcnt lgkmcnt(12)
    v_mfma_f32_32x32x16_bf16 v[240:255], v[108:111], v[172:175], v[240:255]
    v_lshlrev_b32 v150, 16, v115
    v_and_b32 v151, 0xffff0000, v115
    ds_read_b64_tr_b16 v[108:109], v10 offset:14336
    ds_read_b64_tr_b16 v[110:111], v10 offset:15360
    s_waitcnt vmcnt(3)
    v_mfma_f32_32x32x16_bf16 v[224:239], v[80:83], v[176:179], v[224:239]
    v_lshlrev_b32 v152, 16, v116
    v_and_b32 v153, 0xffff0000, v116
    s_waitcnt lgkmcnt(10)
    v_mfma_f32_32x32x16_bf16 v[240:255], v[84:87], v[176:179], v[240:255]
    v_lshlrev_b32 v154, 16, v117
    v_and_b32 v155, 0xffff0000, v117
    s_waitcnt vmcnt(2)
    v_mfma_f32_32x32x16_bf16 v[224:239], v[88:91], v[180:183], v[224:239]
    v_lshlrev_b32 v156, 16, v118
    v_and_b32 v157, 0xffff0000, v118
    s_waitcnt lgkmcnt(6)
    v_mfma_f32_32x32x16_bf16 v[240:255], v[92:95], v[180:183], v[240:255]
    v_lshlrev_b32 v158, 16, v119
    v_and_b32 v159, 0xffff0000, v119
    s_waitcnt vmcnt(1)
    v_mfma_f32_32x32x16_bf16 v[224:239], v[96:99], v[184:187], v[224:239]
    s_waitcnt lgkmcnt(4)
    v_mfma_f32_32x32x16_bf16 v[240:255], v[100:103], v[184:187], v[240:255]
    s_waitcnt vmcnt(0) lgkmcnt(2)
    v_mfma_f32_32x32x16_bf16 v[224:239], v[104:107], v[188:191], v[224:239]
    s_waitcnt lgkmcnt(0)
    v_mfma_f32_32x32x16_bf16 v[240:255], v[108:111], v[188:191], v[240:255]
    s_nop 11
    ds_write_b128 v120, v[240:243] offset:0
    ds_write_b128 v120, v[244:247] offset:1024
    ds_write_b128 v120, v[248:251] offset:2048
    ds_write_b128 v120, v[252:255] offset:3072
    v_pk_add_f32 v[224:225], v[224:225], v[144:145]
    v_pk_add_f32 v[226:227], v[226:227], v[146:147]
    v_pk_add_f32 v[228:229], v[228:229], v[148:149]
    v_pk_add_f32 v[230:231], v[230:231], v[150:151]
    v_pk_add_f32 v[232:233], v[232:233], v[152:153]
    v_pk_add_f32 v[234:235], v[234:235], v[154:155]
    v_pk_add_f32 v[236:237], v[236:237], v[156:157]
    v_pk_add_f32 v[238:239], v[238:239], v[158:159]
    s_waitcnt lgkmcnt(0)
    s_barrier
    ds_read_b128 v[32:35], v121 offset:0
    ds_read_b128 v[36:39], v121 offset:1024
    ds_read_b128 v[40:43], v121 offset:2048
    ds_read_b128 v[44:47], v121 offset:3072
    s_waitcnt lgkmcnt(3)
    v_pk_add_f32 v[224:225], v[224:225], v[32:33]
    v_pk_add_f32 v[226:227], v[226:227], v[34:35]
    s_waitcnt lgkmcnt(2)
    v_pk_add_f32 v[228:229], v[228:229], v[36:37]
    v_pk_add_f32 v[230:231], v[230:231], v[38:39]
    v_cvt_pk_bf16_f32 v48, v224, v225
    v_cvt_pk_bf16_f32 v49, v226, v227
    v_cvt_pk_bf16_f32 v50, v228, v229
    v_cvt_pk_bf16_f32 v51, v230, v231
    s_nop 0
    v_permlane32_swap_b32 v48, v50
    v_permlane32_swap_b32 v49, v51
    buffer_store_dwordx4 v[48:51], v122, s[36:39], s101 offen offset:0
    s_waitcnt lgkmcnt(1)
    v_pk_add_f32 v[232:233], v[232:233], v[40:41]
    v_pk_add_f32 v[234:235], v[234:235], v[42:43]
    s_waitcnt lgkmcnt(0)
    v_pk_add_f32 v[236:237], v[236:237], v[44:45]
    v_pk_add_f32 v[238:239], v[238:239], v[46:47]
    v_cvt_pk_bf16_f32 v52, v232, v233
    v_cvt_pk_bf16_f32 v53, v234, v235
    v_cvt_pk_bf16_f32 v54, v236, v237
    v_cvt_pk_bf16_f32 v55, v238, v239
    s_nop 0
    v_permlane32_swap_b32 v52, v54
    v_permlane32_swap_b32 v53, v55
    buffer_store_dwordx4 v[52:55], v122, s[36:39], s101 offen offset:32
    s_endpgm
C_sl_11:
    buffer_store_dwordx4 v[96:99], v6, s[32:35], s48 offen offset:0 sc1
    s_branch C_dn_12
C_sl_13:
    buffer_store_dwordx4 v[100:103], v6, s[32:35], s48 offen offset:1024 sc1
    s_branch C_dn_14
C_sl_15:
    buffer_store_dword v5, v4, s[32:35], s49 offen sc1
    s_branch C_dn_16
C_rare_21:
    s_mov_b32 s95, 0
C_rl_23:
    ds_read_b32 v1, v11 offset:16
    s_add_u32 s95, s95, 1
    s_cmp_gt_u32 s95, 16777216
    s_waitcnt lgkmcnt(0)
    s_cbranch_scc1 C_back_22
    v_readfirstlane_b32 s94, v1
    s_nop 1
    s_cmp_lt_u32 s94, 2
    s_cbranch_scc1 C_rl_23
    s_branch C_back_22
C_rare_24:
    s_mov_b32 s95, 0
C_rl_26:
    ds_read_b32 v1, v11 offset:16
    s_add_u32 s95, s95, 1
    s_cmp_gt_u32 s95, 16777216
    s_waitcnt lgkmcnt(0)
    s_cbranch_scc1 C_back_25
    v_readfirstlane_b32 s94, v1
    s_nop 1
    s_cmp_lt_u32 s94, 3
    s_cbranch_scc1 C_rl_26
    s_branch C_back_25
C_rare_27:
    s_mov_b32 s95, 0
C_rl_29:
    ds_read_b32 v1, v11 offset:16
    s_add_u32 s95, s95, 1
    s_cmp_gt_u32 s95, 16777216
    s_waitcnt lgkmcnt(0)
    s_cbranch_scc1 C_back_28
    v_readfirstlane_b32 s94, v1
    s_nop 1
    s_cmp_lt_u32 s94, 4
    s_cbranch_scc1 C_rl_29
    s_branch C_back_28
C_sl_30:
    buffer_store_dwordx4 v[96:99], v6, s[32:35], s48 offen sc1
    buffer_store_dwordx4 v[100:103], v6, s[32:35], s48 offen offset:1024 sc1
    s_branch C_dn_31
C_sl_32:
    buffer_store_dword v1, v3, s[32:35], s49 offen sc1
    s_branch C_dn_33
C_sl_34:
    buffer_store_dword v5, v4, s[32:35], s58 offen sc1
    s_branch C_dn_35
C_rare_39:
    s_mov_b32 s95, 0
C_rl_41:
    buffer_load_dword v1, v7, s[32:35], s62 offen sc1
    s_add_u32 s95, s95, 1
    s_cmp_gt_u32 s95, 262144
    s_waitcnt vmcnt(0)
    s_cbranch_scc1 C_back_40
    v_cmp_ne_u32 vcc, s96, v1
    s_nop 1
    s_cbranch_vccnz C_rl_41
    s_branch C_back_40
C_rare_42:
    s_mov_b32 s95, 0
C_rl_44:
    buffer_load_dword v1, v3, s[32:35], s25 offen sc1
    s_add_u32 s95, s95, 1
    s_cmp_gt_u32 s95, 262144
    s_waitcnt vmcnt(0)
    s_cbranch_scc1 C_back_43
    v_cmp_ne_u32 vcc, s96, v1
    s_nop 1
    s_cbranch_vccnz C_rl_44
    s_branch C_back_43
C_sl_45:
    buffer_store_dwordx4 v[120:123], v6, s[32:35], s49 offen offset:0 sc1
    s_branch C_dn_46
C_sl_47:
    buffer_store_dwordx4 v[120:123], v6, s[32:35], s49 offen offset:1024 sc1
    s_branch C_dn_48
C_sl_49:
    buffer_store_dwordx4 v[120:123], v6, s[32:35], s49 offen offset:2048 sc1
    s_branch C_dn_50
C_sl_51:
    buffer_store_dwordx4 v[120:123], v6, s[32:35], s49 offen offset:3072 sc1
    s_branch C_dn_52
C_sl_53:
    buffer_store_dword v5, v4, s[32:35], s98 offen sc1
    s_branch C_dn_54
C_rare_55:
    s_mov_b32 s95, 0
C_rl_57:
    buffer_load_dword v1, v7, s[32:35], s62 offen sc1
    s_add_u32 s95, s95, 1
    s_cmp_gt_u32 s95, 262144
    s_waitcnt vmcnt(0)
    s_cbranch_scc1 C_back_56
    v_cmp_ne_u32 vcc, s96, v1
    s_nop 1
    s_cbranch_vccnz C_rl_57
    s_branch C_back_56
L_END:
    s_endpgm
.set CODE_LINES, (L_END - sequential_preLN__linear_kernel_hedgehog__glu_gated_bilinear__prompt_kernel + 131) / 128
.set CODE_LINES32, (CODE_LINES + 31) / 32
.section .rodata,"a"
.p2align 6
.amdhsa_kernel sequential_preLN__linear_kernel_hedgehog__glu_gated_bilinear__prompt_kernel
  .amdhsa_next_free_vgpr 256
  .amdhsa_next_free_sgpr 102
  .amdhsa_accum_offset 256
  .amdhsa_group_segment_fixed_size 0
  .amdhsa_kernarg_size 88
  .amdhsa_user_sgpr_count 2
  .amdhsa_user_sgpr_kernarg_segment_ptr 1
  .amdhsa_system_sgpr_workgroup_id_x 1
.end_amdhsa_kernel
```
